```python
import torch

def _softmax(x, axis=-1):
    return torch.softmax(x, dim=axis)

def _gelu(x):
    return torch.nn.functional.gelu(x, approximate='tanh')

def _silu(x):
    return torch.nn.functional.silu(x)

def _sigmoid(x):
    return torch.sigmoid(x)

def _layernorm(x, axis=-1, eps=1e-05):
    m = x.mean(dim=axis, keepdim=True)
    v = x.var(dim=axis, keepdim=True, unbiased=False)
    return (x - m) / torch.sqrt(v + eps)

def _scatter_add(tgt, idx, src, axis=0):
    return tgt.clone().index_add_(axis, idx, src)

def _segment_sum(src, seg, n):
    out = torch.zeros((n,) + src.shape[1:], dtype=src.dtype)
    return out.index_add_(0, seg, src)

def _pad(x, pw):
    flat = tuple((v for pair in reversed(pw) for v in pair))
    return torch.nn.functional.pad(x, flat)
kernel_name = 'standalone__tensor_product_equiv_equiformer__graph'

def setup_inputs():

    _w = lambda a: (lambda t: t.to(torch.bfloat16) if t.is_floating_point() else t)(torch.as_tensor(a))
    N, deg, C, De = (10000, 32, 128, max(0, 1))
    E = N * deg
    src = (lambda lo, hi, *s: torch.randint(lo, hi, s))(0, N, E).to(torch.int64)
    dst = (lambda lo, hi, *s: torch.randint(lo, hi, s))(0, N, E).to(torch.int64)
    rvec = (lambda *s: torch.randn(*s, dtype=torch.bfloat16) * 0.05)(E, 3).to(float)
    rn = (torch.linalg.norm(rvec, dim=-1, keepdim=True) + 1e-06).to(float)
    rhat = (rvec / rn).to(float)
    eps = torch.zeros((3, 3, 3), dtype=float)
    eps[0, 1, 2] = eps[1, 2, 0] = eps[2, 0, 1] = 1.0
    eps[0, 2, 1] = eps[2, 1, 0] = eps[1, 0, 2] = -1.0
    return {'x': _w((lambda *s: torch.randn(*s, dtype=torch.bfloat16) * 0.4)(N, 4 * C).to(float)), 'rhat': _w(rhat), 'e_attr': _w((lambda *s: torch.randn(*s, dtype=torch.bfloat16) * 0.4)(E, De).to(float)), 'src': _w(src), 'dst': _w(dst), 'w_rad': _w((lambda *s: torch.randn(*s, dtype=torch.bfloat16) * 0.4)(De, 5 * C).to(float)), 'w_si0': _w((lambda *s: torch.randn(*s, dtype=torch.bfloat16) * 0.4)(2 * C, C).to(float)), 'w_si1': _w((lambda *s: torch.randn(*s, dtype=torch.bfloat16) * 0.05)(3 * C, C).to(float)), 'cg_eps': _w(eps)}

def reference(x, rhat, e_attr, src, dst, w_rad, w_si0, w_si1, cg_eps):
    N = x.shape[0]
    C = w_si0.shape[1]
    E = rhat.shape[0]
    x0 = x[:, :C].clone()
    x1 = x[:, C:].reshape(N, 3, C)
    R = (e_attr @ w_rad).reshape(E, 5, C)
    f0 = x0[src]
    f1 = x1[src]
    Y1 = rhat
    p00_0 = f0 * R[:, 0, :]
    p11_0 = torch.einsum('ejc,ej->ec', f1, Y1) * R[:, 1, :]
    p01_1 = torch.einsum('ec,ej->ejc', f0, Y1) * R[:, 2, :][:, None, :]
    p10_1 = f1 * R[:, 3, :][:, None, :]
    p11_1 = torch.einsum('ijk,ekc,ej->eic', cg_eps, f1, Y1) * R[:, 4, :][:, None, :]
    m0 = torch.concatenate([p00_0, p11_0], axis=-1) @ w_si0
    m1 = torch.einsum('ejp,pc->ejc', torch.concatenate([p01_1, p10_1, p11_1], axis=-1), w_si1)
    agg0 = _segment_sum(m0, dst, N)
    agg1 = _segment_sum(m1.reshape(E, 3 * C), dst, N).reshape(N, 3, C)
    gate = _sigmoid(agg0)
    out1 = agg1 * gate[:, None, :]
    return torch.concatenate([agg0, out1.reshape(N, 3 * C)], axis=-1)
```

```asm
; @launch grid=(256,1,1) block=(512,1,1) lds=157696
.amdgcn_target "amdgcn-amd-amdhsa--gfx950"
.text
  .globl standalone__tensor_product_equiv_equiformer__graph_kernel
  .p2align 8
  .type standalone__tensor_product_equiv_equiformer__graph_kernel,@function
standalone__tensor_product_equiv_equiformer__graph_kernel:
  s_cmp_ge_u32 s2, 256
  s_cbranch_scc1 K2_END
  s_load_dwordx4 s[4:7], s[0:1], 8
  s_load_dwordx4 s[8:11], s[0:1], 24
  s_load_dwordx2 s[12:13], s[0:1], 88
  v_lshrrev_b32 v1, 6, v0
  s_load_dwordx2 s[92:93], s[0:1], 80
  s_mov_b32 s94, 256
  s_mov_b32 s95, 0x20000
  v_readfirstlane_b32 s3, v1
  s_cmp_ge_u32 s2, 250
  s_cbranch_scc1 F_NOK1
  s_cmp_ge_u32 s3, 5
  s_cbranch_scc1 F_AUX
  s_mul_i32 s14, s2, 1280
  v_lshlrev_b32 v1, 2, v0
  v_add_u32 v1, s14, v1
  v_lshlrev_b32 v2, 2, v1
  v_mul_u32_u24 v3, 6, v1
  v_lshlrev_b32 v40, 1, v1
  s_waitcnt lgkmcnt(0)
  s_mov_b32 s16, s10
  s_mov_b32 s17, s11
  s_mov_b32 s18, 1280000
  s_mov_b32 s19, 0x20000
  buffer_load_dwordx4 v[4:7], v2, s[16:19], 0 offen
  s_mov_b32 s20, s8
  s_mov_b32 s21, s9
  s_mov_b32 s22, 1280000
  s_mov_b32 s23, 0x20000
  buffer_load_dwordx4 v[8:11], v2, s[20:23], 0 offen
  s_mov_b32 s24, s4
  s_mov_b32 s25, s5
  s_mov_b32 s26, 1920000
  s_mov_b32 s27, 0x20000
  buffer_load_dwordx4 v[12:15], v3, s[24:27], 0 offen
  buffer_load_dwordx2 v[16:17], v3, s[24:27], 0 offen offset:16
  s_mov_b32 s28, s6
  s_mov_b32 s29, s7
  s_mov_b32 s30, 640000
  s_mov_b32 s31, 0x20000
  buffer_load_dwordx2 v[18:19], v40, s[28:31], 0 offen
  s_mov_b32 s32, s12
  s_mov_b32 s33, s13
  s_mov_b32 s34, 3840000
  s_mov_b32 s35, 0x20000
  s_add_u32 s36, s12, 4194304
  s_addc_u32 s37, s13, 0
  s_mov_b32 s38, 256000
  s_mov_b32 s39, 0x20000
  s_cmp_lg_u32 s3, 0
  s_cbranch_scc1 K1_NOZ
  v_mov_b32 v44, 0
  v_mov_b32 v45, 0
  v_mov_b32 v46, 0
  v_mov_b32 v47, 0
  v_lshlrev_b32 v41, 4, v0
  ds_write_b128 v41, v[44:47] offset:0
  s_waitcnt lgkmcnt(0)
K1_NOZ:
  s_barrier
  s_mov_b32 s40, 625
  v_mov_b32 v42, 1
  s_mov_b32 s41, 2048
  s_waitcnt vmcnt(4)
  v_mul_u32_u24 v48, 214749, v4
  v_mul_u32_u24 v49, 214749, v5
  v_mul_u32_u24 v50, 214749, v6
  v_mul_u32_u24 v51, 214749, v7
  v_lshrrev_b32 v52, 23, v48
  v_lshrrev_b32 v53, 23, v49
  v_lshrrev_b32 v54, 23, v50
  v_lshrrev_b32 v55, 23, v51
  v_lshlrev_b32 v48, 2, v52
  ds_add_rtn_u32 v56, v48, v42 offset:0
  v_lshlrev_b32 v49, 2, v53
  ds_add_rtn_u32 v57, v49, v42 offset:0
  v_lshlrev_b32 v50, 2, v54
  ds_add_rtn_u32 v58, v50, v42 offset:0
  v_lshlrev_b32 v51, 2, v55
  ds_add_rtn_u32 v59, v51, v42 offset:0
  v_mad_u32_u24 v52, v52, s40, 15
  v_mad_u32_u24 v53, v53, s40, 15
  v_mad_u32_u24 v54, v54, s40, 15
  v_mad_u32_u24 v55, v55, s40, 15
  v_lshrrev_b32 v52, 4, v52
  v_lshrrev_b32 v53, 4, v53
  v_lshrrev_b32 v54, 4, v54
  v_lshrrev_b32 v55, 4, v55
  v_sub_u32 v52, v4, v52
  v_sub_u32 v53, v5, v53
  v_sub_u32 v54, v6, v54
  v_sub_u32 v55, v7, v55
  s_waitcnt lgkmcnt(0)
  s_barrier
  v_and_b32 v41, 63, v0
  v_lshlrev_b32 v43, 4, v41
  ds_read_b128 v[68:71], v43 offset:0
  s_waitcnt vmcnt(0)
  v_lshlrev_b32 v60, 10, v8
  v_lshl_or_b32 v22, v52, 3, v60
  v_lshlrev_b32 v61, 10, v9
  v_lshl_or_b32 v26, v53, 3, v61
  v_lshlrev_b32 v62, 10, v10
  v_lshl_or_b32 v30, v54, 3, v62
  v_lshlrev_b32 v63, 10, v11
  v_lshl_or_b32 v34, v55, 3, v63
  v_lshlrev_b32 v60, 16, v18
  v_and_b32 v61, 0xffff0000, v18
  v_lshlrev_b32 v62, 16, v19
  v_and_b32 v63, 0xffff0000, v19
  s_waitcnt lgkmcnt(0)
  v_add_u32 v72, v68, v69
  v_add_u32 v73, v72, v70
  v_add_u32 v74, v73, v71
  v_mov_b32 v75, v74
  v_lshlrev_b32 v64, 16, v12
  v_and_b32 v65, 0xffff0000, v12
  v_add_u32_dpp v75, v75, v75 row_shr:1 row_mask:0xf bank_mask:0xf
  v_lshlrev_b32 v66, 16, v13
  v_mul_f32 v64, v60, v64
  v_add_u32_dpp v75, v75, v75 row_shr:2 row_mask:0xf bank_mask:0xf
  v_mul_f32 v65, v60, v65
  v_mul_f32 v66, v60, v66
  v_add_u32_dpp v75, v75, v75 row_shr:4 row_mask:0xf bank_mask:0xf
  v_cvt_pk_bf16_f32 v20, v60, v64
  v_cvt_pk_bf16_f32 v21, v65, v66
  v_add_u32_dpp v75, v75, v75 row_shr:8 row_mask:0xf bank_mask:0xf
  v_and_b32 v64, 0xffff0000, v13
  v_lshlrev_b32 v65, 16, v14
  v_add_u32_dpp v75, v75, v75 row_bcast:15 row_mask:0xa bank_mask:0xf
  v_and_b32 v66, 0xffff0000, v14
  v_mul_f32 v64, v61, v64
  v_add_u32_dpp v75, v75, v75 row_bcast:31 row_mask:0xc bank_mask:0xf
  v_sub_u32 v76, v75, v74
  v_add_u32 v77, v76, v68
  v_add_u32 v78, v76, v72
  v_add_u32 v79, v76, v73
  ds_write_b128 v43, v[76:79] offset:1024
  ds_read_b32 v80, v48 offset:1024
  ds_read_b32 v81, v49 offset:1024
  ds_read_b32 v82, v50 offset:1024
  ds_read_b32 v83, v51 offset:1024
  v_mul_f32 v65, v61, v65
  v_mul_f32 v66, v61, v66
  v_cvt_pk_bf16_f32 v24, v61, v64
  v_cvt_pk_bf16_f32 v25, v65, v66
  v_lshlrev_b32 v64, 16, v15
  v_and_b32 v65, 0xffff0000, v15
  v_lshlrev_b32 v66, 16, v16
  v_mul_f32 v64, v62, v64
  v_mul_f32 v65, v62, v65
  v_mul_f32 v66, v62, v66
  v_cvt_pk_bf16_f32 v28, v62, v64
  v_cvt_pk_bf16_f32 v29, v65, v66
  v_and_b32 v64, 0xffff0000, v16
  v_lshlrev_b32 v65, 16, v17
  v_and_b32 v66, 0xffff0000, v17
  v_mul_f32 v64, v63, v64
  v_mul_f32 v65, v63, v65
  v_mul_f32 v66, v63, v66
  v_cvt_pk_bf16_f32 v32, v63, v64
  v_cvt_pk_bf16_f32 v33, v65, v66
  s_waitcnt lgkmcnt(0)
  v_add_u32 v60, v80, v56
  v_mad_u32_u24 v60, v60, 12, s41
  v_add_u32 v61, v81, v57
  v_mad_u32_u24 v61, v61, 12, s41
  v_add_u32 v62, v82, v58
  v_mad_u32_u24 v62, v62, 12, s41
  v_add_u32 v63, v83, v59
  v_mad_u32_u24 v63, v63, 12, s41
  ds_write2_b32 v60, v20, v21 offset0:0 offset1:1
  ds_write_b32 v60, v22 offset:8
  ds_write2_b32 v61, v24, v25 offset0:0 offset1:1
  ds_write_b32 v61, v26 offset:8
  ds_write2_b32 v62, v28, v29 offset0:0 offset1:1
  ds_write_b32 v62, v30 offset:8
  ds_write2_b32 v63, v32, v33 offset0:0 offset1:1
  ds_write_b32 v63, v34 offset:8
  v_lshlrev_b32 v2, 4, v0
  s_mul_i32 s15, s2, 15360
  s_add_u32 s42, s15, 5120
  s_add_u32 s43, s15, 10240
  s_waitcnt lgkmcnt(0)
  s_barrier
  ds_read_b128 v[4:7], v2 offset:2048
  ds_read_b128 v[8:11], v2 offset:7168
  ds_read_b128 v[12:15], v2 offset:12288
  s_waitcnt lgkmcnt(2)
  buffer_store_dwordx4 v[4:7], v2, s[32:35], s15 offen sc0 sc1
  s_waitcnt lgkmcnt(1)
  buffer_store_dwordx4 v[8:11], v2, s[32:35], s42 offen sc0 sc1
  s_waitcnt lgkmcnt(0)
  buffer_store_dwordx4 v[12:15], v2, s[32:35], s43 offen sc0 sc1
  s_branch F_JOIN
F_AUX:
  s_cmp_lg_u32 s3, 5
  s_cbranch_scc1 F_IDLE
  s_cmp_ge_u32 s2, 160
  s_cbranch_scc1 F_IDLE
  s_load_dwordx2 s[18:19], s[0:1], 40
  s_load_dwordx4 s[20:23], s[0:1], 48
  v_and_b32 v1, 63, v0
  s_mov_b32 s14, s2
  s_mul_i32 s24, s14, 3277
  s_lshr_b32 s24, s24, 16
  s_mul_i32 s25, s24, 20
  s_sub_u32 s25, s14, s25
  s_lshr_b32 s26, s25, 2
  s_and_b32 s27, s25, 3
  s_waitcnt lgkmcnt(0)
  s_mov_b32 s48, s18
  s_mov_b32 s49, s19
  s_mov_b32 s50, 1280
  s_mov_b32 s51, 0x20000
  s_cmp_eq_u32 s26, 0
  s_cselect_b32 s28, 1, 0
  s_cmp_eq_u32 s26, 3
  s_cselect_b32 s28, 1, s28
  s_cmp_eq_u32 s28, 1
  s_cselect_b32 s52, s20, s22
  s_cselect_b32 s53, s21, s23
  s_mov_b32 s54, 98304
  s_cselect_b32 s54, 65536, s54
  s_mov_b32 s55, 0x20000
  s_lshr_b32 s29, s26, 1
  s_mov_b32 s30, 0
  s_cmp_eq_u32 s26, 1
  s_cselect_b32 s30, 2, s30
  s_cmp_eq_u32 s26, 2
  s_cselect_b32 s30, 3, s30
  s_cmp_eq_u32 s26, 3
  s_cselect_b32 s30, 1, s30
  s_cmp_eq_u32 s26, 4
  s_cselect_b32 s30, 4, s30
  s_add_u32 s56, s12, 4718592
  s_addc_u32 s57, s13, 0
  s_mov_b32 s58, 163840
  s_mov_b32 s59, 0x20000
  v_lshrrev_b32 v2, 4, v1
  v_and_b32 v3, 15, v1
  v_lshlrev_b32 v4, 2, v2
  s_lshl_b32 s31, s27, 5
  v_add_u32 v4, s31, v4
  s_lshl_b32 s31, s30, 8
  v_lshl_add_u32 v5, v4, 1, s31
  s_lshl_b32 s31, s29, 15
  s_lshl_b32 s33, s24, 5
  s_add_u32 s31, s31, s33
  v_lshlrev_b32 v6, 8, v4
  v_lshl_add_u32 v6, v3, 1, v6
  v_add_u32 v6, s31, v6
  v_add_u32 v20, 4096, v6
  buffer_load_dwordx2 v[8:9], v5, s[48:51], 0 offen
  buffer_load_dwordx2 v[10:11], v5, s[48:51], 0 offen offset:32
  buffer_load_ushort v12, v6, s[52:55], 0 offen offset:0
  buffer_load_ushort v13, v6, s[52:55], 0 offen offset:256
  buffer_load_ushort v14, v6, s[52:55], 0 offen offset:512
  buffer_load_ushort v15, v6, s[52:55], 0 offen offset:768
  buffer_load_ushort v16, v20, s[52:55], 0 offen offset:0
  buffer_load_ushort v17, v20, s[52:55], 0 offen offset:256
  buffer_load_ushort v18, v20, s[52:55], 0 offen offset:512
  buffer_load_ushort v19, v20, s[52:55], 0 offen offset:768
  s_barrier
  s_waitcnt vmcnt(0)
  v_lshlrev_b32 v40, 16, v8
  v_and_b32 v41, 0xffff0000, v8
  v_lshlrev_b32 v42, 16, v9
  v_and_b32 v43, 0xffff0000, v9
  v_lshlrev_b32 v44, 16, v10
  v_and_b32 v45, 0xffff0000, v10
  v_lshlrev_b32 v46, 16, v11
  v_and_b32 v47, 0xffff0000, v11
  v_lshlrev_b32 v12, 16, v12
  v_lshlrev_b32 v13, 16, v13
  v_lshlrev_b32 v14, 16, v14
  v_lshlrev_b32 v15, 16, v15
  v_lshlrev_b32 v16, 16, v16
  v_lshlrev_b32 v17, 16, v17
  v_lshlrev_b32 v18, 16, v18
  v_lshlrev_b32 v19, 16, v19
  v_mul_f32 v40, v40, v12
  v_mul_f32 v41, v41, v13
  v_mul_f32 v42, v42, v14
  v_mul_f32 v43, v43, v15
  v_mul_f32 v44, v44, v16
  v_mul_f32 v45, v45, v17
  v_mul_f32 v46, v46, v18
  v_mul_f32 v47, v47, v19
  v_cvt_pk_bf16_f32 v48, v40, v41
  v_cvt_pk_bf16_f32 v49, v42, v43
  v_cvt_pk_bf16_f32 v50, v44, v45
  v_cvt_pk_bf16_f32 v51, v46, v47
  s_lshl_b32 s35, s14, 10
  v_lshlrev_b32 v7, 4, v1
  buffer_store_dwordx4 v[48:51], v7, s[56:59], s35 offen sc0 sc1
  s_barrier
  s_barrier
  s_branch F_JOIN
F_IDLE:
  s_cmp_lg_u32 s3, 7
  s_cbranch_scc1 F_IDLE1
  v_and_b32 v41, 63, v0
  v_mov_b32 v1, 0
  s_cmp_lg_u32 s2, 0
  s_cbranch_scc1 F_T0
  s_memrealtime s[46:47]
  s_waitcnt lgkmcnt(0)
  s_or_b32 s46, s46, 1
  s_and_b32 s45, s47, 31
  s_lshl_b32 s45, s45, 11
  s_lshr_b32 s47, s47, 5
  s_lshl_b32 s47, s47, 27
  s_or_b32 s47, s47, s45
  v_mov_b32 v2, s46
  v_mov_b32 v3, s47
  s_mov_b64 exec, 1
  buffer_store_dwordx2 v[2:3], v1, s[92:95], 0 offen sc0 sc1
  s_mov_b64 exec, -1
F_T0:
  s_waitcnt lgkmcnt(0)
  s_barrier
  s_barrier
  buffer_load_dwordx2 v[66:67], v1, s[92:95], 0 offen sc1
  v_lshlrev_b32 v43, 3, v41
  s_barrier
  ds_read_b64 v[4:5], v43 offset:0
  ds_read_b64 v[6:7], v43 offset:512
  ds_read_b64 v[8:9], v43 offset:1024
  ds_read_b64 v[10:11], v43 offset:1536
F_NOK1B:
  s_mov_b32 s45, 200000
F_NP0:
  s_waitcnt vmcnt(0)
  v_readfirstlane_b32 s88, v66
  v_readfirstlane_b32 s96, v67
  s_cmp_lg_u32 s88, 0
  s_cbranch_scc1 F_NP1
  s_sub_u32 s45, s45, 1
  s_cbranch_scc1 F_NP1
  buffer_load_dwordx2 v[66:67], v1, s[92:95], 0 offen sc1
  s_branch F_NP0
F_NP1:
  v_mov_b32 v2, 28672
  ds_write_b64 v2, v[66:67]
  s_waitcnt lgkmcnt(0)
  v_lshl_or_b32 v12, v4, 16, v8
  v_or_b32 v12, s96, v12
  v_mov_b32 v13, s88
  v_lshl_or_b32 v14, v5, 16, v9
  v_or_b32 v14, s96, v14
  v_mov_b32 v15, s88
  v_lshl_or_b32 v16, v6, 16, v10
  v_or_b32 v16, s96, v16
  v_mov_b32 v17, s88
  v_lshl_or_b32 v18, v7, 16, v11
  v_or_b32 v18, s96, v18
  v_mov_b32 v19, s88
  s_branch F_JOIN
F_NOK1:
  s_waitcnt lgkmcnt(0)
  s_cmp_lg_u32 s3, 7
  s_cbranch_scc1 F_JOIN
  v_mov_b32 v1, 0
  buffer_load_dwordx2 v[66:67], v1, s[92:95], 0 offen sc1
  s_branch F_NOK1B
F_IDLE1:
  s_barrier
  s_barrier
  s_barrier
F_JOIN:
  s_add_u32 s16, s12, 4194304
  s_addc_u32 s17, s13, 0
  s_mov_b32 s18, 524288
  s_mov_b32 s19, 0x20000
  v_and_b32 v41, 63, v0
  v_lshrrev_b32 v44, 1, v41
  v_lshlrev_b32 v44, 13, v44
  v_and_b32 v45, 1, v41
  v_lshl_add_u32 v44, v45, 4, v44
  s_lshr_b32 s14, s2, 2
  s_lshl_b32 s14, s14, 7
  s_and_b32 s15, s2, 3
  s_lshl_b32 s15, s15, 5
  s_add_u32 s14, s14, s15
  s_add_u32 s15, s14, 262144
  s_waitcnt vmcnt(0) lgkmcnt(0)
  s_barrier
  s_cmp_lg_u32 s3, 7
  s_cbranch_scc1 F_SKIP
  s_cmp_ge_u32 s2, 250
  s_cbranch_scc1 F_SKIP
  buffer_store_dwordx4 v[12:15], v44, s[16:19], s14 offen sc0 sc1
  buffer_store_dwordx4 v[16:19], v44, s[16:19], s15 offen sc0 sc1
F_SKIP:
  v_mov_b32 v64, 28672
  ds_read_b64 v[64:65], v64
  s_load_dwordx2 s[30:31], s[0:1], 0
  s_load_dwordx2 s[32:33], s[0:1], 72
  s_load_dwordx2 s[34:35], s[0:1], 88
  s_and_b32 s36, s2, 7
  s_mov_b32 s39, s36
  s_lshr_b32 s37, s2, 3
  s_lshl_b32 s38, s36, 5
  s_mul_i32 s79, s37, 320
  s_add_u32 s2, s38, s37
  v_and_b32 v1, 63, v0
  v_lshrrev_b32 v60, 6, v0
  s_lshr_b32 s29, s2, 2
  s_lshl_b32 s29, s29, 13
  s_and_b32 s37, s2, 3
  s_lshl_b32 s37, s37, 3
  s_add_u32 s29, s29, s37
  s_add_u32 s29, s29, 4194304
  v_readfirstlane_b32 s3, v60
  s_mov_b32 s24, 0
  s_mov_b32 s25, 250
  s_mov_b32 s26, 0
  s_mov_b32 s27, 0
  v_lshrrev_b32 v61, 1, v0
  v_lshrrev_b32 v62, 2, v61
  v_lshlrev_b32 v62, 7, v62
  v_and_b32 v63, 3, v61
  v_lshl_add_u32 v62, v63, 5, v62
  s_waitcnt lgkmcnt(0)
  v_readfirstlane_b32 s88, v64
  v_readfirstlane_b32 s96, v65
  s_mov_b32 s12, s34
  s_mov_b32 s13, s35
  s_mov_b32 s14, 4882432
  s_mov_b32 s15, 0x20000
  s_mov_b32 s4, s30
  s_mov_b32 s5, s31
  s_mov_b32 s6, 10240000
  s_mov_b32 s7, 0x20000
  s_sub_u32 s8, s30, 1024
  s_subb_u32 s9, s31, 0
  s_mov_b32 s10, 10241024
  s_mov_b32 s11, 0x20000
  s_mov_b32 s16, s32
  s_mov_b32 s17, s33
  s_mov_b32 s18, 10240000
  s_mov_b32 s19, 0x20000
  s_mul_i32 s44, s3, 20480
  s_add_u32 s44, s44, 4718592
  s_mul_i32 s23, s3, 18432
  s_add_u32 s23, s23, 10240
  s_mov_b32 s77, 73728
  s_mov_b32 s78, 0xfffffc00
  s_mov_b32 s42, 0x000f000f
  s_mov_b32 s43, 0x000f000f
  v_lshlrev_b32 v10, 4, v1
  v_and_b32 v66, 7, v1
  v_bfe_u32 v67, v1, 4, 1
  v_lshlrev_b32 v68, 2, v67
  v_xor_b32 v68, v68, v66
  v_lshlrev_b32 v9, 4, v68
  v_bfe_u32 v68, v1, 2, 2
  v_and_b32 v69, 3, v1
  v_lshrrev_b32 v70, 4, v1
  v_lshl_add_u32 v71, v70, 3, v68
  v_lshlrev_b32 v71, 7, v71
  v_lshrrev_b32 v72, 1, v69
  v_lshrrev_b32 v73, 1, v68
  v_lshlrev_b32 v73, 2, v73
  v_xor_b32 v72, v72, v73
  v_lshlrev_b32 v73, 1, v67
  v_xor_b32 v72, v72, v73
  v_lshl_add_u32 v71, v72, 4, v71
  v_and_b32 v73, 1, v69
  v_lshl_add_u32 v71, v73, 3, v71
  v_add_u32 v2, s23, v71
  v_xor_b32 v3, 32, v2
  v_xor_b32 v4, 64, v2
  v_xor_b32 v5, 96, v2
  s_mul_i32 s39, s3, 80
  s_add_u32 s39, s39, 22528
  s_mov_b32 s40, 18464
  v_mul_lo_u32 v72, v69, s40
  v_mul_u32_u24 v73, 768, v70
  v_add3_u32 v72, v72, v73, s39
  v_lshl_add_u32 v6, v68, 4, v72
  v_lshrrev_b32 v72, 4, v1
  v_mul_u32_u24 v72, 768, v72
  v_and_b32 v73, 15, v1
  v_lshl_add_u32 v72, v73, 4, v72
  v_add_u32 v7, 22528, v72
  v_add_u32 v8, 59456, v72
  v_mov_b64 v[80:81], 0
  v_mov_b64 v[82:83], 0
  v_mov_b64 v[84:85], 0
  v_mov_b64 v[86:87], 0
  v_mov_b64 v[88:89], 0
  v_mov_b64 v[90:91], 0
  v_mov_b64 v[92:93], 0
  v_mov_b64 v[94:95], 0
  v_mov_b64 v[96:97], 0
  v_mov_b64 v[98:99], 0
  v_mov_b64 v[100:101], 0
  v_mov_b64 v[102:103], 0
  v_mov_b64 v[104:105], 0
  v_mov_b64 v[106:107], 0
  v_mov_b64 v[108:109], 0
  v_mov_b64 v[110:111], 0
  v_mov_b64 v[112:113], 0
  v_mov_b64 v[114:115], 0
  v_mov_b64 v[116:117], 0
  v_mov_b64 v[118:119], 0
  v_mov_b64 v[120:121], 0
  v_mov_b64 v[122:123], 0
  v_mov_b64 v[124:125], 0
  v_mov_b64 v[126:127], 0
K2_ROUND:
  v_mov_b64 v[68:69], 0
  v_mov_b64 v[70:71], 0
  v_mov_b32 v72, 2130706432
  v_mov_b32 v73, 2130706432
  v_mov_b32 v74, 2130706432
  v_mov_b32 v75, 2130706432
  v_add_u32 v76, s23, v10
  ds_write_b128 v76, v[68:71] offset:6144
  ds_write_b128 v76, v[68:71] offset:7168
  ds_write_b128 v76, v[68:71] offset:8192
  ds_write_b128 v76, v[68:71] offset:9216
  ds_write_b128 v76, v[68:71] offset:10240
  ds_write_b128 v76, v[68:71] offset:11264
  ds_write_b128 v76, v[68:71] offset:12288
  ds_write_b128 v76, v[68:71] offset:13312
  ds_write_b128 v76, v[68:71] offset:14336
  ds_write_b128 v76, v[68:71] offset:15360
  ds_write_b128 v76, v[68:71] offset:16384
  ds_write_b128 v76, v[68:71] offset:17408
  s_lshl_b32 s38, s3, 10
  s_add_u32 s38, s38, 0
  v_add_u32 v77, s38, v10
  ds_write_b128 v77, v[72:75]
  s_cmp_lg_u32 s3, 0
  s_cbranch_scc1 K2_I1
  v_add_u32 v77, 8192, v10
  ds_write_b128 v77, v[68:71]
K2_I1:
  v_and_b32 v249, 1, v0
  s_cmp_lg_u32 s27, 0
  s_cbranch_scc1 F_NOPOLL
  s_movk_i32 s45, 250
  v_lshrrev_b32 v61, 1, v0
  v_mul_u32_u24 v255, 15360, v61
  v_mov_b32 v70, 0
  v_mad_u32_u24 v255, v249, 12, v255
  v_cmp_gt_u32 vcc, s45, v61
  s_mov_b32 s45, 200000
  s_and_b64 exec, exec, vcc
  buffer_load_dwordx2 v[70:71], v62, s[12:15], s29 offen sc1
F_POLL:
  s_waitcnt vmcnt(0)
  v_and_b32 v78, 0xf800f800, v70
  v_xor_b32 v79, s88, v71
  v_xor_b32 v78, s96, v78
  v_or_b32 v78, v78, v79
  v_cmp_ne_u32 vcc, 0, v78
  s_cbranch_vccz F_PD0
  s_sub_u32 s45, s45, 1
  s_cbranch_scc1 F_PD0
  buffer_load_dwordx2 v[70:71], v62, s[12:15], s29 offen sc1
  s_branch F_POLL
F_PD0:
F_PDONE:
  s_mov_b64 exec, -1
  v_bfe_u32 v65, v70, 16, 11
  v_and_b32 v67, 0x7ff, v70
  v_sub_u32 v66, v65, v249
  v_mad_u32_u24 v64, v67, 12, v255
F_RECLD:
  v_cmp_lt_i32_e64 s[56:57], 0, v66
  v_cmp_lt_i32_e64 s[58:59], 2, v66
  s_mov_b64 exec, s[56:57]
  buffer_load_dwordx3 v[16:18], v64, s[12:15], 0 offen offset:0
  v_cmp_lt_i32_e64 s[60:61], 4, v66
  s_mov_b64 exec, s[58:59]
  buffer_load_dwordx3 v[20:22], v64, s[12:15], 0 offen offset:24
  v_cmp_lt_i32_e64 s[62:63], 6, v66
  s_mov_b64 exec, s[60:61]
  buffer_load_dwordx3 v[24:26], v64, s[12:15], 0 offen offset:48
  v_cmp_lt_i32_e64 s[64:65], 8, v66
  s_mov_b64 exec, s[62:63]
  buffer_load_dwordx3 v[28:30], v64, s[12:15], 0 offen offset:72
  v_cmp_lt_i32_e64 s[66:67], 10, v66
  s_mov_b64 exec, s[64:65]
  buffer_load_dwordx3 v[32:34], v64, s[12:15], 0 offen offset:96
  v_cmp_lt_i32_e64 s[68:69], 12, v66
  s_mov_b64 exec, s[66:67]
  s_cbranch_execz K2_LD_DONE
  buffer_load_dwordx3 v[36:38], v64, s[12:15], 0 offen offset:120
  v_cmp_lt_i32_e64 s[70:71], 14, v66
  s_mov_b64 exec, s[68:69]
  s_cbranch_execz K2_LD_DONE
  buffer_load_dwordx3 v[40:42], v64, s[12:15], 0 offen offset:144
  v_cmp_lt_i32_e64 s[72:73], 16, v66
  s_mov_b64 exec, s[70:71]
  s_cbranch_execz K2_LD_DONE
  buffer_load_dwordx3 v[44:46], v64, s[12:15], 0 offen offset:168
  v_cmp_lt_i32_e64 s[74:75], 18, v66
  s_mov_b64 exec, s[72:73]
  s_cbranch_execz K2_LD_DONE
  buffer_load_dwordx3 v[48:50], v64, s[12:15], 0 offen offset:192
  s_mov_b64 exec, s[74:75]
  s_cbranch_execz K2_LD_DONE
  buffer_load_dwordx3 v[52:54], v64, s[12:15], 0 offen offset:216
K2_LD_DONE:
  s_mov_b64 exec, -1
  v_mov_b32 v68, 1
  s_waitcnt lgkmcnt(0)
  s_barrier
  s_add_u32 s37, s44, 16384
  s_add_u32 s38, s44, 8192
  s_add_u32 s39, s44, 12288
  buffer_load_dwordx4 v[128:131], v10, s[12:15], s37 offen offset:0
  buffer_load_dwordx4 v[132:135], v10, s[12:15], s37 offen offset:1024
  buffer_load_dwordx4 v[136:139], v10, s[12:15], s38 offen offset:0
  buffer_load_dwordx4 v[140:143], v10, s[12:15], s38 offen offset:1024
  buffer_load_dwordx4 v[144:147], v10, s[12:15], s39 offen offset:0
  buffer_load_dwordx4 v[148:151], v10, s[12:15], s39 offen offset:1024
  buffer_load_dwordx4 v[152:155], v10, s[12:15], s37 offen offset:2048
  buffer_load_dwordx4 v[156:159], v10, s[12:15], s37 offen offset:3072
  buffer_load_dwordx4 v[160:163], v10, s[12:15], s38 offen offset:2048
  buffer_load_dwordx4 v[164:167], v10, s[12:15], s38 offen offset:3072
  buffer_load_dwordx4 v[168:171], v10, s[12:15], s39 offen offset:2048
  buffer_load_dwordx4 v[172:175], v10, s[12:15], s39 offen offset:3072
  v_mov_b32 v69, 8704
  v_cmp_lt_u32 vcc, 20, v65
  s_and_saveexec_b64 s[40:41], vcc
  s_cbranch_execz K2_NOMORE
  ds_write_b32 v69, v68
K2_NOMORE:
  s_mov_b64 exec, s[40:41]
  v_lshrrev_b32 v70, 3, v1
  v_and_b32 v71, 7, v1
  s_mov_b32 s45, 18432
  v_mul_lo_u32 v72, v70, s45
  s_mov_b32 s45, 0x76532104
  v_lshlrev_b32 v71, 2, v71
  v_bfe_u32 v71, s45, v71, 3
  v_lshl_add_u32 v72, v71, 3, v72
  v_add_u32 v72, 16384, v72
  v_lshlrev_b32 v73, 10, v70
  v_lshlrev_b32 v67, 3, v1
  s_lshl_b32 s38, s3, 10
  v_lshl_add_u32 v251, v70, 2, s38
  v_bfe_u32 v71, v1, 2, 2
  v_lshrrev_b32 v70, 4, v1
  v_lshl_add_u32 v71, v70, 3, v71
  v_lshlrev_b32 v71, 6, v71
  v_and_b32 v70, 3, v1
  v_lshl_add_u32 v71, v70, 3, v71
  s_add_u32 s38, s23, 6144
  v_add_u32 v252, s38, v71
  v_xor_b32 v253, 32, v9
  s_mov_b32 s21, 384
  s_mov_b32 s6, 10240000
  s_mov_b32 s10, 10241024
  s_mov_b32 m0, s23
  s_mul_i32 s37, s3, 40
  s_add_u32 s37, s37, s79
  v_add_u32 v14, s37, v1
  v_lshlrev_b32 v14, 10, v14
  s_mov_b32 s37, 384
  s_bfm_b64 s[38:39], 40, 0
  s_waitcnt vmcnt(12)
  s_mov_b64 exec, s[56:57]
  v_and_b32 v56, 0x3f8, v18
  ds_add_rtn_u32 v19, v56, v68 offset:8192
  s_mov_b64 exec, s[58:59]
  v_and_b32 v57, 0x3f8, v22
  ds_add_rtn_u32 v23, v57, v68 offset:8192
  s_mov_b64 exec, s[60:61]
  v_and_b32 v58, 0x3f8, v26
  ds_add_rtn_u32 v27, v58, v68 offset:8192
  s_mov_b64 exec, s[62:63]
  v_and_b32 v59, 0x3f8, v30
  ds_add_rtn_u32 v31, v59, v68 offset:8192
  s_mov_b64 exec, s[64:65]
  v_and_b32 v60, 0x3f8, v34
  ds_add_rtn_u32 v35, v60, v68 offset:8192
  s_mov_b64 exec, s[66:67]
  s_cbranch_execz K2_RK_DONE
  v_and_b32 v61, 0x3f8, v38
  ds_add_rtn_u32 v39, v61, v68 offset:8192
  s_mov_b64 exec, s[68:69]
  s_cbranch_execz K2_RK_DONE
  v_and_b32 v62, 0x3f8, v42
  ds_add_rtn_u32 v43, v62, v68 offset:8192
  s_mov_b64 exec, s[70:71]
  s_cbranch_execz K2_RK_DONE
  v_and_b32 v63, 0x3f8, v46
  ds_add_rtn_u32 v47, v63, v68 offset:8192
  s_mov_b64 exec, s[72:73]
  s_cbranch_execz K2_RK_DONE
  v_and_b32 v64, 0x3f8, v50
  ds_add_rtn_u32 v51, v64, v68 offset:8192
  s_mov_b64 exec, s[74:75]
  s_cbranch_execz K2_RK_DONE
  v_and_b32 v65, 0x3f8, v54
  ds_add_rtn_u32 v55, v65, v68 offset:8192
K2_RK_DONE:
  s_mov_b64 exec, -1
  s_mov_b64 exec, s[38:39]
  buffer_load_dword v11, v14, s[4:7], s37 offen
  s_mov_b64 exec, -1
  s_waitcnt lgkmcnt(0)
  s_barrier
  ds_read_b32 v68, v67 offset:8192
  ds_read_b32 v70, v69
  s_cmp_eq_u32 s27, 0
  s_waitcnt lgkmcnt(0)
  v_readfirstlane_b32 s28, v70
  s_cbranch_scc0 K2_IDENT
  v_med3_u32 v71, v68, 16, 47
  s_cmp_lg_u32 s28, 0
  s_cbranch_scc1 K2_FALLBACK
  v_bfe_i32 v196, v71, 5, 1
  v_bfe_i32 v197, v71, 3, 1
  v_bfe_i32 v198, v71, 2, 1
  v_bfe_i32 v199, v71, 1, 1
  v_bfe_i32 v200, v71, 0, 1
  v_cmp_ne_u32_e64 s[36:37], 0, v196
  v_cmp_ne_u32_e64 s[38:39], 0, v197
  v_cmp_ne_u32_e64 s[40:41], 0, v198
  v_cmp_ne_u32_e64 s[46:47], 0, v199
  v_cmp_ne_u32_e64 s[48:49], 0, v200
  v_bfi_b32 v201, v196, 0, s36
  v_bfi_b32 v202, v196, 0, s37
  v_xnor_b32 v203, s36, v196
  v_xnor_b32 v204, s37, v196
  v_bfi_b32 v205, v197, 0, s38
  v_bfi_b32 v206, v197, 0, s39
  v_and_or_b32 v201, v203, v205, v201
  v_and_or_b32 v202, v204, v206, v202
  v_bitop3_b32 v203, v203, s38, v197 bitop3:0x90
  v_bitop3_b32 v204, v204, s39, v197 bitop3:0x90
  v_bfi_b32 v205, v198, 0, s40
  v_bfi_b32 v206, v198, 0, s41
  v_and_or_b32 v201, v203, v205, v201
  v_and_or_b32 v202, v204, v206, v202
  v_bitop3_b32 v203, v203, s40, v198 bitop3:0x90
  v_bitop3_b32 v204, v204, s41, v198 bitop3:0x90
  v_bfi_b32 v205, v199, 0, s46
  v_bfi_b32 v206, v199, 0, s47
  v_and_or_b32 v201, v203, v205, v201
  v_and_or_b32 v202, v204, v206, v202
  v_bitop3_b32 v203, v203, s46, v199 bitop3:0x90
  v_bitop3_b32 v204, v204, s47, v199 bitop3:0x90
  v_bfi_b32 v205, v200, 0, s48
  v_bfi_b32 v206, v200, 0, s49
  v_and_or_b32 v201, v203, v205, v201
  v_and_or_b32 v202, v204, v206, v202
  v_bitop3_b32 v203, v203, s48, v200 bitop3:0x90
  v_bitop3_b32 v204, v204, s49, v200 bitop3:0x90
  v_bcnt_u32_b32 v71, v201, 0
  v_bcnt_u32_b32 v71, v202, v71
  v_mbcnt_lo_u32_b32 v71, v203, v71
  v_mbcnt_hi_u32_b32 v71, v204, v71
  v_bfe_i32 v74, v71, 3, 1
  v_xor_b32 v74, v71, v74
  v_and_b32 v74, 7, v74
  v_lshrrev_b32 v71, 1, v71
  v_and_b32 v71, 0x1c, v71
  s_mov_b32 s45, 0x76501234
  v_bfe_u32 v71, s45, v71, 3
  v_lshl_add_u32 v71, v74, 3, v71
K2_PERM:
  v_lshlrev_b32 v71, 2, v71
  v_lshl_or_b32 v74, v1, 16, v68
  ds_permute_b32 v75, v71, v74
  s_lshl_b32 s46, s3, 3
  s_add_u32 s47, s46, 7
  s_mov_b32 s45, 192
  s_waitcnt lgkmcnt(0)
  v_and_b32 v76, 0xffff, v75
  v_lshrrev_b32 v254, 16, v75
  v_mov_b32 v77, v76
  v_lshlrev_b32 v74, 3, v254
  v_readlane_b32 s80, v76, s46
  v_add_u32_dpp v77, v77, v77 row_shr:1 row_mask:0xf bank_mask:0xf
  s_nop 1
  v_add_u32_dpp v77, v77, v77 row_shr:2 row_mask:0xf bank_mask:0xf
  s_nop 1
  v_add_u32_dpp v77, v77, v77 row_shr:4 row_mask:0xf bank_mask:0xa
  s_cmp_eq_u32 s27, 0
  v_sub_u32 v78, v77, v76
  v_cmp_lt_u32 vcc, s45, v77
  v_lshl_add_u32 v72, v78, 6, v72
  v_lshl_add_u32 v73, v78, 2, v73
  ds_write_b64 v74, v[72:73] offset:9216
  v_readlane_b32 s20, v77, s47
  s_cbranch_scc0 K2_GO
  s_cmp_lg_u64 vcc, 0
  s_cbranch_scc1 K2_FALLBACK
K2_GO:
  s_mov_b64 exec, s[56:57]
  ds_read_b64 v[176:177], v56 offset:9216
  s_mov_b64 exec, s[58:59]
  ds_read_b64 v[178:179], v57 offset:9216
  s_mov_b64 exec, s[60:61]
  ds_read_b64 v[180:181], v58 offset:9216
  s_mov_b64 exec, s[62:63]
  ds_read_b64 v[182:183], v59 offset:9216
  s_mov_b64 exec, s[64:65]
  ds_read_b64 v[184:185], v60 offset:9216
  s_mov_b64 exec, s[66:67]
  s_cbranch_execz K2_OF_DONE
  ds_read_b64 v[186:187], v61 offset:9216
  s_mov_b64 exec, s[68:69]
  s_cbranch_execz K2_OF_DONE
  ds_read_b64 v[188:189], v62 offset:9216
  s_mov_b64 exec, s[70:71]
  s_cbranch_execz K2_OF_DONE
  ds_read_b64 v[190:191], v63 offset:9216
  s_mov_b64 exec, s[72:73]
  s_cbranch_execz K2_OF_DONE
  ds_read_b64 v[192:193], v64 offset:9216
  s_mov_b64 exec, s[74:75]
  s_cbranch_execz K2_OF_DONE
  ds_read_b64 v[194:195], v65 offset:9216
K2_OF_DONE:
  s_mov_b64 exec, -1
  s_waitcnt lgkmcnt(0)
  s_mov_b64 exec, s[56:57]
  v_lshl_add_u32 v176, v19, 6, v176
  v_lshl_add_u32 v177, v19, 2, v177
  ds_write_b64 v176, v[16:17]
  ds_write_b32 v177, v18
  s_mov_b64 exec, s[58:59]
  v_lshl_add_u32 v178, v23, 6, v178
  v_lshl_add_u32 v179, v23, 2, v179
  ds_write_b64 v178, v[20:21]
  ds_write_b32 v179, v22
  s_mov_b64 exec, s[60:61]
  v_lshl_add_u32 v180, v27, 6, v180
  v_lshl_add_u32 v181, v27, 2, v181
  ds_write_b64 v180, v[24:25]
  ds_write_b32 v181, v26
  s_mov_b64 exec, s[62:63]
  v_lshl_add_u32 v182, v31, 6, v182
  v_lshl_add_u32 v183, v31, 2, v183
  ds_write_b64 v182, v[28:29]
  ds_write_b32 v183, v30
  s_mov_b64 exec, s[64:65]
  v_lshl_add_u32 v184, v35, 6, v184
  v_lshl_add_u32 v185, v35, 2, v185
  ds_write_b64 v184, v[32:33]
  ds_write_b32 v185, v34
  s_mov_b64 exec, s[66:67]
  s_cbranch_execz K2_SC_DONE
  v_lshl_add_u32 v186, v39, 6, v186
  v_lshl_add_u32 v187, v39, 2, v187
  ds_write_b64 v186, v[36:37]
  ds_write_b32 v187, v38
  s_mov_b64 exec, s[68:69]
  s_cbranch_execz K2_SC_DONE
  v_lshl_add_u32 v188, v43, 6, v188
  v_lshl_add_u32 v189, v43, 2, v189
  ds_write_b64 v188, v[40:41]
  ds_write_b32 v189, v42
  s_mov_b64 exec, s[70:71]
  s_cbranch_execz K2_SC_DONE
  v_lshl_add_u32 v190, v47, 6, v190
  v_lshl_add_u32 v191, v47, 2, v191
  ds_write_b64 v190, v[44:45]
  ds_write_b32 v191, v46
  s_mov_b64 exec, s[72:73]
  s_cbranch_execz K2_SC_DONE
  v_lshl_add_u32 v192, v51, 6, v192
  v_lshl_add_u32 v193, v51, 2, v193
  ds_write_b64 v192, v[48:49]
  ds_write_b32 v193, v50
  s_mov_b64 exec, s[74:75]
  s_cbranch_execz K2_SC_DONE
  v_lshl_add_u32 v194, v55, 6, v194
  v_lshl_add_u32 v195, v55, 2, v195
  ds_write_b64 v194, v[52:53]
  ds_write_b32 v195, v54
K2_SC_DONE:
  s_mov_b64 exec, -1
  s_waitcnt lgkmcnt(0)
  s_barrier
  ds_read2_b32 v[16:17], v251 offset0:0 offset1:8
  ds_read2_b32 v[18:19], v251 offset0:16 offset1:24
  ds_read2_b32 v[20:21], v251 offset0:32 offset1:40
  ds_read2_b32 v[22:23], v251 offset0:48 offset1:56
  ds_read2_b32 v[224:225], v251 offset0:64 offset1:72
  ds_read2_b32 v[226:227], v251 offset0:80 offset1:88
  ds_read2_b32 v[228:229], v251 offset0:96 offset1:104
  ds_read2_b32 v[230:231], v251 offset0:112 offset1:120
  ds_read2_b32 v[232:233], v251 offset0:128 offset1:136
  ds_read2_b32 v[234:235], v251 offset0:144 offset1:152
  ds_read2_b32 v[236:237], v251 offset0:160 offset1:168
  ds_read2_b32 v[238:239], v251 offset0:176 offset1:184
  s_waitcnt lgkmcnt(8)
  v_and_or_b32 v16, v16, s78, v9
  v_and_or_b32 v17, v17, s78, v253
  buffer_load_dwordx4 v16, s[4:7], s21 offen lds
  buffer_load_dwordx4 v17, s[8:11], s21 offen offset:1024 lds
  v_and_or_b32 v18, v18, s78, v9
  v_and_or_b32 v19, v19, s78, v253
  s_add_u32 m0, s23, 2048
  s_nop 0
  buffer_load_dwordx4 v18, s[4:7], s21 offen lds
  buffer_load_dwordx4 v19, s[8:11], s21 offen offset:1024 lds
  v_and_or_b32 v20, v20, s78, v9
  v_and_or_b32 v21, v21, s78, v253
  s_add_u32 m0, s23, 4096
  s_nop 0
  buffer_load_dwordx4 v20, s[4:7], s21 offen lds
  buffer_load_dwordx4 v21, s[8:11], s21 offen offset:1024 lds
  v_and_or_b32 v22, v22, s78, v9
  v_and_or_b32 v23, v23, s78, v253
  s_add_u32 m0, s23, 6144
  s_waitcnt lgkmcnt(0)
  ds_read_b64_tr_b16 v[200:201], v252 offset:32
  ds_read_b64_tr_b16 v[202:203], v252 offset:288
  ds_read_b64_tr_b16 v[176:177], v252 offset:0
  ds_read_b64_tr_b16 v[178:179], v252 offset:256
  ds_read_b64_tr_b16 v[180:181], v252 offset:2048
  ds_read_b64_tr_b16 v[182:183], v252 offset:2304
  ds_read_b64_tr_b16 v[184:185], v252 offset:4096
  ds_read_b64_tr_b16 v[186:187], v252 offset:4352
  ds_read_b64_tr_b16 v[188:189], v252 offset:6144
  ds_read_b64_tr_b16 v[190:191], v252 offset:6400
  ds_read_b64_tr_b16 v[192:193], v252 offset:8192
  ds_read_b64_tr_b16 v[194:195], v252 offset:8448
  ds_read_b64_tr_b16 v[196:197], v252 offset:10240
  ds_read_b64_tr_b16 v[198:199], v252 offset:10496
  v_and_or_b32 v224, v224, s78, v9
  v_and_or_b32 v225, v225, s78, v253
  v_and_or_b32 v226, v226, s78, v9
  v_and_or_b32 v227, v227, s78, v253
  v_and_or_b32 v228, v228, s78, v9
  v_and_or_b32 v229, v229, s78, v253
  v_and_or_b32 v230, v230, s78, v9
  v_and_or_b32 v231, v231, s78, v253
  v_and_or_b32 v232, v232, s78, v9
  v_and_or_b32 v233, v233, s78, v253
  v_and_or_b32 v234, v234, s78, v9
  v_and_or_b32 v235, v235, s78, v253
  v_and_or_b32 v236, v236, s78, v9
  v_and_or_b32 v237, v237, s78, v253
  v_and_or_b32 v238, v238, s78, v9
  v_and_or_b32 v239, v239, s78, v253
  s_cmp_gt_u32 s80, 32
  s_cbranch_scc1 K2_VG
  s_cmp_gt_u32 s20, 160
  s_cbranch_scc1 K2_V6
K2_V5:
  v_mov_b32 v236, v16
  v_mov_b32 v237, v17
  v_mov_b32 v238, v18
  v_mov_b32 v239, v19
  v_mov_b32 v240, v20
  v_mov_b32 v241, v21
  v_mov_b32 v242, v22
  v_mov_b32 v243, v23
  s_waitcnt lgkmcnt(0)
  buffer_load_dwordx4 v22, s[4:7], s21 offen lds
  buffer_load_dwordx4 v23, s[8:11], s21 offen offset:1024 lds
  s_add_u32 m0, s23, 8192
  s_lshl_b32 s46, s3, 3
  v_readlane_b32 s72, v254, s46
  s_add_u32 s46, s46, 1
  v_readlane_b32 s73, v254, s46
  s_add_u32 s46, s46, 1
  v_readlane_b32 s74, v254, s46
  s_add_u32 s46, s46, 1
  v_readlane_b32 s75, v254, s46
  s_add_u32 s46, s46, 1
  v_readlane_b32 s76, v254, s46
  s_mul_i32 s46, s2, 625
  s_add_u32 s45, s46, 15
  s_lshr_b32 s45, s45, 4
  s_add_u32 s46, s46, 640
  s_lshr_b32 s46, s46, 4
  s_sub_u32 s46, s46, s45
  s_mov_b32 s81, 0
  s_cmp_lt_u32 s72, s46
  s_cselect_b32 s47, 1, 0
  s_or_b32 s81, s81, s47
  s_cmp_lt_u32 s73, s46
  s_cselect_b32 s47, 2, 0
  s_or_b32 s81, s81, s47
  s_cmp_lt_u32 s74, s46
  s_cselect_b32 s47, 4, 0
  s_or_b32 s81, s81, s47
  s_cmp_lt_u32 s75, s46
  s_cselect_b32 s47, 8, 0
  s_or_b32 s81, s81, s47
  s_cmp_lt_u32 s76, s46
  s_cselect_b32 s47, 16, 0
  s_or_b32 s81, s81, s47
  s_add_u32 s72, s72, s45
  s_lshl_b32 s72, s72, 10
  s_add_u32 s73, s73, s45
  s_lshl_b32 s73, s73, 10
  s_add_u32 s74, s74, s45
  s_lshl_b32 s74, s74, 10
  s_add_u32 s75, s75, s45
  s_lshl_b32 s75, s75, 10
  s_add_u32 s76, s76, s45
  s_lshl_b32 s76, s76, 10
  s_waitcnt vmcnt(4) lgkmcnt(0)
  buffer_load_dwordx4 v224, s[4:7], s21 offen lds
  buffer_load_dwordx4 v225, s[8:11], s21 offen offset:1024 lds
  ds_read_b64_tr_b16 v[16:17], v2 offset:0
  ds_read_b64_tr_b16 v[18:19], v2 offset:512
  ds_read_b64_tr_b16 v[20:21], v3 offset:0
  ds_read_b64_tr_b16 v[22:23], v3 offset:512
  s_add_u32 m0, s23, 10240
  s_waitcnt lgkmcnt(0)
  buffer_load_dwordx4 v226, s[4:7], s21 offen lds
  buffer_load_dwordx4 v227, s[8:11], s21 offen offset:1024 lds
  ds_read_b64_tr_b16 v[24:25], v4 offset:0
  ds_read_b64_tr_b16 v[26:27], v4 offset:512
  ds_read_b64_tr_b16 v[28:29], v5 offset:0
  ds_read_b64_tr_b16 v[30:31], v5 offset:512
  v_mfma_f32_16x16x32_bf16 v[48:51], v[16:19], v[176:179], 0
  v_mfma_f32_16x16x32_bf16 v[52:55], v[20:23], v[176:179], 0
  v_mfma_f32_16x16x32_bf16 v[64:67], v[16:19], v[200:203], 0
  v_mfma_f32_16x16x32_bf16 v[68:71], v[20:23], v[200:203], 0
  s_add_u32 m0, s23, 0
  s_waitcnt vmcnt(4) lgkmcnt(0)
  buffer_load_dwordx4 v228, s[4:7], s21 offen lds
  buffer_load_dwordx4 v229, s[8:11], s21 offen offset:1024 lds
  ds_read_b64_tr_b16 v[16:17], v2 offset:4096
  ds_read_b64_tr_b16 v[18:19], v2 offset:4608
  ds_read_b64_tr_b16 v[20:21], v3 offset:4096
  ds_read_b64_tr_b16 v[22:23], v3 offset:4608
  v_mfma_f32_16x16x32_bf16 v[56:59], v[24:27], v[176:179], 0
  v_mfma_f32_16x16x32_bf16 v[60:63], v[28:31], v[176:179], 0
  v_mfma_f32_16x16x32_bf16 v[72:75], v[24:27], v[200:203], 0
  v_mfma_f32_16x16x32_bf16 v[76:79], v[28:31], v[200:203], 0
  s_add_u32 m0, s23, 2048
  s_waitcnt lgkmcnt(0)
  s_barrier
  buffer_load_dwordx4 v230, s[4:7], s21 offen lds
  buffer_load_dwordx4 v231, s[8:11], s21 offen offset:1024 lds
  ds_read_b64_tr_b16 v[24:25], v4 offset:4096
  ds_read_b64_tr_b16 v[26:27], v4 offset:4608
  ds_read_b64_tr_b16 v[28:29], v5 offset:4096
  ds_read_b64_tr_b16 v[30:31], v5 offset:4608
  v_mfma_f32_16x16x32_bf16 v[48:51], v[16:19], v[180:183], v[48:51]
  v_mfma_f32_16x16x32_bf16 v[52:55], v[20:23], v[180:183], v[52:55]
  s_add_u32 m0, s23, 4096
  s_waitcnt vmcnt(4) lgkmcnt(0)
  buffer_load_dwordx4 v232, s[4:7], s21 offen lds
  buffer_load_dwordx4 v233, s[8:11], s21 offen offset:1024 lds
  ds_read_b64_tr_b16 v[16:17], v2 offset:8192
  ds_read_b64_tr_b16 v[18:19], v2 offset:8704
  ds_read_b64_tr_b16 v[20:21], v3 offset:8192
  ds_read_b64_tr_b16 v[22:23], v3 offset:8704
  v_mfma_f32_16x16x32_bf16 v[56:59], v[24:27], v[180:183], v[56:59]
  v_mfma_f32_16x16x32_bf16 v[60:63], v[28:31], v[180:183], v[60:63]
  s_add_u32 m0, s23, 6144
  s_waitcnt lgkmcnt(0)
  buffer_load_dwordx4 v234, s[4:7], s21 offen lds
  buffer_load_dwordx4 v235, s[8:11], s21 offen offset:1024 lds
  ds_read_b64_tr_b16 v[24:25], v4 offset:8192
  ds_read_b64_tr_b16 v[26:27], v4 offset:8704
  ds_read_b64_tr_b16 v[28:29], v5 offset:8192
  ds_read_b64_tr_b16 v[30:31], v5 offset:8704
  v_mfma_f32_16x16x32_bf16 v[48:51], v[16:19], v[184:187], v[48:51]
  v_mfma_f32_16x16x32_bf16 v[52:55], v[20:23], v[184:187], v[52:55]
  s_add_u32 m0, s23, 8192
  s_waitcnt vmcnt(4) lgkmcnt(0)
  s_mov_b32 s21, 256
  buffer_load_dwordx4 v236, s[4:7], s21 offen lds
  buffer_load_dwordx4 v237, s[8:11], s21 offen offset:1024 lds
  ds_read_b64_tr_b16 v[16:17], v2 offset:0
  ds_read_b64_tr_b16 v[18:19], v2 offset:512
  ds_read_b64_tr_b16 v[20:21], v3 offset:0
  ds_read_b64_tr_b16 v[22:23], v3 offset:512
  v_mfma_f32_16x16x32_bf16 v[56:59], v[24:27], v[184:187], v[56:59]
  v_mfma_f32_16x16x32_bf16 v[60:63], v[28:31], v[184:187], v[60:63]
  s_add_u32 m0, s23, 10240
  s_waitcnt lgkmcnt(0)
  buffer_load_dwordx4 v238, s[4:7], s21 offen lds
  buffer_load_dwordx4 v239, s[8:11], s21 offen offset:1024 lds
  ds_read_b64_tr_b16 v[24:25], v4 offset:0
  ds_read_b64_tr_b16 v[26:27], v4 offset:512
  ds_read_b64_tr_b16 v[28:29], v5 offset:0
  ds_read_b64_tr_b16 v[30:31], v5 offset:512
  v_mfma_f32_16x16x32_bf16 v[48:51], v[16:19], v[188:191], v[48:51]
  v_mfma_f32_16x16x32_bf16 v[52:55], v[20:23], v[188:191], v[52:55]
  s_add_u32 m0, s23, 0
  s_waitcnt vmcnt(4) lgkmcnt(0)
  buffer_load_dwordx4 v240, s[4:7], s21 offen lds
  buffer_load_dwordx4 v241, s[8:11], s21 offen offset:1024 lds
  ds_read_b64_tr_b16 v[16:17], v2 offset:4096
  ds_read_b64_tr_b16 v[18:19], v2 offset:4608
  ds_read_b64_tr_b16 v[20:21], v3 offset:4096
  ds_read_b64_tr_b16 v[22:23], v3 offset:4608
  v_mfma_f32_16x16x32_bf16 v[56:59], v[24:27], v[188:191], v[56:59]
  v_mfma_f32_16x16x32_bf16 v[60:63], v[28:31], v[188:191], v[60:63]
  s_add_u32 m0, s23, 2048
  s_waitcnt lgkmcnt(0)
  buffer_load_dwordx4 v242, s[4:7], s21 offen lds
  buffer_load_dwordx4 v243, s[8:11], s21 offen offset:1024 lds
  ds_read_b64_tr_b16 v[24:25], v4 offset:4096
  ds_read_b64_tr_b16 v[26:27], v4 offset:4608
  ds_read_b64_tr_b16 v[28:29], v5 offset:4096
  ds_read_b64_tr_b16 v[30:31], v5 offset:4608
  v_mfma_f32_16x16x32_bf16 v[48:51], v[16:19], v[192:195], v[48:51]
  v_mfma_f32_16x16x32_bf16 v[52:55], v[20:23], v[192:195], v[52:55]
  s_add_u32 m0, s23, 4096
  s_waitcnt lgkmcnt(0)
  v_mfma_f32_16x16x32_bf16 v[56:59], v[24:27], v[192:195], v[56:59]
  v_mfma_f32_16x16x32_bf16 v[60:63], v[28:31], v[192:195], v[60:63]
  s_waitcnt vmcnt(4) lgkmcnt(0)
  buffer_load_dwordx4 v224, s[4:7], s21 offen lds
  buffer_load_dwordx4 v225, s[8:11], s21 offen offset:1024 lds
  ds_read_b64_tr_b16 v[16:17], v2 offset:8192
  ds_read_b64_tr_b16 v[18:19], v2 offset:8704
  ds_read_b64_tr_b16 v[20:21], v3 offset:8192
  ds_read_b64_tr_b16 v[22:23], v3 offset:8704
  s_add_u32 m0, s23, 6144
  s_nop 0
  v_cvt_pk_bf16_f32 v32, v48, v49
  v_cvt_pk_bf16_f32 v33, v50, v51
  v_cvt_pk_bf16_f32 v34, v52, v53
  v_cvt_pk_bf16_f32 v35, v54, v55
  v_cvt_pk_bf16_f32 v36, v56, v57
  v_cvt_pk_bf16_f32 v37, v58, v59
  v_cvt_pk_bf16_f32 v38, v60, v61
  v_cvt_pk_bf16_f32 v39, v62, v63
  v_cvt_pk_bf16_f32 v40, v64, v65
  v_cvt_pk_bf16_f32 v41, v66, v67
  v_cvt_pk_bf16_f32 v42, v68, v69
  v_cvt_pk_bf16_f32 v43, v70, v71
  v_cvt_pk_bf16_f32 v44, v72, v73
  v_cvt_pk_bf16_f32 v45, v74, v75
  v_cvt_pk_bf16_f32 v46, v76, v77
  v_cvt_pk_bf16_f32 v47, v78, v79
  ds_write_b128 v6, v[32:35] offset:16
  ds_write_b128 v6, v[36:39] offset:3088
  s_mov_b64 exec, s[42:43]
  ds_write_b128 v6, v[40:43] offset:0
  ds_write_b128 v6, v[44:47] offset:3072
  s_mov_b64 exec, -1
  v_add_u32 v6, s77, v6
  s_waitcnt lgkmcnt(0)
  buffer_load_dwordx4 v226, s[4:7], s21 offen lds
  buffer_load_dwordx4 v227, s[8:11], s21 offen offset:1024 lds
  ds_read_b64_tr_b16 v[24:25], v4 offset:8192
  ds_read_b64_tr_b16 v[26:27], v4 offset:8704
  ds_read_b64_tr_b16 v[28:29], v5 offset:8192
  ds_read_b64_tr_b16 v[30:31], v5 offset:8704
  v_mfma_f32_16x16x32_bf16 v[48:51], v[16:19], v[176:179], 0
  v_mfma_f32_16x16x32_bf16 v[52:55], v[20:23], v[176:179], 0
  v_mfma_f32_16x16x32_bf16 v[64:67], v[16:19], v[200:203], 0
  v_mfma_f32_16x16x32_bf16 v[68:71], v[20:23], v[200:203], 0
  s_add_u32 m0, s23, 8192
  s_waitcnt vmcnt(4) lgkmcnt(0)
  buffer_load_dwordx4 v228, s[4:7], s21 offen lds
  buffer_load_dwordx4 v229, s[8:11], s21 offen offset:1024 lds
  ds_read_b64_tr_b16 v[16:17], v2 offset:0
  ds_read_b64_tr_b16 v[18:19], v2 offset:512
  ds_read_b64_tr_b16 v[20:21], v3 offset:0
  ds_read_b64_tr_b16 v[22:23], v3 offset:512
  v_mfma_f32_16x16x32_bf16 v[56:59], v[24:27], v[176:179], 0
  v_mfma_f32_16x16x32_bf16 v[60:63], v[28:31], v[176:179], 0
  v_mfma_f32_16x16x32_bf16 v[72:75], v[24:27], v[200:203], 0
  v_mfma_f32_16x16x32_bf16 v[76:79], v[28:31], v[200:203], 0
  s_add_u32 m0, s23, 10240
  s_waitcnt lgkmcnt(0)
  s_barrier
  buffer_load_dwordx4 v230, s[4:7], s21 offen lds
  buffer_load_dwordx4 v231, s[8:11], s21 offen offset:1024 lds
  ds_read_b64_tr_b16 v[24:25], v4 offset:0
  ds_read_b64_tr_b16 v[26:27], v4 offset:512
  ds_read_b64_tr_b16 v[28:29], v5 offset:0
  ds_read_b64_tr_b16 v[30:31], v5 offset:512
  ds_read_b128 v[32:35], v8 offset:18464
  ds_read_b128 v[36:39], v8 offset:18720
  ds_read_b128 v[40:43], v8 offset:18976
  ds_read_b128 v[44:47], v8 offset:21536
  v_mfma_f32_16x16x32_bf16 v[48:51], v[16:19], v[180:183], v[48:51]
  v_mfma_f32_16x16x32_bf16 v[52:55], v[20:23], v[180:183], v[52:55]
  s_add_u32 m0, s23, 0
  s_waitcnt vmcnt(4) lgkmcnt(0)
  buffer_load_dwordx4 v232, s[4:7], s21 offen lds
  buffer_load_dwordx4 v233, s[8:11], s21 offen offset:1024 lds
  ds_read_b64_tr_b16 v[16:17], v2 offset:4096
  ds_read_b64_tr_b16 v[18:19], v2 offset:4608
  ds_read_b64_tr_b16 v[20:21], v3 offset:4096
  ds_read_b64_tr_b16 v[22:23], v3 offset:4608
  v_mfma_f32_16x16x32_bf16 v[104:107], v[152:155], v[32:35], v[104:107]
  v_mfma_f32_16x16x32_bf16 v[108:111], v[152:155], v[36:39], v[108:111]
  v_mfma_f32_16x16x32_bf16 v[112:115], v[152:155], v[40:43], v[112:115]
  v_mfma_f32_16x16x32_bf16 v[104:107], v[156:159], v[44:47], v[104:107]
  ds_read_b128 v[32:35], v8 offset:21792
  ds_read_b128 v[36:39], v8 offset:22048
  ds_read_b128 v[40:43], v7 offset:0
  ds_read_b128 v[44:47], v7 offset:256
  v_mfma_f32_16x16x32_bf16 v[56:59], v[24:27], v[180:183], v[56:59]
  v_mfma_f32_16x16x32_bf16 v[60:63], v[28:31], v[180:183], v[60:63]
  s_add_u32 m0, s23, 2048
  s_waitcnt lgkmcnt(0)
  buffer_load_dwordx4 v234, s[4:7], s21 offen lds
  buffer_load_dwordx4 v235, s[8:11], s21 offen offset:1024 lds
  ds_read_b64_tr_b16 v[24:25], v4 offset:4096
  ds_read_b64_tr_b16 v[26:27], v4 offset:4608
  ds_read_b64_tr_b16 v[28:29], v5 offset:4096
  ds_read_b64_tr_b16 v[30:31], v5 offset:4608
  v_mfma_f32_16x16x32_bf16 v[108:111], v[156:159], v[32:35], v[108:111]
  v_mfma_f32_16x16x32_bf16 v[112:115], v[156:159], v[36:39], v[112:115]
  v_mfma_f32_16x16x32_bf16 v[92:95], v[160:163], v[40:43], v[92:95]
  v_mfma_f32_16x16x32_bf16 v[96:99], v[160:163], v[44:47], v[96:99]
  ds_read_b128 v[32:35], v7 offset:512
  ds_read_b128 v[36:39], v7 offset:3072
  ds_read_b128 v[40:43], v7 offset:3328
  ds_read_b128 v[44:47], v7 offset:3584
  v_mfma_f32_16x16x32_bf16 v[48:51], v[16:19], v[184:187], v[48:51]
  v_mfma_f32_16x16x32_bf16 v[52:55], v[20:23], v[184:187], v[52:55]
  s_add_u32 m0, s23, 4096
  s_waitcnt vmcnt(4) lgkmcnt(0)
  s_mov_b32 s21, 512
  buffer_load_dwordx4 v236, s[4:7], s21 offen lds
  buffer_load_dwordx4 v237, s[8:11], s21 offen offset:1024 lds
  ds_read_b64_tr_b16 v[16:17], v2 offset:8192
  ds_read_b64_tr_b16 v[18:19], v2 offset:8704
  ds_read_b64_tr_b16 v[20:21], v3 offset:8192
  ds_read_b64_tr_b16 v[22:23], v3 offset:8704
  v_mfma_f32_16x16x32_bf16 v[100:103], v[160:163], v[32:35], v[100:103]
  v_mfma_f32_16x16x32_bf16 v[92:95], v[164:167], v[36:39], v[92:95]
  v_mfma_f32_16x16x32_bf16 v[96:99], v[164:167], v[40:43], v[96:99]
  v_mfma_f32_16x16x32_bf16 v[100:103], v[164:167], v[44:47], v[100:103]
  ds_read_b128 v[32:35], v7 offset:18464
  ds_read_b128 v[36:39], v7 offset:18720
  ds_read_b128 v[40:43], v7 offset:18976
  ds_read_b128 v[44:47], v7 offset:21536
  v_mfma_f32_16x16x32_bf16 v[56:59], v[24:27], v[184:187], v[56:59]
  v_mfma_f32_16x16x32_bf16 v[60:63], v[28:31], v[184:187], v[60:63]
  v_xor_b32 v152, 0x80008000, v152
  v_xor_b32 v153, 0x80008000, v153
  v_xor_b32 v154, 0x80008000, v154
  v_xor_b32 v155, 0x80008000, v155
  v_xor_b32 v156, 0x80008000, v156
  v_xor_b32 v157, 0x80008000, v157
  v_xor_b32 v158, 0x80008000, v158
  v_xor_b32 v159, 0x80008000, v159
  s_add_u32 m0, s23, 6144
  s_waitcnt lgkmcnt(0)
  buffer_load_dwordx4 v238, s[4:7], s21 offen lds
  buffer_load_dwordx4 v239, s[8:11], s21 offen offset:1024 lds
  ds_read_b64_tr_b16 v[24:25], v4 offset:8192
  ds_read_b64_tr_b16 v[26:27], v4 offset:8704
  ds_read_b64_tr_b16 v[28:29], v5 offset:8192
  ds_read_b64_tr_b16 v[30:31], v5 offset:8704
  v_mfma_f32_16x16x32_bf16 v[80:83], v[168:171], v[32:35], v[80:83]
  v_mfma_f32_16x16x32_bf16 v[84:87], v[168:171], v[36:39], v[84:87]
  v_mfma_f32_16x16x32_bf16 v[88:91], v[168:171], v[40:43], v[88:91]
  v_mfma_f32_16x16x32_bf16 v[80:83], v[172:175], v[44:47], v[80:83]
  ds_read_b128 v[32:35], v7 offset:21792
  ds_read_b128 v[36:39], v7 offset:22048
  ds_read_b128 v[40:43], v8 offset:0
  ds_read_b128 v[44:47], v8 offset:256
  v_mfma_f32_16x16x32_bf16 v[48:51], v[16:19], v[188:191], v[48:51]
  v_mfma_f32_16x16x32_bf16 v[52:55], v[20:23], v[188:191], v[52:55]
  s_add_u32 m0, s23, 8192
  s_waitcnt vmcnt(4) lgkmcnt(0)
  buffer_load_dwordx4 v240, s[4:7], s21 offen lds
  buffer_load_dwordx4 v241, s[8:11], s21 offen offset:1024 lds
  ds_read_b64_tr_b16 v[16:17], v2 offset:0
  ds_read_b64_tr_b16 v[18:19], v2 offset:512
  ds_read_b64_tr_b16 v[20:21], v3 offset:0
  ds_read_b64_tr_b16 v[22:23], v3 offset:512
  v_mfma_f32_16x16x32_bf16 v[84:87], v[172:175], v[32:35], v[84:87]
  v_mfma_f32_16x16x32_bf16 v[88:91], v[172:175], v[36:39], v[88:91]
  v_mfma_f32_16x16x32_bf16 v[116:119], v[152:155], v[40:43], v[116:119]
  v_mfma_f32_16x16x32_bf16 v[120:123], v[152:155], v[44:47], v[120:123]
  ds_read_b128 v[32:35], v8 offset:512
  ds_read_b128 v[36:39], v8 offset:3072
  ds_read_b128 v[40:43], v8 offset:3328
  ds_read_b128 v[44:47], v8 offset:3584
  v_mfma_f32_16x16x32_bf16 v[56:59], v[24:27], v[188:191], v[56:59]
  v_mfma_f32_16x16x32_bf16 v[60:63], v[28:31], v[188:191], v[60:63]
  s_add_u32 m0, s23, 10240
  s_waitcnt lgkmcnt(0)
  buffer_load_dwordx4 v242, s[4:7], s21 offen lds
  buffer_load_dwordx4 v243, s[8:11], s21 offen offset:1024 lds
  ds_read_b64_tr_b16 v[24:25], v4 offset:0
  ds_read_b64_tr_b16 v[26:27], v4 offset:512
  ds_read_b64_tr_b16 v[28:29], v5 offset:0
  ds_read_b64_tr_b16 v[30:31], v5 offset:512
  v_mfma_f32_16x16x32_bf16 v[124:127], v[152:155], v[32:35], v[124:127]
  v_mfma_f32_16x16x32_bf16 v[116:119], v[156:159], v[36:39], v[116:119]
  v_mfma_f32_16x16x32_bf16 v[120:123], v[156:159], v[40:43], v[120:123]
  v_mfma_f32_16x16x32_bf16 v[124:127], v[156:159], v[44:47], v[124:127]
  v_mfma_f32_16x16x32_bf16 v[48:51], v[16:19], v[192:195], v[48:51]
  v_mfma_f32_16x16x32_bf16 v[52:55], v[20:23], v[192:195], v[52:55]
  s_add_u32 m0, s23, 0
  s_waitcnt lgkmcnt(0)
  v_mfma_f32_16x16x32_bf16 v[56:59], v[24:27], v[192:195], v[56:59]
  v_mfma_f32_16x16x32_bf16 v[60:63], v[28:31], v[192:195], v[60:63]
  s_waitcnt vmcnt(4) lgkmcnt(0)
  buffer_load_dwordx4 v224, s[4:7], s21 offen lds
  buffer_load_dwordx4 v225, s[8:11], s21 offen offset:1024 lds
  ds_read_b64_tr_b16 v[16:17], v2 offset:4096
  ds_read_b64_tr_b16 v[18:19], v2 offset:4608
  ds_read_b64_tr_b16 v[20:21], v3 offset:4096
  ds_read_b64_tr_b16 v[22:23], v3 offset:4608
  s_add_u32 m0, s23, 2048
  s_nop 0
  v_cvt_pk_bf16_f32 v32, v48, v49
  v_cvt_pk_bf16_f32 v33, v50, v51
  v_cvt_pk_bf16_f32 v34, v52, v53
  v_cvt_pk_bf16_f32 v35, v54, v55
  v_cvt_pk_bf16_f32 v36, v56, v57
  v_cvt_pk_bf16_f32 v37, v58, v59
  v_cvt_pk_bf16_f32 v38, v60, v61
  v_cvt_pk_bf16_f32 v39, v62, v63
  v_cvt_pk_bf16_f32 v40, v64, v65
  v_cvt_pk_bf16_f32 v41, v66, v67
  v_cvt_pk_bf16_f32 v42, v68, v69
  v_cvt_pk_bf16_f32 v43, v70, v71
  v_cvt_pk_bf16_f32 v44, v72, v73
  v_cvt_pk_bf16_f32 v45, v74, v75
  v_cvt_pk_bf16_f32 v46, v76, v77
  v_cvt_pk_bf16_f32 v47, v78, v79
  ds_write_b128 v6, v[32:35] offset:16
  ds_write_b128 v6, v[36:39] offset:3088
  s_mov_b64 exec, s[42:43]
  ds_write_b128 v6, v[40:43] offset:0
  ds_write_b128 v6, v[44:47] offset:3072
  s_mov_b64 exec, -1
  v_subrev_u32 v6, s77, v6
  s_waitcnt lgkmcnt(0)
  buffer_load_dwordx4 v226, s[4:7], s21 offen lds
  buffer_load_dwordx4 v227, s[8:11], s21 offen offset:1024 lds
  ds_read_b64_tr_b16 v[24:25], v4 offset:4096
  ds_read_b64_tr_b16 v[26:27], v4 offset:4608
  ds_read_b64_tr_b16 v[28:29], v5 offset:4096
  ds_read_b64_tr_b16 v[30:31], v5 offset:4608
  v_add_u32 v7, s77, v7
  v_add_u32 v8, s77, v8
  v_mfma_f32_16x16x32_bf16 v[48:51], v[16:19], v[176:179], 0
  v_mfma_f32_16x16x32_bf16 v[52:55], v[20:23], v[176:179], 0
  v_mfma_f32_16x16x32_bf16 v[64:67], v[16:19], v[200:203], 0
  v_mfma_f32_16x16x32_bf16 v[68:71], v[20:23], v[200:203], 0
  s_add_u32 m0, s23, 4096
  s_waitcnt vmcnt(4) lgkmcnt(0)
  buffer_load_dwordx4 v228, s[4:7], s21 offen lds
  buffer_load_dwordx4 v229, s[8:11], s21 offen offset:1024 lds
  ds_read_b64_tr_b16 v[16:17], v2 offset:8192
  ds_read_b64_tr_b16 v[18:19], v2 offset:8704
  ds_read_b64_tr_b16 v[20:21], v3 offset:8192
  ds_read_b64_tr_b16 v[22:23], v3 offset:8704
  v_mfma_f32_16x16x32_bf16 v[56:59], v[24:27], v[176:179], 0
  v_mfma_f32_16x16x32_bf16 v[60:63], v[28:31], v[176:179], 0
  v_mfma_f32_16x16x32_bf16 v[72:75], v[24:27], v[200:203], 0
  v_mfma_f32_16x16x32_bf16 v[76:79], v[28:31], v[200:203], 0
  s_add_u32 m0, s23, 6144
  s_waitcnt lgkmcnt(0)
  s_barrier
  buffer_load_dwordx4 v230, s[4:7], s21 offen lds
  buffer_load_dwordx4 v231, s[8:11], s21 offen offset:1024 lds
  ds_read_b64_tr_b16 v[24:25], v4 offset:8192
  ds_read_b64_tr_b16 v[26:27], v4 offset:8704
  ds_read_b64_tr_b16 v[28:29], v5 offset:8192
  ds_read_b64_tr_b16 v[30:31], v5 offset:8704
  ds_read_b128 v[32:35], v8 offset:18464
  ds_read_b128 v[36:39], v8 offset:18720
  ds_read_b128 v[40:43], v8 offset:18976
  ds_read_b128 v[44:47], v8 offset:21536
  v_mfma_f32_16x16x32_bf16 v[48:51], v[16:19], v[180:183], v[48:51]
  v_mfma_f32_16x16x32_bf16 v[52:55], v[20:23], v[180:183], v[52:55]
  s_add_u32 m0, s23, 8192
  s_waitcnt vmcnt(4) lgkmcnt(0)
  buffer_load_dwordx4 v232, s[4:7], s21 offen lds
  buffer_load_dwordx4 v233, s[8:11], s21 offen offset:1024 lds
  ds_read_b64_tr_b16 v[16:17], v2 offset:0
  ds_read_b64_tr_b16 v[18:19], v2 offset:512
  ds_read_b64_tr_b16 v[20:21], v3 offset:0
  ds_read_b64_tr_b16 v[22:23], v3 offset:512
  v_mfma_f32_16x16x32_bf16 v[104:107], v[128:131], v[32:35], v[104:107]
  v_mfma_f32_16x16x32_bf16 v[108:111], v[128:131], v[36:39], v[108:111]
  v_mfma_f32_16x16x32_bf16 v[112:115], v[128:131], v[40:43], v[112:115]
  v_mfma_f32_16x16x32_bf16 v[104:107], v[132:135], v[44:47], v[104:107]
  ds_read_b128 v[32:35], v8 offset:21792
  ds_read_b128 v[36:39], v8 offset:22048
  ds_read_b128 v[40:43], v7 offset:0
  ds_read_b128 v[44:47], v7 offset:256
  v_mfma_f32_16x16x32_bf16 v[56:59], v[24:27], v[180:183], v[56:59]
  v_mfma_f32_16x16x32_bf16 v[60:63], v[28:31], v[180:183], v[60:63]
  s_add_u32 m0, s23, 10240
  s_waitcnt lgkmcnt(0)
  buffer_load_dwordx4 v234, s[4:7], s21 offen lds
  buffer_load_dwordx4 v235, s[8:11], s21 offen offset:1024 lds
  ds_read_b64_tr_b16 v[24:25], v4 offset:0
  ds_read_b64_tr_b16 v[26:27], v4 offset:512
  ds_read_b64_tr_b16 v[28:29], v5 offset:0
  ds_read_b64_tr_b16 v[30:31], v5 offset:512
  v_mfma_f32_16x16x32_bf16 v[108:111], v[132:135], v[32:35], v[108:111]
  v_mfma_f32_16x16x32_bf16 v[112:115], v[132:135], v[36:39], v[112:115]
  v_mfma_f32_16x16x32_bf16 v[92:95], v[136:139], v[40:43], v[92:95]
  v_mfma_f32_16x16x32_bf16 v[96:99], v[136:139], v[44:47], v[96:99]
  ds_read_b128 v[32:35], v7 offset:512
  ds_read_b128 v[36:39], v7 offset:3072
  ds_read_b128 v[40:43], v7 offset:3328
  ds_read_b128 v[44:47], v7 offset:3584
  v_mfma_f32_16x16x32_bf16 v[48:51], v[16:19], v[184:187], v[48:51]
  v_mfma_f32_16x16x32_bf16 v[52:55], v[20:23], v[184:187], v[52:55]
  s_add_u32 m0, s23, 0
  s_waitcnt vmcnt(4) lgkmcnt(0)
  s_mov_b32 s21, 640
  buffer_load_dwordx4 v236, s[4:7], s21 offen lds
  buffer_load_dwordx4 v237, s[8:11], s21 offen offset:1024 lds
  ds_read_b64_tr_b16 v[16:17], v2 offset:4096
  ds_read_b64_tr_b16 v[18:19], v2 offset:4608
  ds_read_b64_tr_b16 v[20:21], v3 offset:4096
  ds_read_b64_tr_b16 v[22:23], v3 offset:4608
  v_mfma_f32_16x16x32_bf16 v[100:103], v[136:139], v[32:35], v[100:103]
  v_mfma_f32_16x16x32_bf16 v[92:95], v[140:143], v[36:39], v[92:95]
  v_mfma_f32_16x16x32_bf16 v[96:99], v[140:143], v[40:43], v[96:99]
  v_mfma_f32_16x16x32_bf16 v[100:103], v[140:143], v[44:47], v[100:103]
  ds_read_b128 v[32:35], v7 offset:18464
  ds_read_b128 v[36:39], v7 offset:18720
  ds_read_b128 v[40:43], v7 offset:18976
  ds_read_b128 v[44:47], v7 offset:21536
  v_mfma_f32_16x16x32_bf16 v[56:59], v[24:27], v[184:187], v[56:59]
  v_mfma_f32_16x16x32_bf16 v[60:63], v[28:31], v[184:187], v[60:63]
  v_xor_b32 v128, 0x80008000, v128
  v_xor_b32 v129, 0x80008000, v129
  v_xor_b32 v130, 0x80008000, v130
  v_xor_b32 v131, 0x80008000, v131
  v_xor_b32 v132, 0x80008000, v132
  v_xor_b32 v133, 0x80008000, v133
  v_xor_b32 v134, 0x80008000, v134
  v_xor_b32 v135, 0x80008000, v135
  s_add_u32 m0, s23, 2048
  s_waitcnt lgkmcnt(0)
  buffer_load_dwordx4 v238, s[4:7], s21 offen lds
  buffer_load_dwordx4 v239, s[8:11], s21 offen offset:1024 lds
  ds_read_b64_tr_b16 v[24:25], v4 offset:4096
  ds_read_b64_tr_b16 v[26:27], v4 offset:4608
  ds_read_b64_tr_b16 v[28:29], v5 offset:4096
  ds_read_b64_tr_b16 v[30:31], v5 offset:4608
  v_mfma_f32_16x16x32_bf16 v[80:83], v[144:147], v[32:35], v[80:83]
  v_mfma_f32_16x16x32_bf16 v[84:87], v[144:147], v[36:39], v[84:87]
  v_mfma_f32_16x16x32_bf16 v[88:91], v[144:147], v[40:43], v[88:91]
  v_mfma_f32_16x16x32_bf16 v[80:83], v[148:151], v[44:47], v[80:83]
  ds_read_b128 v[32:35], v7 offset:21792
  ds_read_b128 v[36:39], v7 offset:22048
  ds_read_b128 v[40:43], v8 offset:0
  ds_read_b128 v[44:47], v8 offset:256
  v_mfma_f32_16x16x32_bf16 v[48:51], v[16:19], v[188:191], v[48:51]
  v_mfma_f32_16x16x32_bf16 v[52:55], v[20:23], v[188:191], v[52:55]
  s_add_u32 m0, s23, 4096
  s_waitcnt vmcnt(4) lgkmcnt(0)
  buffer_load_dwordx4 v240, s[4:7], s21 offen lds
  buffer_load_dwordx4 v241, s[8:11], s21 offen offset:1024 lds
  ds_read_b64_tr_b16 v[16:17], v2 offset:8192
  ds_read_b64_tr_b16 v[18:19], v2 offset:8704
  ds_read_b64_tr_b16 v[20:21], v3 offset:8192
  ds_read_b64_tr_b16 v[22:23], v3 offset:8704
  v_mfma_f32_16x16x32_bf16 v[84:87], v[148:151], v[32:35], v[84:87]
  v_mfma_f32_16x16x32_bf16 v[88:91], v[148:151], v[36:39], v[88:91]
  v_mfma_f32_16x16x32_bf16 v[116:119], v[128:131], v[40:43], v[116:119]
  v_mfma_f32_16x16x32_bf16 v[120:123], v[128:131], v[44:47], v[120:123]
  ds_read_b128 v[32:35], v8 offset:512
  ds_read_b128 v[36:39], v8 offset:3072
  ds_read_b128 v[40:43], v8 offset:3328
  ds_read_b128 v[44:47], v8 offset:3584
  v_mfma_f32_16x16x32_bf16 v[56:59], v[24:27], v[188:191], v[56:59]
  v_mfma_f32_16x16x32_bf16 v[60:63], v[28:31], v[188:191], v[60:63]
  s_add_u32 m0, s23, 6144
  s_waitcnt lgkmcnt(0)
  buffer_load_dwordx4 v242, s[4:7], s21 offen lds
  buffer_load_dwordx4 v243, s[8:11], s21 offen offset:1024 lds
  ds_read_b64_tr_b16 v[24:25], v4 offset:8192
  ds_read_b64_tr_b16 v[26:27], v4 offset:8704
  ds_read_b64_tr_b16 v[28:29], v5 offset:8192
  ds_read_b64_tr_b16 v[30:31], v5 offset:8704
  v_mfma_f32_16x16x32_bf16 v[124:127], v[128:131], v[32:35], v[124:127]
  v_mfma_f32_16x16x32_bf16 v[116:119], v[132:135], v[36:39], v[116:119]
  v_mfma_f32_16x16x32_bf16 v[120:123], v[132:135], v[40:43], v[120:123]
  v_mfma_f32_16x16x32_bf16 v[124:127], v[132:135], v[44:47], v[124:127]
  v_mfma_f32_16x16x32_bf16 v[48:51], v[16:19], v[192:195], v[48:51]
  v_mfma_f32_16x16x32_bf16 v[52:55], v[20:23], v[192:195], v[52:55]
  s_add_u32 m0, s23, 8192
  s_waitcnt lgkmcnt(0)
  v_mfma_f32_16x16x32_bf16 v[56:59], v[24:27], v[192:195], v[56:59]
  v_mfma_f32_16x16x32_bf16 v[60:63], v[28:31], v[192:195], v[60:63]
  s_waitcnt vmcnt(4) lgkmcnt(0)
  buffer_load_dwordx4 v224, s[4:7], s21 offen lds
  buffer_load_dwordx4 v225, s[8:11], s21 offen offset:1024 lds
  ds_read_b64_tr_b16 v[16:17], v2 offset:0
  ds_read_b64_tr_b16 v[18:19], v2 offset:512
  ds_read_b64_tr_b16 v[20:21], v3 offset:0
  ds_read_b64_tr_b16 v[22:23], v3 offset:512
  s_add_u32 m0, s23, 10240
  s_nop 0
  v_cvt_pk_bf16_f32 v32, v48, v49
  v_cvt_pk_bf16_f32 v33, v50, v51
  v_cvt_pk_bf16_f32 v34, v52, v53
  v_cvt_pk_bf16_f32 v35, v54, v55
  v_cvt_pk_bf16_f32 v36, v56, v57
  v_cvt_pk_bf16_f32 v37, v58, v59
  v_cvt_pk_bf16_f32 v38, v60, v61
  v_cvt_pk_bf16_f32 v39, v62, v63
  v_cvt_pk_bf16_f32 v40, v64, v65
  v_cvt_pk_bf16_f32 v41, v66, v67
  v_cvt_pk_bf16_f32 v42, v68, v69
  v_cvt_pk_bf16_f32 v43, v70, v71
  v_cvt_pk_bf16_f32 v44, v72, v73
  v_cvt_pk_bf16_f32 v45, v74, v75
  v_cvt_pk_bf16_f32 v46, v76, v77
  v_cvt_pk_bf16_f32 v47, v78, v79
  ds_write_b128 v6, v[32:35] offset:16
  ds_write_b128 v6, v[36:39] offset:3088
  s_mov_b64 exec, s[42:43]
  ds_write_b128 v6, v[40:43] offset:0
  ds_write_b128 v6, v[44:47] offset:3072
  s_mov_b64 exec, -1
  v_add_u32 v6, s77, v6
  s_waitcnt lgkmcnt(0)
  buffer_load_dwordx4 v226, s[4:7], s21 offen lds
  buffer_load_dwordx4 v227, s[8:11], s21 offen offset:1024 lds
  ds_read_b64_tr_b16 v[24:25], v4 offset:0
  ds_read_b64_tr_b16 v[26:27], v4 offset:512
  ds_read_b64_tr_b16 v[28:29], v5 offset:0
  ds_read_b64_tr_b16 v[30:31], v5 offset:512
  v_subrev_u32 v7, s77, v7
  v_subrev_u32 v8, s77, v8
  v_mfma_f32_16x16x32_bf16 v[48:51], v[16:19], v[176:179], 0
  v_mfma_f32_16x16x32_bf16 v[52:55], v[20:23], v[176:179], 0
  v_mfma_f32_16x16x32_bf16 v[64:67], v[16:19], v[200:203], 0
  v_mfma_f32_16x16x32_bf16 v[68:71], v[20:23], v[200:203], 0
  s_add_u32 m0, s23, 0
  s_waitcnt vmcnt(4) lgkmcnt(0)
  buffer_load_dwordx4 v228, s[4:7], s21 offen lds
  buffer_load_dwordx4 v229, s[8:11], s21 offen offset:1024 lds
  ds_read_b64_tr_b16 v[16:17], v2 offset:4096
  ds_read_b64_tr_b16 v[18:19], v2 offset:4608
  ds_read_b64_tr_b16 v[20:21], v3 offset:4096
  ds_read_b64_tr_b16 v[22:23], v3 offset:4608
  v_mfma_f32_16x16x32_bf16 v[56:59], v[24:27], v[176:179], 0
  v_mfma_f32_16x16x32_bf16 v[60:63], v[28:31], v[176:179], 0
  v_mfma_f32_16x16x32_bf16 v[72:75], v[24:27], v[200:203], 0
  v_mfma_f32_16x16x32_bf16 v[76:79], v[28:31], v[200:203], 0
  s_add_u32 m0, s23, 2048
  s_waitcnt lgkmcnt(0)
  s_barrier
  buffer_load_dwordx4 v230, s[4:7], s21 offen lds
  buffer_load_dwordx4 v231, s[8:11], s21 offen offset:1024 lds
  ds_read_b64_tr_b16 v[24:25], v4 offset:4096
  ds_read_b64_tr_b16 v[26:27], v4 offset:4608
  ds_read_b64_tr_b16 v[28:29], v5 offset:4096
  ds_read_b64_tr_b16 v[30:31], v5 offset:4608
  ds_read_b128 v[32:35], v8 offset:18464
  ds_read_b128 v[36:39], v8 offset:18720
  ds_read_b128 v[40:43], v8 offset:18976
  ds_read_b128 v[44:47], v8 offset:21536
  v_mfma_f32_16x16x32_bf16 v[48:51], v[16:19], v[180:183], v[48:51]
  v_mfma_f32_16x16x32_bf16 v[52:55], v[20:23], v[180:183], v[52:55]
  s_add_u32 m0, s23, 4096
  s_waitcnt vmcnt(4) lgkmcnt(0)
  buffer_load_dwordx4 v232, s[4:7], s21 offen lds
  buffer_load_dwordx4 v233, s[8:11], s21 offen offset:1024 lds
  ds_read_b64_tr_b16 v[16:17], v2 offset:8192
  ds_read_b64_tr_b16 v[18:19], v2 offset:8704
  ds_read_b64_tr_b16 v[20:21], v3 offset:8192
  ds_read_b64_tr_b16 v[22:23], v3 offset:8704
  v_mfma_f32_16x16x32_bf16 v[92:95], v[128:131], v[32:35], v[92:95]
  v_mfma_f32_16x16x32_bf16 v[96:99], v[128:131], v[36:39], v[96:99]
  v_mfma_f32_16x16x32_bf16 v[100:103], v[128:131], v[40:43], v[100:103]
  v_mfma_f32_16x16x32_bf16 v[92:95], v[132:135], v[44:47], v[92:95]
  ds_read_b128 v[32:35], v8 offset:21792
  ds_read_b128 v[36:39], v8 offset:22048
  ds_read_b128 v[40:43], v7 offset:0
  ds_read_b128 v[44:47], v7 offset:256
  v_mfma_f32_16x16x32_bf16 v[56:59], v[24:27], v[180:183], v[56:59]
  v_mfma_f32_16x16x32_bf16 v[60:63], v[28:31], v[180:183], v[60:63]
  s_add_u32 m0, s23, 6144
  s_waitcnt lgkmcnt(0)
  buffer_load_dwordx4 v234, s[4:7], s21 offen lds
  buffer_load_dwordx4 v235, s[8:11], s21 offen offset:1024 lds
  ds_read_b64_tr_b16 v[24:25], v4 offset:8192
  ds_read_b64_tr_b16 v[26:27], v4 offset:8704
  ds_read_b64_tr_b16 v[28:29], v5 offset:8192
  ds_read_b64_tr_b16 v[30:31], v5 offset:8704
  v_mfma_f32_16x16x32_bf16 v[96:99], v[132:135], v[32:35], v[96:99]
  v_mfma_f32_16x16x32_bf16 v[100:103], v[132:135], v[36:39], v[100:103]
  v_mfma_f32_16x16x32_bf16 v[104:107], v[136:139], v[40:43], v[104:107]
  v_mfma_f32_16x16x32_bf16 v[108:111], v[136:139], v[44:47], v[108:111]
  ds_read_b128 v[32:35], v7 offset:512
  ds_read_b128 v[36:39], v7 offset:3072
  ds_read_b128 v[40:43], v7 offset:3328
  ds_read_b128 v[44:47], v7 offset:3584
  v_mfma_f32_16x16x32_bf16 v[48:51], v[16:19], v[184:187], v[48:51]
  v_mfma_f32_16x16x32_bf16 v[52:55], v[20:23], v[184:187], v[52:55]
  s_add_u32 m0, s23, 8192
  s_waitcnt vmcnt(4) lgkmcnt(0)
  s_mov_b32 s21, 768
  buffer_load_dwordx4 v236, s[4:7], s21 offen lds
  buffer_load_dwordx4 v237, s[8:11], s21 offen offset:1024 lds
  ds_read_b64_tr_b16 v[16:17], v2 offset:0
  ds_read_b64_tr_b16 v[18:19], v2 offset:512
  ds_read_b64_tr_b16 v[20:21], v3 offset:0
  ds_read_b64_tr_b16 v[22:23], v3 offset:512
  v_mfma_f32_16x16x32_bf16 v[112:115], v[136:139], v[32:35], v[112:115]
  v_mfma_f32_16x16x32_bf16 v[104:107], v[140:143], v[36:39], v[104:107]
  v_mfma_f32_16x16x32_bf16 v[108:111], v[140:143], v[40:43], v[108:111]
  v_mfma_f32_16x16x32_bf16 v[112:115], v[140:143], v[44:47], v[112:115]
  ds_read_b128 v[32:35], v8 offset:0
  ds_read_b128 v[36:39], v8 offset:256
  ds_read_b128 v[40:43], v8 offset:512
  ds_read_b128 v[44:47], v8 offset:3072
  v_mfma_f32_16x16x32_bf16 v[56:59], v[24:27], v[184:187], v[56:59]
  v_mfma_f32_16x16x32_bf16 v[60:63], v[28:31], v[184:187], v[60:63]
  v_xor_b32 v128, 0x80008000, v128
  v_xor_b32 v129, 0x80008000, v129
  v_xor_b32 v130, 0x80008000, v130
  v_xor_b32 v131, 0x80008000, v131
  v_xor_b32 v132, 0x80008000, v132
  v_xor_b32 v133, 0x80008000, v133
  v_xor_b32 v134, 0x80008000, v134
  v_xor_b32 v135, 0x80008000, v135
  s_add_u32 m0, s23, 10240
  s_waitcnt lgkmcnt(0)
  buffer_load_dwordx4 v238, s[4:7], s21 offen lds
  buffer_load_dwordx4 v239, s[8:11], s21 offen offset:1024 lds
  ds_read_b64_tr_b16 v[24:25], v4 offset:0
  ds_read_b64_tr_b16 v[26:27], v4 offset:512
  ds_read_b64_tr_b16 v[28:29], v5 offset:0
  ds_read_b64_tr_b16 v[30:31], v5 offset:512
  v_mfma_f32_16x16x32_bf16 v[80:83], v[144:147], v[32:35], v[80:83]
  v_mfma_f32_16x16x32_bf16 v[84:87], v[144:147], v[36:39], v[84:87]
  v_mfma_f32_16x16x32_bf16 v[88:91], v[144:147], v[40:43], v[88:91]
  v_mfma_f32_16x16x32_bf16 v[80:83], v[148:151], v[44:47], v[80:83]
  ds_read_b128 v[32:35], v8 offset:3328
  ds_read_b128 v[36:39], v8 offset:3584
  ds_read_b128 v[40:43], v7 offset:18464
  ds_read_b128 v[44:47], v7 offset:18720
  v_mfma_f32_16x16x32_bf16 v[48:51], v[16:19], v[188:191], v[48:51]
  v_mfma_f32_16x16x32_bf16 v[52:55], v[20:23], v[188:191], v[52:55]
  s_add_u32 m0, s23, 0
  s_waitcnt vmcnt(4) lgkmcnt(0)
  buffer_load_dwordx4 v240, s[4:7], s21 offen lds
  buffer_load_dwordx4 v241, s[8:11], s21 offen offset:1024 lds
  ds_read_b64_tr_b16 v[16:17], v2 offset:4096
  ds_read_b64_tr_b16 v[18:19], v2 offset:4608
  ds_read_b64_tr_b16 v[20:21], v3 offset:4096
  ds_read_b64_tr_b16 v[22:23], v3 offset:4608
  v_mfma_f32_16x16x32_bf16 v[84:87], v[148:151], v[32:35], v[84:87]
  v_mfma_f32_16x16x32_bf16 v[88:91], v[148:151], v[36:39], v[88:91]
  v_mfma_f32_16x16x32_bf16 v[116:119], v[128:131], v[40:43], v[116:119]
  v_mfma_f32_16x16x32_bf16 v[120:123], v[128:131], v[44:47], v[120:123]
  ds_read_b128 v[32:35], v7 offset:18976
  ds_read_b128 v[36:39], v7 offset:21536
  ds_read_b128 v[40:43], v7 offset:21792
  ds_read_b128 v[44:47], v7 offset:22048
  v_mfma_f32_16x16x32_bf16 v[56:59], v[24:27], v[188:191], v[56:59]
  v_mfma_f32_16x16x32_bf16 v[60:63], v[28:31], v[188:191], v[60:63]
  s_add_u32 m0, s23, 2048
  s_waitcnt lgkmcnt(0)
  buffer_load_dwordx4 v242, s[4:7], s21 offen lds
  buffer_load_dwordx4 v243, s[8:11], s21 offen offset:1024 lds
  ds_read_b64_tr_b16 v[24:25], v4 offset:4096
  ds_read_b64_tr_b16 v[26:27], v4 offset:4608
  ds_read_b64_tr_b16 v[28:29], v5 offset:4096
  ds_read_b64_tr_b16 v[30:31], v5 offset:4608
  v_mfma_f32_16x16x32_bf16 v[124:127], v[128:131], v[32:35], v[124:127]
  v_mfma_f32_16x16x32_bf16 v[116:119], v[132:135], v[36:39], v[116:119]
  v_mfma_f32_16x16x32_bf16 v[120:123], v[132:135], v[40:43], v[120:123]
  v_mfma_f32_16x16x32_bf16 v[124:127], v[132:135], v[44:47], v[124:127]
  v_mfma_f32_16x16x32_bf16 v[48:51], v[16:19], v[192:195], v[48:51]
  v_mfma_f32_16x16x32_bf16 v[52:55], v[20:23], v[192:195], v[52:55]
  s_add_u32 m0, s23, 4096
  s_waitcnt lgkmcnt(0)
  v_mfma_f32_16x16x32_bf16 v[56:59], v[24:27], v[192:195], v[56:59]
  v_mfma_f32_16x16x32_bf16 v[60:63], v[28:31], v[192:195], v[60:63]
  s_waitcnt vmcnt(4) lgkmcnt(0)
  buffer_load_dwordx4 v224, s[4:7], s21 offen lds
  buffer_load_dwordx4 v225, s[8:11], s21 offen offset:1024 lds
  ds_read_b64_tr_b16 v[16:17], v2 offset:8192
  ds_read_b64_tr_b16 v[18:19], v2 offset:8704
  ds_read_b64_tr_b16 v[20:21], v3 offset:8192
  ds_read_b64_tr_b16 v[22:23], v3 offset:8704
  s_add_u32 m0, s23, 6144
  s_nop 0
  v_cvt_pk_bf16_f32 v32, v48, v49
  v_cvt_pk_bf16_f32 v33, v50, v51
  v_cvt_pk_bf16_f32 v34, v52, v53
  v_cvt_pk_bf16_f32 v35, v54, v55
  v_cvt_pk_bf16_f32 v36, v56, v57
  v_cvt_pk_bf16_f32 v37, v58, v59
  v_cvt_pk_bf16_f32 v38, v60, v61
  v_cvt_pk_bf16_f32 v39, v62, v63
  v_cvt_pk_bf16_f32 v40, v64, v65
  v_cvt_pk_bf16_f32 v41, v66, v67
  v_cvt_pk_bf16_f32 v42, v68, v69
  v_cvt_pk_bf16_f32 v43, v70, v71
  v_cvt_pk_bf16_f32 v44, v72, v73
  v_cvt_pk_bf16_f32 v45, v74, v75
  v_cvt_pk_bf16_f32 v46, v76, v77
  v_cvt_pk_bf16_f32 v47, v78, v79
  ds_write_b128 v6, v[32:35] offset:16
  ds_write_b128 v6, v[36:39] offset:3088
  s_mov_b64 exec, s[42:43]
  ds_write_b128 v6, v[40:43] offset:0
  ds_write_b128 v6, v[44:47] offset:3072
  s_mov_b64 exec, -1
  v_subrev_u32 v6, s77, v6
  s_waitcnt lgkmcnt(0)
  buffer_load_dwordx4 v226, s[4:7], s21 offen lds
  buffer_load_dwordx4 v227, s[8:11], s21 offen offset:1024 lds
  ds_read_b64_tr_b16 v[24:25], v4 offset:8192
  ds_read_b64_tr_b16 v[26:27], v4 offset:8704
  ds_read_b64_tr_b16 v[28:29], v5 offset:8192
  ds_read_b64_tr_b16 v[30:31], v5 offset:8704
  v_add_u32 v7, s77, v7
  v_add_u32 v8, s77, v8
  v_mfma_f32_16x16x32_bf16 v[48:51], v[16:19], v[176:179], 0
  v_mfma_f32_16x16x32_bf16 v[52:55], v[20:23], v[176:179], 0
  v_mfma_f32_16x16x32_bf16 v[64:67], v[16:19], v[200:203], 0
  v_mfma_f32_16x16x32_bf16 v[68:71], v[20:23], v[200:203], 0
  s_add_u32 m0, s23, 8192
  s_waitcnt vmcnt(4) lgkmcnt(0)
  buffer_load_dwordx4 v228, s[4:7], s21 offen lds
  buffer_load_dwordx4 v229, s[8:11], s21 offen offset:1024 lds
  ds_read_b64_tr_b16 v[16:17], v2 offset:0
  ds_read_b64_tr_b16 v[18:19], v2 offset:512
  ds_read_b64_tr_b16 v[20:21], v3 offset:0
  ds_read_b64_tr_b16 v[22:23], v3 offset:512
  v_mfma_f32_16x16x32_bf16 v[56:59], v[24:27], v[176:179], 0
  v_mfma_f32_16x16x32_bf16 v[60:63], v[28:31], v[176:179], 0
  v_mfma_f32_16x16x32_bf16 v[72:75], v[24:27], v[200:203], 0
  v_mfma_f32_16x16x32_bf16 v[76:79], v[28:31], v[200:203], 0
  s_add_u32 m0, s23, 10240
  s_waitcnt lgkmcnt(0)
  s_barrier
  buffer_load_dwordx4 v230, s[4:7], s21 offen lds
  buffer_load_dwordx4 v231, s[8:11], s21 offen offset:1024 lds
  ds_read_b64_tr_b16 v[24:25], v4 offset:0
  ds_read_b64_tr_b16 v[26:27], v4 offset:512
  ds_read_b64_tr_b16 v[28:29], v5 offset:0
  ds_read_b64_tr_b16 v[30:31], v5 offset:512
  ds_read_b128 v[32:35], v8 offset:18464
  ds_read_b128 v[36:39], v8 offset:18720
  ds_read_b128 v[40:43], v8 offset:18976
  ds_read_b128 v[44:47], v8 offset:21536
  v_mfma_f32_16x16x32_bf16 v[48:51], v[16:19], v[180:183], v[48:51]
  v_mfma_f32_16x16x32_bf16 v[52:55], v[20:23], v[180:183], v[52:55]
  s_add_u32 m0, s23, 0
  s_waitcnt vmcnt(4) lgkmcnt(0)
  buffer_load_dwordx4 v232, s[4:7], s21 offen lds
  buffer_load_dwordx4 v233, s[8:11], s21 offen offset:1024 lds
  ds_read_b64_tr_b16 v[16:17], v2 offset:4096
  ds_read_b64_tr_b16 v[18:19], v2 offset:4608
  ds_read_b64_tr_b16 v[20:21], v3 offset:4096
  ds_read_b64_tr_b16 v[22:23], v3 offset:4608
  v_mfma_f32_16x16x32_bf16 v[92:95], v[152:155], v[32:35], v[92:95]
  v_mfma_f32_16x16x32_bf16 v[96:99], v[152:155], v[36:39], v[96:99]
  v_mfma_f32_16x16x32_bf16 v[100:103], v[152:155], v[40:43], v[100:103]
  v_mfma_f32_16x16x32_bf16 v[92:95], v[156:159], v[44:47], v[92:95]
  ds_read_b128 v[32:35], v8 offset:21792
  ds_read_b128 v[36:39], v8 offset:22048
  ds_read_b128 v[40:43], v7 offset:0
  ds_read_b128 v[44:47], v7 offset:256
  v_mfma_f32_16x16x32_bf16 v[56:59], v[24:27], v[180:183], v[56:59]
  v_mfma_f32_16x16x32_bf16 v[60:63], v[28:31], v[180:183], v[60:63]
  s_add_u32 m0, s23, 2048
  s_waitcnt lgkmcnt(0)
  buffer_load_dwordx4 v234, s[4:7], s21 offen lds
  buffer_load_dwordx4 v235, s[8:11], s21 offen offset:1024 lds
  ds_read_b64_tr_b16 v[24:25], v4 offset:4096
  ds_read_b64_tr_b16 v[26:27], v4 offset:4608
  ds_read_b64_tr_b16 v[28:29], v5 offset:4096
  ds_read_b64_tr_b16 v[30:31], v5 offset:4608
  v_mfma_f32_16x16x32_bf16 v[96:99], v[156:159], v[32:35], v[96:99]
  v_mfma_f32_16x16x32_bf16 v[100:103], v[156:159], v[36:39], v[100:103]
  v_mfma_f32_16x16x32_bf16 v[104:107], v[160:163], v[40:43], v[104:107]
  v_mfma_f32_16x16x32_bf16 v[108:111], v[160:163], v[44:47], v[108:111]
  ds_read_b128 v[32:35], v7 offset:512
  ds_read_b128 v[36:39], v7 offset:3072
  ds_read_b128 v[40:43], v7 offset:3328
  ds_read_b128 v[44:47], v7 offset:3584
  v_mfma_f32_16x16x32_bf16 v[48:51], v[16:19], v[184:187], v[48:51]
  v_mfma_f32_16x16x32_bf16 v[52:55], v[20:23], v[184:187], v[52:55]
  s_add_u32 m0, s23, 4096
  s_waitcnt vmcnt(4) lgkmcnt(0)
  s_mov_b32 s21, 896
  buffer_load_dwordx4 v236, s[4:7], s21 offen lds
  buffer_load_dwordx4 v237, s[8:11], s21 offen offset:1024 lds
  ds_read_b64_tr_b16 v[16:17], v2 offset:8192
  ds_read_b64_tr_b16 v[18:19], v2 offset:8704
  ds_read_b64_tr_b16 v[20:21], v3 offset:8192
  ds_read_b64_tr_b16 v[22:23], v3 offset:8704
  v_mfma_f32_16x16x32_bf16 v[112:115], v[160:163], v[32:35], v[112:115]
  v_mfma_f32_16x16x32_bf16 v[104:107], v[164:167], v[36:39], v[104:107]
  v_mfma_f32_16x16x32_bf16 v[108:111], v[164:167], v[40:43], v[108:111]
  v_mfma_f32_16x16x32_bf16 v[112:115], v[164:167], v[44:47], v[112:115]
  ds_read_b128 v[32:35], v8 offset:0
  ds_read_b128 v[36:39], v8 offset:256
  ds_read_b128 v[40:43], v8 offset:512
  ds_read_b128 v[44:47], v8 offset:3072
  v_mfma_f32_16x16x32_bf16 v[56:59], v[24:27], v[184:187], v[56:59]
  v_mfma_f32_16x16x32_bf16 v[60:63], v[28:31], v[184:187], v[60:63]
  v_xor_b32 v152, 0x80008000, v152
  v_xor_b32 v153, 0x80008000, v153
  v_xor_b32 v154, 0x80008000, v154
  v_xor_b32 v155, 0x80008000, v155
  v_xor_b32 v156, 0x80008000, v156
  v_xor_b32 v157, 0x80008000, v157
  v_xor_b32 v158, 0x80008000, v158
  v_xor_b32 v159, 0x80008000, v159
  s_add_u32 m0, s23, 6144
  s_waitcnt lgkmcnt(0)
  buffer_load_dwordx4 v238, s[4:7], s21 offen lds
  buffer_load_dwordx4 v239, s[8:11], s21 offen offset:1024 lds
  ds_read_b64_tr_b16 v[24:25], v4 offset:8192
  ds_read_b64_tr_b16 v[26:27], v4 offset:8704
  ds_read_b64_tr_b16 v[28:29], v5 offset:8192
  ds_read_b64_tr_b16 v[30:31], v5 offset:8704
  v_mfma_f32_16x16x32_bf16 v[80:83], v[168:171], v[32:35], v[80:83]
  v_mfma_f32_16x16x32_bf16 v[84:87], v[168:171], v[36:39], v[84:87]
  v_mfma_f32_16x16x32_bf16 v[88:91], v[168:171], v[40:43], v[88:91]
  v_mfma_f32_16x16x32_bf16 v[80:83], v[172:175], v[44:47], v[80:83]
  ds_read_b128 v[32:35], v8 offset:3328
  ds_read_b128 v[36:39], v8 offset:3584
  ds_read_b128 v[40:43], v7 offset:18464
  ds_read_b128 v[44:47], v7 offset:18720
  v_mfma_f32_16x16x32_bf16 v[48:51], v[16:19], v[188:191], v[48:51]
  v_mfma_f32_16x16x32_bf16 v[52:55], v[20:23], v[188:191], v[52:55]
  s_add_u32 m0, s23, 8192
  s_waitcnt vmcnt(4) lgkmcnt(0)
  buffer_load_dwordx4 v240, s[4:7], s21 offen lds
  buffer_load_dwordx4 v241, s[8:11], s21 offen offset:1024 lds
  ds_read_b64_tr_b16 v[16:17], v2 offset:0
  ds_read_b64_tr_b16 v[18:19], v2 offset:512
  ds_read_b64_tr_b16 v[20:21], v3 offset:0
  ds_read_b64_tr_b16 v[22:23], v3 offset:512
  v_mfma_f32_16x16x32_bf16 v[84:87], v[172:175], v[32:35], v[84:87]
  v_mfma_f32_16x16x32_bf16 v[88:91], v[172:175], v[36:39], v[88:91]
  v_mfma_f32_16x16x32_bf16 v[116:119], v[152:155], v[40:43], v[116:119]
  v_mfma_f32_16x16x32_bf16 v[120:123], v[152:155], v[44:47], v[120:123]
  ds_read_b128 v[32:35], v7 offset:18976
  ds_read_b128 v[36:39], v7 offset:21536
  ds_read_b128 v[40:43], v7 offset:21792
  ds_read_b128 v[44:47], v7 offset:22048
  v_mfma_f32_16x16x32_bf16 v[56:59], v[24:27], v[188:191], v[56:59]
  v_mfma_f32_16x16x32_bf16 v[60:63], v[28:31], v[188:191], v[60:63]
  s_add_u32 m0, s23, 10240
  s_waitcnt lgkmcnt(0)
  buffer_load_dwordx4 v242, s[4:7], s21 offen lds
  buffer_load_dwordx4 v243, s[8:11], s21 offen offset:1024 lds
  ds_read_b64_tr_b16 v[24:25], v4 offset:0
  ds_read_b64_tr_b16 v[26:27], v4 offset:512
  ds_read_b64_tr_b16 v[28:29], v5 offset:0
  ds_read_b64_tr_b16 v[30:31], v5 offset:512
  v_mfma_f32_16x16x32_bf16 v[124:127], v[152:155], v[32:35], v[124:127]
  v_mfma_f32_16x16x32_bf16 v[116:119], v[156:159], v[36:39], v[116:119]
  v_mfma_f32_16x16x32_bf16 v[120:123], v[156:159], v[40:43], v[120:123]
  v_mfma_f32_16x16x32_bf16 v[124:127], v[156:159], v[44:47], v[124:127]
  v_mfma_f32_16x16x32_bf16 v[48:51], v[16:19], v[192:195], v[48:51]
  v_mfma_f32_16x16x32_bf16 v[52:55], v[20:23], v[192:195], v[52:55]
  s_add_u32 m0, s23, 0
  s_waitcnt lgkmcnt(0)
  v_mfma_f32_16x16x32_bf16 v[56:59], v[24:27], v[192:195], v[56:59]
  v_mfma_f32_16x16x32_bf16 v[60:63], v[28:31], v[192:195], v[60:63]
  s_waitcnt vmcnt(4) lgkmcnt(0)
  buffer_load_dwordx4 v224, s[4:7], s21 offen lds
  buffer_load_dwordx4 v225, s[8:11], s21 offen offset:1024 lds
  ds_read_b64_tr_b16 v[16:17], v2 offset:4096
  ds_read_b64_tr_b16 v[18:19], v2 offset:4608
  ds_read_b64_tr_b16 v[20:21], v3 offset:4096
  ds_read_b64_tr_b16 v[22:23], v3 offset:4608
  s_add_u32 m0, s23, 2048
  s_nop 0
  v_cvt_pk_bf16_f32 v32, v48, v49
  v_cvt_pk_bf16_f32 v33, v50, v51
  v_cvt_pk_bf16_f32 v34, v52, v53
  v_cvt_pk_bf16_f32 v35, v54, v55
  v_cvt_pk_bf16_f32 v36, v56, v57
  v_cvt_pk_bf16_f32 v37, v58, v59
  v_cvt_pk_bf16_f32 v38, v60, v61
  v_cvt_pk_bf16_f32 v39, v62, v63
  v_cvt_pk_bf16_f32 v40, v64, v65
  v_cvt_pk_bf16_f32 v41, v66, v67
  v_cvt_pk_bf16_f32 v42, v68, v69
  v_cvt_pk_bf16_f32 v43, v70, v71
  v_cvt_pk_bf16_f32 v44, v72, v73
  v_cvt_pk_bf16_f32 v45, v74, v75
  v_cvt_pk_bf16_f32 v46, v76, v77
  v_cvt_pk_bf16_f32 v47, v78, v79
  ds_write_b128 v6, v[32:35] offset:16
  ds_write_b128 v6, v[36:39] offset:3088
  s_mov_b64 exec, s[42:43]
  ds_write_b128 v6, v[40:43] offset:0
  ds_write_b128 v6, v[44:47] offset:3072
  s_mov_b64 exec, -1
  v_add_u32 v6, s77, v6
  s_waitcnt lgkmcnt(0)
  buffer_load_dwordx4 v226, s[4:7], s21 offen lds
  buffer_load_dwordx4 v227, s[8:11], s21 offen offset:1024 lds
  ds_read_b64_tr_b16 v[24:25], v4 offset:4096
  ds_read_b64_tr_b16 v[26:27], v4 offset:4608
  ds_read_b64_tr_b16 v[28:29], v5 offset:4096
  ds_read_b64_tr_b16 v[30:31], v5 offset:4608
  v_subrev_u32 v7, s77, v7
  v_subrev_u32 v8, s77, v8
  v_mfma_f32_16x16x32_bf16 v[48:51], v[16:19], v[176:179], 0
  v_mfma_f32_16x16x32_bf16 v[52:55], v[20:23], v[176:179], 0
  v_mfma_f32_16x16x32_bf16 v[64:67], v[16:19], v[200:203], 0
  v_mfma_f32_16x16x32_bf16 v[68:71], v[20:23], v[200:203], 0
  s_add_u32 m0, s23, 4096
  s_waitcnt vmcnt(4) lgkmcnt(0)
  buffer_load_dwordx4 v228, s[4:7], s21 offen lds
  buffer_load_dwordx4 v229, s[8:11], s21 offen offset:1024 lds
  ds_read_b64_tr_b16 v[16:17], v2 offset:8192
  ds_read_b64_tr_b16 v[18:19], v2 offset:8704
  ds_read_b64_tr_b16 v[20:21], v3 offset:8192
  ds_read_b64_tr_b16 v[22:23], v3 offset:8704
  v_mfma_f32_16x16x32_bf16 v[56:59], v[24:27], v[176:179], 0
  v_mfma_f32_16x16x32_bf16 v[60:63], v[28:31], v[176:179], 0
  v_mfma_f32_16x16x32_bf16 v[72:75], v[24:27], v[200:203], 0
  v_mfma_f32_16x16x32_bf16 v[76:79], v[28:31], v[200:203], 0
  s_add_u32 m0, s23, 6144
  s_waitcnt lgkmcnt(0)
  s_barrier
  buffer_load_dwordx4 v230, s[4:7], s21 offen lds
  buffer_load_dwordx4 v231, s[8:11], s21 offen offset:1024 lds
  ds_read_b64_tr_b16 v[24:25], v4 offset:8192
  ds_read_b64_tr_b16 v[26:27], v4 offset:8704
  ds_read_b64_tr_b16 v[28:29], v5 offset:8192
  ds_read_b64_tr_b16 v[30:31], v5 offset:8704
  ds_read_b128 v[32:35], v8 offset:0
  ds_read_b128 v[36:39], v8 offset:256
  ds_read_b128 v[40:43], v8 offset:512
  ds_read_b128 v[44:47], v8 offset:3072
  v_mfma_f32_16x16x32_bf16 v[48:51], v[16:19], v[180:183], v[48:51]
  v_mfma_f32_16x16x32_bf16 v[52:55], v[20:23], v[180:183], v[52:55]
  s_add_u32 m0, s23, 8192
  s_waitcnt vmcnt(4) lgkmcnt(0)
  buffer_load_dwordx4 v232, s[4:7], s21 offen lds
  buffer_load_dwordx4 v233, s[8:11], s21 offen offset:1024 lds
  ds_read_b64_tr_b16 v[16:17], v2 offset:0
  ds_read_b64_tr_b16 v[18:19], v2 offset:512
  ds_read_b64_tr_b16 v[20:21], v3 offset:0
  ds_read_b64_tr_b16 v[22:23], v3 offset:512
  v_mfma_f32_16x16x32_bf16 v[92:95], v[128:131], v[32:35], v[92:95]
  v_mfma_f32_16x16x32_bf16 v[96:99], v[128:131], v[36:39], v[96:99]
  v_mfma_f32_16x16x32_bf16 v[100:103], v[128:131], v[40:43], v[100:103]
  v_mfma_f32_16x16x32_bf16 v[92:95], v[132:135], v[44:47], v[92:95]
  ds_read_b128 v[32:35], v8 offset:3328
  ds_read_b128 v[36:39], v8 offset:3584
  ds_read_b128 v[40:43], v7 offset:0
  ds_read_b128 v[44:47], v7 offset:256
  v_mfma_f32_16x16x32_bf16 v[56:59], v[24:27], v[180:183], v[56:59]
  v_mfma_f32_16x16x32_bf16 v[60:63], v[28:31], v[180:183], v[60:63]
  s_add_u32 m0, s23, 10240
  s_waitcnt lgkmcnt(0)
  buffer_load_dwordx4 v234, s[4:7], s21 offen lds
  buffer_load_dwordx4 v235, s[8:11], s21 offen offset:1024 lds
  ds_read_b64_tr_b16 v[24:25], v4 offset:0
  ds_read_b64_tr_b16 v[26:27], v4 offset:512
  ds_read_b64_tr_b16 v[28:29], v5 offset:0
  ds_read_b64_tr_b16 v[30:31], v5 offset:512
  v_mfma_f32_16x16x32_bf16 v[96:99], v[132:135], v[32:35], v[96:99]
  v_mfma_f32_16x16x32_bf16 v[100:103], v[132:135], v[36:39], v[100:103]
  v_mfma_f32_16x16x32_bf16 v[116:119], v[136:139], v[40:43], v[116:119]
  v_mfma_f32_16x16x32_bf16 v[120:123], v[136:139], v[44:47], v[120:123]
  ds_read_b128 v[32:35], v7 offset:512
  ds_read_b128 v[36:39], v7 offset:3072
  ds_read_b128 v[40:43], v7 offset:3328
  ds_read_b128 v[44:47], v7 offset:3584
  v_mfma_f32_16x16x32_bf16 v[48:51], v[16:19], v[184:187], v[48:51]
  v_mfma_f32_16x16x32_bf16 v[52:55], v[20:23], v[184:187], v[52:55]
  s_add_u32 m0, s23, 0
  s_waitcnt vmcnt(4) lgkmcnt(0)
  s_mov_b32 s21, 0
  buffer_load_dwordx4 v236, s[4:7], s21 offen lds
  buffer_load_dwordx4 v237, s[8:11], s21 offen offset:1024 lds
  ds_read_b64_tr_b16 v[16:17], v2 offset:4096
  ds_read_b64_tr_b16 v[18:19], v2 offset:4608
  ds_read_b64_tr_b16 v[20:21], v3 offset:4096
  ds_read_b64_tr_b16 v[22:23], v3 offset:4608
  v_mfma_f32_16x16x32_bf16 v[124:127], v[136:139], v[32:35], v[124:127]
  v_mfma_f32_16x16x32_bf16 v[116:119], v[140:143], v[36:39], v[116:119]
  v_mfma_f32_16x16x32_bf16 v[120:123], v[140:143], v[40:43], v[120:123]
  v_mfma_f32_16x16x32_bf16 v[124:127], v[140:143], v[44:47], v[124:127]
  ds_read_b128 v[32:35], v8 offset:18464
  ds_read_b128 v[36:39], v8 offset:18720
  ds_read_b128 v[40:43], v8 offset:18976
  ds_read_b128 v[44:47], v8 offset:21536
  v_mfma_f32_16x16x32_bf16 v[56:59], v[24:27], v[184:187], v[56:59]
  v_mfma_f32_16x16x32_bf16 v[60:63], v[28:31], v[184:187], v[60:63]
  v_xor_b32 v128, 0x80008000, v128
  v_xor_b32 v129, 0x80008000, v129
  v_xor_b32 v130, 0x80008000, v130
  v_xor_b32 v131, 0x80008000, v131
  v_xor_b32 v132, 0x80008000, v132
  v_xor_b32 v133, 0x80008000, v133
  v_xor_b32 v134, 0x80008000, v134
  v_xor_b32 v135, 0x80008000, v135
  s_add_u32 m0, s23, 2048
  s_waitcnt lgkmcnt(0)
  buffer_load_dwordx4 v238, s[4:7], s21 offen lds
  buffer_load_dwordx4 v239, s[8:11], s21 offen offset:1024 lds
  ds_read_b64_tr_b16 v[24:25], v4 offset:4096
  ds_read_b64_tr_b16 v[26:27], v4 offset:4608
  ds_read_b64_tr_b16 v[28:29], v5 offset:4096
  ds_read_b64_tr_b16 v[30:31], v5 offset:4608
  v_mfma_f32_16x16x32_bf16 v[80:83], v[144:147], v[32:35], v[80:83]
  v_mfma_f32_16x16x32_bf16 v[84:87], v[144:147], v[36:39], v[84:87]
  v_mfma_f32_16x16x32_bf16 v[88:91], v[144:147], v[40:43], v[88:91]
  v_mfma_f32_16x16x32_bf16 v[80:83], v[148:151], v[44:47], v[80:83]
  ds_read_b128 v[32:35], v8 offset:21792
  ds_read_b128 v[36:39], v8 offset:22048
  ds_read_b128 v[40:43], v7 offset:18464
  ds_read_b128 v[44:47], v7 offset:18720
  v_mfma_f32_16x16x32_bf16 v[48:51], v[16:19], v[188:191], v[48:51]
  v_mfma_f32_16x16x32_bf16 v[52:55], v[20:23], v[188:191], v[52:55]
  s_add_u32 m0, s23, 4096
  s_waitcnt vmcnt(4) lgkmcnt(0)
  buffer_load_dwordx4 v240, s[4:7], s21 offen lds
  buffer_load_dwordx4 v241, s[8:11], s21 offen offset:1024 lds
  ds_read_b64_tr_b16 v[16:17], v2 offset:8192
  ds_read_b64_tr_b16 v[18:19], v2 offset:8704
  ds_read_b64_tr_b16 v[20:21], v3 offset:8192
  ds_read_b64_tr_b16 v[22:23], v3 offset:8704
  v_mfma_f32_16x16x32_bf16 v[84:87], v[148:151], v[32:35], v[84:87]
  v_mfma_f32_16x16x32_bf16 v[88:91], v[148:151], v[36:39], v[88:91]
  v_mfma_f32_16x16x32_bf16 v[104:107], v[128:131], v[40:43], v[104:107]
  v_mfma_f32_16x16x32_bf16 v[108:111], v[128:131], v[44:47], v[108:111]
  ds_read_b128 v[32:35], v7 offset:18976
  ds_read_b128 v[36:39], v7 offset:21536
  ds_read_b128 v[40:43], v7 offset:21792
  ds_read_b128 v[44:47], v7 offset:22048
  v_mfma_f32_16x16x32_bf16 v[56:59], v[24:27], v[188:191], v[56:59]
  v_mfma_f32_16x16x32_bf16 v[60:63], v[28:31], v[188:191], v[60:63]
  s_add_u32 m0, s23, 6144
  s_waitcnt lgkmcnt(0)
  buffer_load_dwordx4 v242, s[4:7], s21 offen lds
  buffer_load_dwordx4 v243, s[8:11], s21 offen offset:1024 lds
  ds_read_b64_tr_b16 v[24:25], v4 offset:8192
  ds_read_b64_tr_b16 v[26:27], v4 offset:8704
  ds_read_b64_tr_b16 v[28:29], v5 offset:8192
  ds_read_b64_tr_b16 v[30:31], v5 offset:8704
  v_mfma_f32_16x16x32_bf16 v[112:115], v[128:131], v[32:35], v[112:115]
  v_mfma_f32_16x16x32_bf16 v[104:107], v[132:135], v[36:39], v[104:107]
  v_mfma_f32_16x16x32_bf16 v[108:111], v[132:135], v[40:43], v[108:111]
  v_mfma_f32_16x16x32_bf16 v[112:115], v[132:135], v[44:47], v[112:115]
  v_mfma_f32_16x16x32_bf16 v[48:51], v[16:19], v[192:195], v[48:51]
  v_mfma_f32_16x16x32_bf16 v[52:55], v[20:23], v[192:195], v[52:55]
  s_add_u32 m0, s23, 8192
  s_waitcnt lgkmcnt(0)
  v_mfma_f32_16x16x32_bf16 v[56:59], v[24:27], v[192:195], v[56:59]
  v_mfma_f32_16x16x32_bf16 v[60:63], v[28:31], v[192:195], v[60:63]
  s_waitcnt vmcnt(4) lgkmcnt(0)
  buffer_load_dwordx4 v224, s[4:7], s21 offen lds
  buffer_load_dwordx4 v225, s[8:11], s21 offen offset:1024 lds
  ds_read_b64_tr_b16 v[16:17], v2 offset:0
  ds_read_b64_tr_b16 v[18:19], v2 offset:512
  ds_read_b64_tr_b16 v[20:21], v3 offset:0
  ds_read_b64_tr_b16 v[22:23], v3 offset:512
  s_add_u32 s37, s44, 4096
  buffer_load_dwordx4 v[128:131], v10, s[12:15], s44 offen offset:0
  buffer_load_dwordx4 v[132:135], v10, s[12:15], s44 offen offset:1024
  buffer_load_dwordx4 v[136:139], v10, s[12:15], s37 offen offset:0
  buffer_load_dwordx4 v[140:143], v10, s[12:15], s37 offen offset:1024
  s_add_u32 m0, s23, 10240
  v_cvt_pk_bf16_f32 v32, v48, v49
  v_cvt_pk_bf16_f32 v33, v50, v51
  v_cvt_pk_bf16_f32 v34, v52, v53
  v_cvt_pk_bf16_f32 v35, v54, v55
  v_cvt_pk_bf16_f32 v36, v56, v57
  v_cvt_pk_bf16_f32 v37, v58, v59
  v_cvt_pk_bf16_f32 v38, v60, v61
  v_cvt_pk_bf16_f32 v39, v62, v63
  v_cvt_pk_bf16_f32 v40, v64, v65
  v_cvt_pk_bf16_f32 v41, v66, v67
  v_cvt_pk_bf16_f32 v42, v68, v69
  v_cvt_pk_bf16_f32 v43, v70, v71
  v_cvt_pk_bf16_f32 v44, v72, v73
  v_cvt_pk_bf16_f32 v45, v74, v75
  v_cvt_pk_bf16_f32 v46, v76, v77
  v_cvt_pk_bf16_f32 v47, v78, v79
  ds_write_b128 v6, v[32:35] offset:16
  ds_write_b128 v6, v[36:39] offset:3088
  s_mov_b64 exec, s[42:43]
  ds_write_b128 v6, v[40:43] offset:0
  ds_write_b128 v6, v[44:47] offset:3072
  s_mov_b64 exec, -1
  v_subrev_u32 v6, s77, v6
  s_waitcnt lgkmcnt(0)
  buffer_load_dwordx4 v226, s[4:7], s21 offen lds
  buffer_load_dwordx4 v227, s[8:11], s21 offen offset:1024 lds
  ds_read_b64_tr_b16 v[24:25], v4 offset:0
  ds_read_b64_tr_b16 v[26:27], v4 offset:512
  ds_read_b64_tr_b16 v[28:29], v5 offset:0
  ds_read_b64_tr_b16 v[30:31], v5 offset:512
  v_add_u32 v7, s77, v7
  v_add_u32 v8, s77, v8
  v_mfma_f32_16x16x32_bf16 v[48:51], v[16:19], v[176:179], 0
  v_mfma_f32_16x16x32_bf16 v[52:55], v[20:23], v[176:179], 0
  v_mfma_f32_16x16x32_bf16 v[64:67], v[16:19], v[200:203], 0
  v_mfma_f32_16x16x32_bf16 v[68:71], v[20:23], v[200:203], 0
  s_add_u32 m0, s23, 0
  s_waitcnt vmcnt(8) lgkmcnt(0)
  buffer_load_dwordx4 v228, s[4:7], s21 offen lds
  buffer_load_dwordx4 v229, s[8:11], s21 offen offset:1024 lds
  ds_read_b64_tr_b16 v[16:17], v2 offset:4096
  ds_read_b64_tr_b16 v[18:19], v2 offset:4608
  ds_read_b64_tr_b16 v[20:21], v3 offset:4096
  ds_read_b64_tr_b16 v[22:23], v3 offset:4608
  v_mfma_f32_16x16x32_bf16 v[56:59], v[24:27], v[176:179], 0
  v_mfma_f32_16x16x32_bf16 v[60:63], v[28:31], v[176:179], 0
  v_mfma_f32_16x16x32_bf16 v[72:75], v[24:27], v[200:203], 0
  v_mfma_f32_16x16x32_bf16 v[76:79], v[28:31], v[200:203], 0
  s_add_u32 m0, s23, 2048
  s_waitcnt lgkmcnt(0)
  s_barrier
  buffer_load_dwordx4 v230, s[4:7], s21 offen lds
  buffer_load_dwordx4 v231, s[8:11], s21 offen offset:1024 lds
  ds_read_b64_tr_b16 v[24:25], v4 offset:4096
  ds_read_b64_tr_b16 v[26:27], v4 offset:4608
  ds_read_b64_tr_b16 v[28:29], v5 offset:4096
  ds_read_b64_tr_b16 v[30:31], v5 offset:4608
  ds_read_b128 v[32:35], v8 offset:0
  ds_read_b128 v[36:39], v8 offset:256
  ds_read_b128 v[40:43], v8 offset:512
  ds_read_b128 v[44:47], v8 offset:3072
  v_mfma_f32_16x16x32_bf16 v[48:51], v[16:19], v[180:183], v[48:51]
  v_mfma_f32_16x16x32_bf16 v[52:55], v[20:23], v[180:183], v[52:55]
  s_add_u32 m0, s23, 4096
  s_waitcnt vmcnt(4) lgkmcnt(0)
  buffer_load_dwordx4 v232, s[4:7], s21 offen lds
  buffer_load_dwordx4 v233, s[8:11], s21 offen offset:1024 lds
  ds_read_b64_tr_b16 v[16:17], v2 offset:8192
  ds_read_b64_tr_b16 v[18:19], v2 offset:8704
  ds_read_b64_tr_b16 v[20:21], v3 offset:8192
  ds_read_b64_tr_b16 v[22:23], v3 offset:8704
  v_mfma_f32_16x16x32_bf16 v[92:95], v[152:155], v[32:35], v[92:95]
  v_mfma_f32_16x16x32_bf16 v[96:99], v[152:155], v[36:39], v[96:99]
  v_mfma_f32_16x16x32_bf16 v[100:103], v[152:155], v[40:43], v[100:103]
  v_mfma_f32_16x16x32_bf16 v[92:95], v[156:159], v[44:47], v[92:95]
  ds_read_b128 v[32:35], v8 offset:3328
  ds_read_b128 v[36:39], v8 offset:3584
  ds_read_b128 v[40:43], v7 offset:0
  ds_read_b128 v[44:47], v7 offset:256
  v_mfma_f32_16x16x32_bf16 v[56:59], v[24:27], v[180:183], v[56:59]
  v_mfma_f32_16x16x32_bf16 v[60:63], v[28:31], v[180:183], v[60:63]
  s_add_u32 m0, s23, 6144
  s_waitcnt lgkmcnt(0)
  buffer_load_dwordx4 v234, s[4:7], s21 offen lds
  buffer_load_dwordx4 v235, s[8:11], s21 offen offset:1024 lds
  ds_read_b64_tr_b16 v[24:25], v4 offset:8192
  ds_read_b64_tr_b16 v[26:27], v4 offset:8704
  ds_read_b64_tr_b16 v[28:29], v5 offset:8192
  ds_read_b64_tr_b16 v[30:31], v5 offset:8704
  v_mfma_f32_16x16x32_bf16 v[96:99], v[156:159], v[32:35], v[96:99]
  v_mfma_f32_16x16x32_bf16 v[100:103], v[156:159], v[36:39], v[100:103]
  v_mfma_f32_16x16x32_bf16 v[116:119], v[160:163], v[40:43], v[116:119]
  v_mfma_f32_16x16x32_bf16 v[120:123], v[160:163], v[44:47], v[120:123]
  ds_read_b128 v[32:35], v7 offset:512
  ds_read_b128 v[36:39], v7 offset:3072
  ds_read_b128 v[40:43], v7 offset:3328
  ds_read_b128 v[44:47], v7 offset:3584
  v_mfma_f32_16x16x32_bf16 v[48:51], v[16:19], v[184:187], v[48:51]
  v_mfma_f32_16x16x32_bf16 v[52:55], v[20:23], v[184:187], v[52:55]
  s_add_u32 m0, s23, 8192
  s_waitcnt vmcnt(4) lgkmcnt(0)
  s_mov_b32 s21, 128
  buffer_load_dwordx4 v236, s[4:7], s21 offen lds
  buffer_load_dwordx4 v237, s[8:11], s21 offen offset:1024 lds
  ds_read_b64_tr_b16 v[16:17], v2 offset:0
  ds_read_b64_tr_b16 v[18:19], v2 offset:512
  ds_read_b64_tr_b16 v[20:21], v3 offset:0
  ds_read_b64_tr_b16 v[22:23], v3 offset:512
  v_mfma_f32_16x16x32_bf16 v[124:127], v[160:163], v[32:35], v[124:127]
  v_mfma_f32_16x16x32_bf16 v[116:119], v[164:167], v[36:39], v[116:119]
  v_mfma_f32_16x16x32_bf16 v[120:123], v[164:167], v[40:43], v[120:123]
  v_mfma_f32_16x16x32_bf16 v[124:127], v[164:167], v[44:47], v[124:127]
  ds_read_b128 v[32:35], v8 offset:18464
  ds_read_b128 v[36:39], v8 offset:18720
  ds_read_b128 v[40:43], v8 offset:18976
  ds_read_b128 v[44:47], v8 offset:21536
  v_mfma_f32_16x16x32_bf16 v[56:59], v[24:27], v[184:187], v[56:59]
  v_mfma_f32_16x16x32_bf16 v[60:63], v[28:31], v[184:187], v[60:63]
  v_xor_b32 v152, 0x80008000, v152
  v_xor_b32 v153, 0x80008000, v153
  v_xor_b32 v154, 0x80008000, v154
  v_xor_b32 v155, 0x80008000, v155
  v_xor_b32 v156, 0x80008000, v156
  v_xor_b32 v157, 0x80008000, v157
  v_xor_b32 v158, 0x80008000, v158
  v_xor_b32 v159, 0x80008000, v159
  s_add_u32 m0, s23, 10240
  s_waitcnt lgkmcnt(0)
  buffer_load_dwordx4 v238, s[4:7], s21 offen lds
  buffer_load_dwordx4 v239, s[8:11], s21 offen offset:1024 lds
  ds_read_b64_tr_b16 v[24:25], v4 offset:0
  ds_read_b64_tr_b16 v[26:27], v4 offset:512
  ds_read_b64_tr_b16 v[28:29], v5 offset:0
  ds_read_b64_tr_b16 v[30:31], v5 offset:512
  v_mfma_f32_16x16x32_bf16 v[80:83], v[168:171], v[32:35], v[80:83]
  v_mfma_f32_16x16x32_bf16 v[84:87], v[168:171], v[36:39], v[84:87]
  v_mfma_f32_16x16x32_bf16 v[88:91], v[168:171], v[40:43], v[88:91]
  v_mfma_f32_16x16x32_bf16 v[80:83], v[172:175], v[44:47], v[80:83]
  ds_read_b128 v[32:35], v8 offset:21792
  ds_read_b128 v[36:39], v8 offset:22048
  ds_read_b128 v[40:43], v7 offset:18464
  ds_read_b128 v[44:47], v7 offset:18720
  v_mfma_f32_16x16x32_bf16 v[48:51], v[16:19], v[188:191], v[48:51]
  v_mfma_f32_16x16x32_bf16 v[52:55], v[20:23], v[188:191], v[52:55]
  s_add_u32 m0, s23, 0
  s_waitcnt vmcnt(4) lgkmcnt(0)
  buffer_load_dwordx4 v240, s[4:7], s21 offen lds
  buffer_load_dwordx4 v241, s[8:11], s21 offen offset:1024 lds
  ds_read_b64_tr_b16 v[16:17], v2 offset:4096
  ds_read_b64_tr_b16 v[18:19], v2 offset:4608
  ds_read_b64_tr_b16 v[20:21], v3 offset:4096
  ds_read_b64_tr_b16 v[22:23], v3 offset:4608
  v_mfma_f32_16x16x32_bf16 v[84:87], v[172:175], v[32:35], v[84:87]
  v_mfma_f32_16x16x32_bf16 v[88:91], v[172:175], v[36:39], v[88:91]
  v_mfma_f32_16x16x32_bf16 v[104:107], v[152:155], v[40:43], v[104:107]
  v_mfma_f32_16x16x32_bf16 v[108:111], v[152:155], v[44:47], v[108:111]
  ds_read_b128 v[32:35], v7 offset:18976
  ds_read_b128 v[36:39], v7 offset:21536
  ds_read_b128 v[40:43], v7 offset:21792
  ds_read_b128 v[44:47], v7 offset:22048
  v_mfma_f32_16x16x32_bf16 v[56:59], v[24:27], v[188:191], v[56:59]
  v_mfma_f32_16x16x32_bf16 v[60:63], v[28:31], v[188:191], v[60:63]
  s_add_u32 m0, s23, 2048
  s_waitcnt lgkmcnt(0)
  buffer_load_dwordx4 v242, s[4:7], s21 offen lds
  buffer_load_dwordx4 v243, s[8:11], s21 offen offset:1024 lds
  ds_read_b64_tr_b16 v[24:25], v4 offset:4096
  ds_read_b64_tr_b16 v[26:27], v4 offset:4608
  ds_read_b64_tr_b16 v[28:29], v5 offset:4096
  ds_read_b64_tr_b16 v[30:31], v5 offset:4608
  v_mfma_f32_16x16x32_bf16 v[112:115], v[152:155], v[32:35], v[112:115]
  v_mfma_f32_16x16x32_bf16 v[104:107], v[156:159], v[36:39], v[104:107]
  v_mfma_f32_16x16x32_bf16 v[108:111], v[156:159], v[40:43], v[108:111]
  v_mfma_f32_16x16x32_bf16 v[112:115], v[156:159], v[44:47], v[112:115]
  v_mfma_f32_16x16x32_bf16 v[48:51], v[16:19], v[192:195], v[48:51]
  v_mfma_f32_16x16x32_bf16 v[52:55], v[20:23], v[192:195], v[52:55]
  s_add_u32 m0, s23, 4096
  s_waitcnt lgkmcnt(0)
  v_mfma_f32_16x16x32_bf16 v[56:59], v[24:27], v[192:195], v[56:59]
  v_mfma_f32_16x16x32_bf16 v[60:63], v[28:31], v[192:195], v[60:63]
  s_waitcnt vmcnt(4) lgkmcnt(0)
  buffer_load_dwordx4 v224, s[4:7], s21 offen lds
  buffer_load_dwordx4 v225, s[8:11], s21 offen offset:1024 lds
  ds_read_b64_tr_b16 v[16:17], v2 offset:8192
  ds_read_b64_tr_b16 v[18:19], v2 offset:8704
  ds_read_b64_tr_b16 v[20:21], v3 offset:8192
  ds_read_b64_tr_b16 v[22:23], v3 offset:8704
  s_add_u32 s37, s44, 4096
  buffer_load_dwordx4 v[152:155], v10, s[12:15], s44 offen offset:2048
  buffer_load_dwordx4 v[156:159], v10, s[12:15], s44 offen offset:3072
  buffer_load_dwordx4 v[160:163], v10, s[12:15], s37 offen offset:2048
  buffer_load_dwordx4 v[164:167], v10, s[12:15], s37 offen offset:3072
  s_add_u32 m0, s23, 6144
  v_cvt_pk_bf16_f32 v32, v48, v49
  v_cvt_pk_bf16_f32 v33, v50, v51
  v_cvt_pk_bf16_f32 v34, v52, v53
  v_cvt_pk_bf16_f32 v35, v54, v55
  v_cvt_pk_bf16_f32 v36, v56, v57
  v_cvt_pk_bf16_f32 v37, v58, v59
  v_cvt_pk_bf16_f32 v38, v60, v61
  v_cvt_pk_bf16_f32 v39, v62, v63
  v_cvt_pk_bf16_f32 v40, v64, v65
  v_cvt_pk_bf16_f32 v41, v66, v67
  v_cvt_pk_bf16_f32 v42, v68, v69
  v_cvt_pk_bf16_f32 v43, v70, v71
  v_cvt_pk_bf16_f32 v44, v72, v73
  v_cvt_pk_bf16_f32 v45, v74, v75
  v_cvt_pk_bf16_f32 v46, v76, v77
  v_cvt_pk_bf16_f32 v47, v78, v79
  ds_write_b128 v6, v[32:35] offset:16
  ds_write_b128 v6, v[36:39] offset:3088
  s_mov_b64 exec, s[42:43]
  ds_write_b128 v6, v[40:43] offset:0
  ds_write_b128 v6, v[44:47] offset:3072
  s_mov_b64 exec, -1
  v_add_u32 v6, s77, v6
  s_waitcnt lgkmcnt(0)
  buffer_load_dwordx4 v226, s[4:7], s21 offen lds
  buffer_load_dwordx4 v227, s[8:11], s21 offen offset:1024 lds
  ds_read_b64_tr_b16 v[24:25], v4 offset:8192
  ds_read_b64_tr_b16 v[26:27], v4 offset:8704
  ds_read_b64_tr_b16 v[28:29], v5 offset:8192
  ds_read_b64_tr_b16 v[30:31], v5 offset:8704
  v_subrev_u32 v7, s77, v7
  v_subrev_u32 v8, s77, v8
  v_mfma_f32_16x16x32_bf16 v[48:51], v[16:19], v[176:179], 0
  v_mfma_f32_16x16x32_bf16 v[52:55], v[20:23], v[176:179], 0
  v_mfma_f32_16x16x32_bf16 v[64:67], v[16:19], v[200:203], 0
  v_mfma_f32_16x16x32_bf16 v[68:71], v[20:23], v[200:203], 0
  s_add_u32 m0, s23, 8192
  s_waitcnt vmcnt(8) lgkmcnt(0)
  buffer_load_dwordx4 v228, s[4:7], s21 offen lds
  buffer_load_dwordx4 v229, s[8:11], s21 offen offset:1024 lds
  ds_read_b64_tr_b16 v[16:17], v2 offset:0
  ds_read_b64_tr_b16 v[18:19], v2 offset:512
  ds_read_b64_tr_b16 v[20:21], v3 offset:0
  ds_read_b64_tr_b16 v[22:23], v3 offset:512
  v_mfma_f32_16x16x32_bf16 v[56:59], v[24:27], v[176:179], 0
  v_mfma_f32_16x16x32_bf16 v[60:63], v[28:31], v[176:179], 0
  v_mfma_f32_16x16x32_bf16 v[72:75], v[24:27], v[200:203], 0
  v_mfma_f32_16x16x32_bf16 v[76:79], v[28:31], v[200:203], 0
  s_add_u32 m0, s23, 10240
  s_waitcnt lgkmcnt(0)
  s_barrier
  buffer_load_dwordx4 v230, s[4:7], s21 offen lds
  buffer_load_dwordx4 v231, s[8:11], s21 offen offset:1024 lds
  ds_read_b64_tr_b16 v[24:25], v4 offset:0
  ds_read_b64_tr_b16 v[26:27], v4 offset:512
  ds_read_b64_tr_b16 v[28:29], v5 offset:0
  ds_read_b64_tr_b16 v[30:31], v5 offset:512
  ds_read_b128 v[32:35], v7 offset:0
  ds_read_b128 v[36:39], v7 offset:256
  ds_read_b128 v[40:43], v7 offset:512
  ds_read_b128 v[44:47], v7 offset:3072
  v_mfma_f32_16x16x32_bf16 v[48:51], v[16:19], v[180:183], v[48:51]
  v_mfma_f32_16x16x32_bf16 v[52:55], v[20:23], v[180:183], v[52:55]
  s_add_u32 m0, s23, 0
  s_waitcnt vmcnt(4) lgkmcnt(0)
  buffer_load_dwordx4 v232, s[4:7], s21 offen lds
  buffer_load_dwordx4 v233, s[8:11], s21 offen offset:1024 lds
  ds_read_b64_tr_b16 v[16:17], v2 offset:4096
  ds_read_b64_tr_b16 v[18:19], v2 offset:4608
  ds_read_b64_tr_b16 v[20:21], v3 offset:4096
  ds_read_b64_tr_b16 v[22:23], v3 offset:4608
  v_mfma_f32_16x16x32_bf16 v[80:83], v[128:131], v[32:35], v[80:83]
  v_mfma_f32_16x16x32_bf16 v[84:87], v[128:131], v[36:39], v[84:87]
  v_mfma_f32_16x16x32_bf16 v[88:91], v[128:131], v[40:43], v[88:91]
  v_mfma_f32_16x16x32_bf16 v[80:83], v[132:135], v[44:47], v[80:83]
  ds_read_b128 v[32:35], v7 offset:3328
  ds_read_b128 v[36:39], v7 offset:3584
  ds_read_b128 v[40:43], v7 offset:18464
  ds_read_b128 v[44:47], v7 offset:18720
  v_mfma_f32_16x16x32_bf16 v[56:59], v[24:27], v[180:183], v[56:59]
  v_mfma_f32_16x16x32_bf16 v[60:63], v[28:31], v[180:183], v[60:63]
  s_add_u32 m0, s23, 2048
  s_waitcnt lgkmcnt(0)
  buffer_load_dwordx4 v234, s[4:7], s21 offen lds
  buffer_load_dwordx4 v235, s[8:11], s21 offen offset:1024 lds
  ds_read_b64_tr_b16 v[24:25], v4 offset:4096
  ds_read_b64_tr_b16 v[26:27], v4 offset:4608
  ds_read_b64_tr_b16 v[28:29], v5 offset:4096
  ds_read_b64_tr_b16 v[30:31], v5 offset:4608
  v_mfma_f32_16x16x32_bf16 v[84:87], v[132:135], v[32:35], v[84:87]
  v_mfma_f32_16x16x32_bf16 v[88:91], v[132:135], v[36:39], v[88:91]
  v_mfma_f32_16x16x32_bf16 v[92:95], v[136:139], v[40:43], v[92:95]
  v_mfma_f32_16x16x32_bf16 v[96:99], v[136:139], v[44:47], v[96:99]
  ds_read_b128 v[32:35], v7 offset:18976
  ds_read_b128 v[36:39], v7 offset:21536
  ds_read_b128 v[40:43], v7 offset:21792
  ds_read_b128 v[44:47], v7 offset:22048
  v_mfma_f32_16x16x32_bf16 v[48:51], v[16:19], v[184:187], v[48:51]
  v_mfma_f32_16x16x32_bf16 v[52:55], v[20:23], v[184:187], v[52:55]
  s_waitcnt vmcnt(4) lgkmcnt(0)
  ds_read_b64_tr_b16 v[16:17], v2 offset:8192
  ds_read_b64_tr_b16 v[18:19], v2 offset:8704
  ds_read_b64_tr_b16 v[20:21], v3 offset:8192
  ds_read_b64_tr_b16 v[22:23], v3 offset:8704
  v_mfma_f32_16x16x32_bf16 v[100:103], v[136:139], v[32:35], v[100:103]
  v_mfma_f32_16x16x32_bf16 v[92:95], v[140:143], v[36:39], v[92:95]
  v_mfma_f32_16x16x32_bf16 v[96:99], v[140:143], v[40:43], v[96:99]
  v_mfma_f32_16x16x32_bf16 v[100:103], v[140:143], v[44:47], v[100:103]
  ds_read_b128 v[32:35], v8 offset:0
  ds_read_b128 v[36:39], v8 offset:256
  ds_read_b128 v[40:43], v8 offset:512
  ds_read_b128 v[44:47], v8 offset:3072
  v_mfma_f32_16x16x32_bf16 v[56:59], v[24:27], v[184:187], v[56:59]
  v_mfma_f32_16x16x32_bf16 v[60:63], v[28:31], v[184:187], v[60:63]
  s_waitcnt lgkmcnt(0)
  ds_read_b64_tr_b16 v[24:25], v4 offset:8192
  ds_read_b64_tr_b16 v[26:27], v4 offset:8704
  ds_read_b64_tr_b16 v[28:29], v5 offset:8192
  ds_read_b64_tr_b16 v[30:31], v5 offset:8704
  v_mfma_f32_16x16x32_bf16 v[104:107], v[136:139], v[32:35], v[104:107]
  v_mfma_f32_16x16x32_bf16 v[108:111], v[136:139], v[36:39], v[108:111]
  v_mfma_f32_16x16x32_bf16 v[112:115], v[136:139], v[40:43], v[112:115]
  v_mfma_f32_16x16x32_bf16 v[104:107], v[140:143], v[44:47], v[104:107]
  ds_read_b128 v[32:35], v8 offset:3328
  ds_read_b128 v[36:39], v8 offset:3584
  ds_read_b128 v[40:43], v8 offset:18464
  ds_read_b128 v[44:47], v8 offset:18720
  v_mfma_f32_16x16x32_bf16 v[48:51], v[16:19], v[188:191], v[48:51]
  v_mfma_f32_16x16x32_bf16 v[52:55], v[20:23], v[188:191], v[52:55]
  s_waitcnt vmcnt(0) lgkmcnt(0)
  ds_read_b64_tr_b16 v[16:17], v2 offset:0
  ds_read_b64_tr_b16 v[18:19], v2 offset:512
  ds_read_b64_tr_b16 v[20:21], v3 offset:0
  ds_read_b64_tr_b16 v[22:23], v3 offset:512
  v_mfma_f32_16x16x32_bf16 v[108:111], v[140:143], v[32:35], v[108:111]
  v_mfma_f32_16x16x32_bf16 v[112:115], v[140:143], v[36:39], v[112:115]
  v_mfma_f32_16x16x32_bf16 v[116:119], v[136:139], v[40:43], v[116:119]
  v_mfma_f32_16x16x32_bf16 v[120:123], v[136:139], v[44:47], v[120:123]
  ds_read_b128 v[32:35], v8 offset:18976
  ds_read_b128 v[36:39], v8 offset:21536
  ds_read_b128 v[40:43], v8 offset:21792
  ds_read_b128 v[44:47], v8 offset:22048
  v_mfma_f32_16x16x32_bf16 v[56:59], v[24:27], v[188:191], v[56:59]
  v_mfma_f32_16x16x32_bf16 v[60:63], v[28:31], v[188:191], v[60:63]
  s_waitcnt lgkmcnt(0)
  ds_read_b64_tr_b16 v[24:25], v4 offset:0
  ds_read_b64_tr_b16 v[26:27], v4 offset:512
  ds_read_b64_tr_b16 v[28:29], v5 offset:0
  ds_read_b64_tr_b16 v[30:31], v5 offset:512
  v_mfma_f32_16x16x32_bf16 v[124:127], v[136:139], v[32:35], v[124:127]
  v_mfma_f32_16x16x32_bf16 v[116:119], v[140:143], v[36:39], v[116:119]
  v_mfma_f32_16x16x32_bf16 v[120:123], v[140:143], v[40:43], v[120:123]
  v_mfma_f32_16x16x32_bf16 v[124:127], v[140:143], v[44:47], v[124:127]
  v_mfma_f32_16x16x32_bf16 v[48:51], v[16:19], v[192:195], v[48:51]
  v_mfma_f32_16x16x32_bf16 v[52:55], v[20:23], v[192:195], v[52:55]
  s_waitcnt lgkmcnt(0)
  v_mfma_f32_16x16x32_bf16 v[56:59], v[24:27], v[192:195], v[56:59]
  v_mfma_f32_16x16x32_bf16 v[60:63], v[28:31], v[192:195], v[60:63]
  s_branch K2_TAIL
K2_V6:
  v_mov_b32 v240, v16
  v_mov_b32 v241, v17
  v_mov_b32 v242, v18
  v_mov_b32 v243, v19
  v_mov_b32 v244, v20
  v_mov_b32 v245, v21
  v_mov_b32 v246, v22
  v_mov_b32 v247, v23
  s_waitcnt lgkmcnt(0)
  buffer_load_dwordx4 v22, s[4:7], s21 offen lds
  buffer_load_dwordx4 v23, s[8:11], s21 offen offset:1024 lds
  s_add_u32 m0, s23, 8192
  s_lshl_b32 s46, s3, 3
  v_readlane_b32 s72, v254, s46
  s_add_u32 s46, s46, 1
  v_readlane_b32 s73, v254, s46
  s_add_u32 s46, s46, 1
  v_readlane_b32 s74, v254, s46
  s_add_u32 s46, s46, 1
  v_readlane_b32 s75, v254, s46
  s_add_u32 s46, s46, 1
  v_readlane_b32 s76, v254, s46
  s_mul_i32 s46, s2, 625
  s_add_u32 s45, s46, 15
  s_lshr_b32 s45, s45, 4
  s_add_u32 s46, s46, 640
  s_lshr_b32 s46, s46, 4
  s_sub_u32 s46, s46, s45
  s_mov_b32 s81, 0
  s_cmp_lt_u32 s72, s46
  s_cselect_b32 s47, 1, 0
  s_or_b32 s81, s81, s47
  s_cmp_lt_u32 s73, s46
  s_cselect_b32 s47, 2, 0
  s_or_b32 s81, s81, s47
  s_cmp_lt_u32 s74, s46
  s_cselect_b32 s47, 4, 0
  s_or_b32 s81, s81, s47
  s_cmp_lt_u32 s75, s46
  s_cselect_b32 s47, 8, 0
  s_or_b32 s81, s81, s47
  s_cmp_lt_u32 s76, s46
  s_cselect_b32 s47, 16, 0
  s_or_b32 s81, s81, s47
  s_add_u32 s72, s72, s45
  s_lshl_b32 s72, s72, 10
  s_add_u32 s73, s73, s45
  s_lshl_b32 s73, s73, 10
  s_add_u32 s74, s74, s45
  s_lshl_b32 s74, s74, 10
  s_add_u32 s75, s75, s45
  s_lshl_b32 s75, s75, 10
  s_add_u32 s76, s76, s45
  s_lshl_b32 s76, s76, 10
  s_waitcnt vmcnt(4) lgkmcnt(0)
  buffer_load_dwordx4 v224, s[4:7], s21 offen lds
  buffer_load_dwordx4 v225, s[8:11], s21 offen offset:1024 lds
  ds_read_b64_tr_b16 v[16:17], v2 offset:0
  ds_read_b64_tr_b16 v[18:19], v2 offset:512
  ds_read_b64_tr_b16 v[20:21], v3 offset:0
  ds_read_b64_tr_b16 v[22:23], v3 offset:512
  s_add_u32 m0, s23, 10240
  s_waitcnt lgkmcnt(0)
  buffer_load_dwordx4 v226, s[4:7], s21 offen lds
  buffer_load_dwordx4 v227, s[8:11], s21 offen offset:1024 lds
  ds_read_b64_tr_b16 v[24:25], v4 offset:0
  ds_read_b64_tr_b16 v[26:27], v4 offset:512
  ds_read_b64_tr_b16 v[28:29], v5 offset:0
  ds_read_b64_tr_b16 v[30:31], v5 offset:512
  v_mfma_f32_16x16x32_bf16 v[48:51], v[16:19], v[176:179], 0
  v_mfma_f32_16x16x32_bf16 v[52:55], v[20:23], v[176:179], 0
  v_mfma_f32_16x16x32_bf16 v[64:67], v[16:19], v[200:203], 0
  v_mfma_f32_16x16x32_bf16 v[68:71], v[20:23], v[200:203], 0
  s_add_u32 m0, s23, 0
  s_waitcnt vmcnt(4) lgkmcnt(0)
  buffer_load_dwordx4 v228, s[4:7], s21 offen lds
  buffer_load_dwordx4 v229, s[8:11], s21 offen offset:1024 lds
  ds_read_b64_tr_b16 v[16:17], v2 offset:4096
  ds_read_b64_tr_b16 v[18:19], v2 offset:4608
  ds_read_b64_tr_b16 v[20:21], v3 offset:4096
  ds_read_b64_tr_b16 v[22:23], v3 offset:4608
  v_mfma_f32_16x16x32_bf16 v[56:59], v[24:27], v[176:179], 0
  v_mfma_f32_16x16x32_bf16 v[60:63], v[28:31], v[176:179], 0
  v_mfma_f32_16x16x32_bf16 v[72:75], v[24:27], v[200:203], 0
  v_mfma_f32_16x16x32_bf16 v[76:79], v[28:31], v[200:203], 0
  s_add_u32 m0, s23, 2048
  s_waitcnt lgkmcnt(0)
  s_barrier
  buffer_load_dwordx4 v230, s[4:7], s21 offen lds
  buffer_load_dwordx4 v231, s[8:11], s21 offen offset:1024 lds
  ds_read_b64_tr_b16 v[24:25], v4 offset:4096
  ds_read_b64_tr_b16 v[26:27], v4 offset:4608
  ds_read_b64_tr_b16 v[28:29], v5 offset:4096
  ds_read_b64_tr_b16 v[30:31], v5 offset:4608
  v_mfma_f32_16x16x32_bf16 v[48:51], v[16:19], v[180:183], v[48:51]
  v_mfma_f32_16x16x32_bf16 v[52:55], v[20:23], v[180:183], v[52:55]
  s_add_u32 m0, s23, 4096
  s_waitcnt vmcnt(4) lgkmcnt(0)
  buffer_load_dwordx4 v232, s[4:7], s21 offen lds
  buffer_load_dwordx4 v233, s[8:11], s21 offen offset:1024 lds
  ds_read_b64_tr_b16 v[16:17], v2 offset:8192
  ds_read_b64_tr_b16 v[18:19], v2 offset:8704
  ds_read_b64_tr_b16 v[20:21], v3 offset:8192
  ds_read_b64_tr_b16 v[22:23], v3 offset:8704
  v_mfma_f32_16x16x32_bf16 v[56:59], v[24:27], v[180:183], v[56:59]
  v_mfma_f32_16x16x32_bf16 v[60:63], v[28:31], v[180:183], v[60:63]
  s_add_u32 m0, s23, 6144
  s_waitcnt lgkmcnt(0)
  buffer_load_dwordx4 v234, s[4:7], s21 offen lds
  buffer_load_dwordx4 v235, s[8:11], s21 offen offset:1024 lds
  ds_read_b64_tr_b16 v[24:25], v4 offset:8192
  ds_read_b64_tr_b16 v[26:27], v4 offset:8704
  ds_read_b64_tr_b16 v[28:29], v5 offset:8192
  ds_read_b64_tr_b16 v[30:31], v5 offset:8704
  v_mfma_f32_16x16x32_bf16 v[48:51], v[16:19], v[184:187], v[48:51]
  v_mfma_f32_16x16x32_bf16 v[52:55], v[20:23], v[184:187], v[52:55]
  s_add_u32 m0, s23, 8192
  s_waitcnt vmcnt(4) lgkmcnt(0)
  buffer_load_dwordx4 v236, s[4:7], s21 offen lds
  buffer_load_dwordx4 v237, s[8:11], s21 offen offset:1024 lds
  ds_read_b64_tr_b16 v[16:17], v2 offset:0
  ds_read_b64_tr_b16 v[18:19], v2 offset:512
  ds_read_b64_tr_b16 v[20:21], v3 offset:0
  ds_read_b64_tr_b16 v[22:23], v3 offset:512
  v_mfma_f32_16x16x32_bf16 v[56:59], v[24:27], v[184:187], v[56:59]
  v_mfma_f32_16x16x32_bf16 v[60:63], v[28:31], v[184:187], v[60:63]
  s_add_u32 m0, s23, 10240
  s_waitcnt lgkmcnt(0)
  buffer_load_dwordx4 v238, s[4:7], s21 offen lds
  buffer_load_dwordx4 v239, s[8:11], s21 offen offset:1024 lds
  ds_read_b64_tr_b16 v[24:25], v4 offset:0
  ds_read_b64_tr_b16 v[26:27], v4 offset:512
  ds_read_b64_tr_b16 v[28:29], v5 offset:0
  ds_read_b64_tr_b16 v[30:31], v5 offset:512
  v_mfma_f32_16x16x32_bf16 v[48:51], v[16:19], v[188:191], v[48:51]
  v_mfma_f32_16x16x32_bf16 v[52:55], v[20:23], v[188:191], v[52:55]
  s_add_u32 m0, s23, 0
  s_waitcnt vmcnt(4) lgkmcnt(0)
  s_mov_b32 s21, 256
  buffer_load_dwordx4 v240, s[4:7], s21 offen lds
  buffer_load_dwordx4 v241, s[8:11], s21 offen offset:1024 lds
  ds_read_b64_tr_b16 v[16:17], v2 offset:4096
  ds_read_b64_tr_b16 v[18:19], v2 offset:4608
  ds_read_b64_tr_b16 v[20:21], v3 offset:4096
  ds_read_b64_tr_b16 v[22:23], v3 offset:4608
  v_mfma_f32_16x16x32_bf16 v[56:59], v[24:27], v[188:191], v[56:59]
  v_mfma_f32_16x16x32_bf16 v[60:63], v[28:31], v[188:191], v[60:63]
  s_add_u32 m0, s23, 2048
  s_waitcnt lgkmcnt(0)
  buffer_load_dwordx4 v242, s[4:7], s21 offen lds
  buffer_load_dwordx4 v243, s[8:11], s21 offen offset:1024 lds
  ds_read_b64_tr_b16 v[24:25], v4 offset:4096
  ds_read_b64_tr_b16 v[26:27], v4 offset:4608
  ds_read_b64_tr_b16 v[28:29], v5 offset:4096
  ds_read_b64_tr_b16 v[30:31], v5 offset:4608
  v_mfma_f32_16x16x32_bf16 v[48:51], v[16:19], v[192:195], v[48:51]
  v_mfma_f32_16x16x32_bf16 v[52:55], v[20:23], v[192:195], v[52:55]
  s_add_u32 m0, s23, 4096
  s_waitcnt vmcnt(4) lgkmcnt(0)
  buffer_load_dwordx4 v244, s[4:7], s21 offen lds
  buffer_load_dwordx4 v245, s[8:11], s21 offen offset:1024 lds
  ds_read_b64_tr_b16 v[16:17], v2 offset:8192
  ds_read_b64_tr_b16 v[18:19], v2 offset:8704
  ds_read_b64_tr_b16 v[20:21], v3 offset:8192
  ds_read_b64_tr_b16 v[22:23], v3 offset:8704
  v_mfma_f32_16x16x32_bf16 v[56:59], v[24:27], v[192:195], v[56:59]
  v_mfma_f32_16x16x32_bf16 v[60:63], v[28:31], v[192:195], v[60:63]
  s_add_u32 m0, s23, 6144
  s_waitcnt lgkmcnt(0)
  buffer_load_dwordx4 v246, s[4:7], s21 offen lds
  buffer_load_dwordx4 v247, s[8:11], s21 offen offset:1024 lds
  ds_read_b64_tr_b16 v[24:25], v4 offset:8192
  ds_read_b64_tr_b16 v[26:27], v4 offset:8704
  ds_read_b64_tr_b16 v[28:29], v5 offset:8192
  ds_read_b64_tr_b16 v[30:31], v5 offset:8704
  v_mfma_f32_16x16x32_bf16 v[48:51], v[16:19], v[196:199], v[48:51]
  v_mfma_f32_16x16x32_bf16 v[52:55], v[20:23], v[196:199], v[52:55]
  s_add_u32 m0, s23, 8192
  s_waitcnt lgkmcnt(0)
  v_mfma_f32_16x16x32_bf16 v[56:59], v[24:27], v[196:199], v[56:59]
  v_mfma_f32_16x16x32_bf16 v[60:63], v[28:31], v[196:199], v[60:63]
  s_waitcnt vmcnt(4) lgkmcnt(0)
  buffer_load_dwordx4 v224, s[4:7], s21 offen lds
  buffer_load_dwordx4 v225, s[8:11], s21 offen offset:1024 lds
  ds_read_b64_tr_b16 v[16:17], v2 offset:0
  ds_read_b64_tr_b16 v[18:19], v2 offset:512
  ds_read_b64_tr_b16 v[20:21], v3 offset:0
  ds_read_b64_tr_b16 v[22:23], v3 offset:512
  s_add_u32 m0, s23, 10240
  s_nop 0
  v_cvt_pk_bf16_f32 v32, v48, v49
  v_cvt_pk_bf16_f32 v33, v50, v51
  v_cvt_pk_bf16_f32 v34, v52, v53
  v_cvt_pk_bf16_f32 v35, v54, v55
  v_cvt_pk_bf16_f32 v36, v56, v57
  v_cvt_pk_bf16_f32 v37, v58, v59
  v_cvt_pk_bf16_f32 v38, v60, v61
  v_cvt_pk_bf16_f32 v39, v62, v63
  v_cvt_pk_bf16_f32 v40, v64, v65
  v_cvt_pk_bf16_f32 v41, v66, v67
  v_cvt_pk_bf16_f32 v42, v68, v69
  v_cvt_pk_bf16_f32 v43, v70, v71
  v_cvt_pk_bf16_f32 v44, v72, v73
  v_cvt_pk_bf16_f32 v45, v74, v75
  v_cvt_pk_bf16_f32 v46, v76, v77
  v_cvt_pk_bf16_f32 v47, v78, v79
  ds_write_b128 v6, v[32:35] offset:16
  ds_write_b128 v6, v[36:39] offset:3088
  s_mov_b64 exec, s[42:43]
  ds_write_b128 v6, v[40:43] offset:0
  ds_write_b128 v6, v[44:47] offset:3072
  s_mov_b64 exec, -1
  v_add_u32 v6, s77, v6
  s_waitcnt lgkmcnt(0)
  buffer_load_dwordx4 v226, s[4:7], s21 offen lds
  buffer_load_dwordx4 v227, s[8:11], s21 offen offset:1024 lds
  ds_read_b64_tr_b16 v[24:25], v4 offset:0
  ds_read_b64_tr_b16 v[26:27], v4 offset:512
  ds_read_b64_tr_b16 v[28:29], v5 offset:0
  ds_read_b64_tr_b16 v[30:31], v5 offset:512
  v_mfma_f32_16x16x32_bf16 v[48:51], v[16:19], v[176:179], 0
  v_mfma_f32_16x16x32_bf16 v[52:55], v[20:23], v[176:179], 0
  v_mfma_f32_16x16x32_bf16 v[64:67], v[16:19], v[200:203], 0
  v_mfma_f32_16x16x32_bf16 v[68:71], v[20:23], v[200:203], 0
  s_add_u32 m0, s23, 0
  s_waitcnt vmcnt(4) lgkmcnt(0)
  buffer_load_dwordx4 v228, s[4:7], s21 offen lds
  buffer_load_dwordx4 v229, s[8:11], s21 offen offset:1024 lds
  ds_read_b64_tr_b16 v[16:17], v2 offset:4096
  ds_read_b64_tr_b16 v[18:19], v2 offset:4608
  ds_read_b64_tr_b16 v[20:21], v3 offset:4096
  ds_read_b64_tr_b16 v[22:23], v3 offset:4608
  v_mfma_f32_16x16x32_bf16 v[56:59], v[24:27], v[176:179], 0
  v_mfma_f32_16x16x32_bf16 v[60:63], v[28:31], v[176:179], 0
  v_mfma_f32_16x16x32_bf16 v[72:75], v[24:27], v[200:203], 0
  v_mfma_f32_16x16x32_bf16 v[76:79], v[28:31], v[200:203], 0
  s_add_u32 m0, s23, 2048
  s_waitcnt lgkmcnt(0)
  s_barrier
  buffer_load_dwordx4 v230, s[4:7], s21 offen lds
  buffer_load_dwordx4 v231, s[8:11], s21 offen offset:1024 lds
  ds_read_b64_tr_b16 v[24:25], v4 offset:4096
  ds_read_b64_tr_b16 v[26:27], v4 offset:4608
  ds_read_b64_tr_b16 v[28:29], v5 offset:4096
  ds_read_b64_tr_b16 v[30:31], v5 offset:4608
  ds_read_b128 v[32:35], v8 offset:18464
  ds_read_b128 v[36:39], v8 offset:18720
  ds_read_b128 v[40:43], v8 offset:18976
  ds_read_b128 v[44:47], v8 offset:21536
  v_mfma_f32_16x16x32_bf16 v[48:51], v[16:19], v[180:183], v[48:51]
  v_mfma_f32_16x16x32_bf16 v[52:55], v[20:23], v[180:183], v[52:55]
  s_add_u32 m0, s23, 4096
  s_waitcnt vmcnt(4) lgkmcnt(0)
  buffer_load_dwordx4 v232, s[4:7], s21 offen lds
  buffer_load_dwordx4 v233, s[8:11], s21 offen offset:1024 lds
  ds_read_b64_tr_b16 v[16:17], v2 offset:8192
  ds_read_b64_tr_b16 v[18:19], v2 offset:8704
  ds_read_b64_tr_b16 v[20:21], v3 offset:8192
  ds_read_b64_tr_b16 v[22:23], v3 offset:8704
  v_mfma_f32_16x16x32_bf16 v[104:107], v[152:155], v[32:35], v[104:107]
  v_mfma_f32_16x16x32_bf16 v[108:111], v[152:155], v[36:39], v[108:111]
  v_mfma_f32_16x16x32_bf16 v[112:115], v[152:155], v[40:43], v[112:115]
  v_mfma_f32_16x16x32_bf16 v[104:107], v[156:159], v[44:47], v[104:107]
  ds_read_b128 v[32:35], v8 offset:21792
  ds_read_b128 v[36:39], v8 offset:22048
  ds_read_b128 v[40:43], v7 offset:0
  ds_read_b128 v[44:47], v7 offset:256
  v_mfma_f32_16x16x32_bf16 v[56:59], v[24:27], v[180:183], v[56:59]
  v_mfma_f32_16x16x32_bf16 v[60:63], v[28:31], v[180:183], v[60:63]
  s_add_u32 m0, s23, 6144
  s_waitcnt lgkmcnt(0)
  buffer_load_dwordx4 v234, s[4:7], s21 offen lds
  buffer_load_dwordx4 v235, s[8:11], s21 offen offset:1024 lds
  ds_read_b64_tr_b16 v[24:25], v4 offset:8192
  ds_read_b64_tr_b16 v[26:27], v4 offset:8704
  ds_read_b64_tr_b16 v[28:29], v5 offset:8192
  ds_read_b64_tr_b16 v[30:31], v5 offset:8704
  v_mfma_f32_16x16x32_bf16 v[108:111], v[156:159], v[32:35], v[108:111]
  v_mfma_f32_16x16x32_bf16 v[112:115], v[156:159], v[36:39], v[112:115]
  v_mfma_f32_16x16x32_bf16 v[92:95], v[160:163], v[40:43], v[92:95]
  v_mfma_f32_16x16x32_bf16 v[96:99], v[160:163], v[44:47], v[96:99]
  ds_read_b128 v[32:35], v7 offset:512
  ds_read_b128 v[36:39], v7 offset:3072
  ds_read_b128 v[40:43], v7 offset:3328
  ds_read_b128 v[44:47], v7 offset:3584
  v_mfma_f32_16x16x32_bf16 v[48:51], v[16:19], v[184:187], v[48:51]
  v_mfma_f32_16x16x32_bf16 v[52:55], v[20:23], v[184:187], v[52:55]
  s_add_u32 m0, s23, 8192
  s_waitcnt vmcnt(4) lgkmcnt(0)
  buffer_load_dwordx4 v236, s[4:7], s21 offen lds
  buffer_load_dwordx4 v237, s[8:11], s21 offen offset:1024 lds
  ds_read_b64_tr_b16 v[16:17], v2 offset:0
  ds_read_b64_tr_b16 v[18:19], v2 offset:512
  ds_read_b64_tr_b16 v[20:21], v3 offset:0
  ds_read_b64_tr_b16 v[22:23], v3 offset:512
  v_mfma_f32_16x16x32_bf16 v[100:103], v[160:163], v[32:35], v[100:103]
  v_mfma_f32_16x16x32_bf16 v[92:95], v[164:167], v[36:39], v[92:95]
  v_mfma_f32_16x16x32_bf16 v[96:99], v[164:167], v[40:43], v[96:99]
  v_mfma_f32_16x16x32_bf16 v[100:103], v[164:167], v[44:47], v[100:103]
  ds_read_b128 v[32:35], v7 offset:18464
  ds_read_b128 v[36:39], v7 offset:18720
  ds_read_b128 v[40:43], v7 offset:18976
  ds_read_b128 v[44:47], v7 offset:21536
  v_mfma_f32_16x16x32_bf16 v[56:59], v[24:27], v[184:187], v[56:59]
  v_mfma_f32_16x16x32_bf16 v[60:63], v[28:31], v[184:187], v[60:63]
  v_xor_b32 v152, 0x80008000, v152
  v_xor_b32 v153, 0x80008000, v153
  v_xor_b32 v154, 0x80008000, v154
  v_xor_b32 v155, 0x80008000, v155
  v_xor_b32 v156, 0x80008000, v156
  v_xor_b32 v157, 0x80008000, v157
  v_xor_b32 v158, 0x80008000, v158
  v_xor_b32 v159, 0x80008000, v159
  s_add_u32 m0, s23, 10240
  s_waitcnt lgkmcnt(0)
  buffer_load_dwordx4 v238, s[4:7], s21 offen lds
  buffer_load_dwordx4 v239, s[8:11], s21 offen offset:1024 lds
  ds_read_b64_tr_b16 v[24:25], v4 offset:0
  ds_read_b64_tr_b16 v[26:27], v4 offset:512
  ds_read_b64_tr_b16 v[28:29], v5 offset:0
  ds_read_b64_tr_b16 v[30:31], v5 offset:512
  v_mfma_f32_16x16x32_bf16 v[80:83], v[168:171], v[32:35], v[80:83]
  v_mfma_f32_16x16x32_bf16 v[84:87], v[168:171], v[36:39], v[84:87]
  v_mfma_f32_16x16x32_bf16 v[88:91], v[168:171], v[40:43], v[88:91]
  v_mfma_f32_16x16x32_bf16 v[80:83], v[172:175], v[44:47], v[80:83]
  ds_read_b128 v[32:35], v7 offset:21792
  ds_read_b128 v[36:39], v7 offset:22048
  ds_read_b128 v[40:43], v8 offset:0
  ds_read_b128 v[44:47], v8 offset:256
  v_mfma_f32_16x16x32_bf16 v[48:51], v[16:19], v[188:191], v[48:51]
  v_mfma_f32_16x16x32_bf16 v[52:55], v[20:23], v[188:191], v[52:55]
  s_add_u32 m0, s23, 0
  s_waitcnt vmcnt(4) lgkmcnt(0)
  s_mov_b32 s21, 512
  buffer_load_dwordx4 v240, s[4:7], s21 offen lds
  buffer_load_dwordx4 v241, s[8:11], s21 offen offset:1024 lds
  ds_read_b64_tr_b16 v[16:17], v2 offset:4096
  ds_read_b64_tr_b16 v[18:19], v2 offset:4608
  ds_read_b64_tr_b16 v[20:21], v3 offset:4096
  ds_read_b64_tr_b16 v[22:23], v3 offset:4608
  v_mfma_f32_16x16x32_bf16 v[84:87], v[172:175], v[32:35], v[84:87]
  v_mfma_f32_16x16x32_bf16 v[88:91], v[172:175], v[36:39], v[88:91]
  v_mfma_f32_16x16x32_bf16 v[116:119], v[152:155], v[40:43], v[116:119]
  v_mfma_f32_16x16x32_bf16 v[120:123], v[152:155], v[44:47], v[120:123]
  ds_read_b128 v[32:35], v8 offset:512
  ds_read_b128 v[36:39], v8 offset:3072
  ds_read_b128 v[40:43], v8 offset:3328
  ds_read_b128 v[44:47], v8 offset:3584
  v_mfma_f32_16x16x32_bf16 v[56:59], v[24:27], v[188:191], v[56:59]
  v_mfma_f32_16x16x32_bf16 v[60:63], v[28:31], v[188:191], v[60:63]
  s_add_u32 m0, s23, 2048
  s_waitcnt lgkmcnt(0)
  buffer_load_dwordx4 v242, s[4:7], s21 offen lds
  buffer_load_dwordx4 v243, s[8:11], s21 offen offset:1024 lds
  ds_read_b64_tr_b16 v[24:25], v4 offset:4096
  ds_read_b64_tr_b16 v[26:27], v4 offset:4608
  ds_read_b64_tr_b16 v[28:29], v5 offset:4096
  ds_read_b64_tr_b16 v[30:31], v5 offset:4608
  v_mfma_f32_16x16x32_bf16 v[124:127], v[152:155], v[32:35], v[124:127]
  v_mfma_f32_16x16x32_bf16 v[116:119], v[156:159], v[36:39], v[116:119]
  v_mfma_f32_16x16x32_bf16 v[120:123], v[156:159], v[40:43], v[120:123]
  v_mfma_f32_16x16x32_bf16 v[124:127], v[156:159], v[44:47], v[124:127]
  v_mfma_f32_16x16x32_bf16 v[48:51], v[16:19], v[192:195], v[48:51]
  v_mfma_f32_16x16x32_bf16 v[52:55], v[20:23], v[192:195], v[52:55]
  s_add_u32 m0, s23, 4096
  s_waitcnt vmcnt(4) lgkmcnt(0)
  buffer_load_dwordx4 v244, s[4:7], s21 offen lds
  buffer_load_dwordx4 v245, s[8:11], s21 offen offset:1024 lds
  ds_read_b64_tr_b16 v[16:17], v2 offset:8192
  ds_read_b64_tr_b16 v[18:19], v2 offset:8704
  ds_read_b64_tr_b16 v[20:21], v3 offset:8192
  ds_read_b64_tr_b16 v[22:23], v3 offset:8704
  v_mfma_f32_16x16x32_bf16 v[56:59], v[24:27], v[192:195], v[56:59]
  v_mfma_f32_16x16x32_bf16 v[60:63], v[28:31], v[192:195], v[60:63]
  s_add_u32 m0, s23, 6144
  s_waitcnt lgkmcnt(0)
  buffer_load_dwordx4 v246, s[4:7], s21 offen lds
  buffer_load_dwordx4 v247, s[8:11], s21 offen offset:1024 lds
  ds_read_b64_tr_b16 v[24:25], v4 offset:8192
  ds_read_b64_tr_b16 v[26:27], v4 offset:8704
  ds_read_b64_tr_b16 v[28:29], v5 offset:8192
  ds_read_b64_tr_b16 v[30:31], v5 offset:8704
  v_mfma_f32_16x16x32_bf16 v[48:51], v[16:19], v[196:199], v[48:51]
  v_mfma_f32_16x16x32_bf16 v[52:55], v[20:23], v[196:199], v[52:55]
  s_add_u32 m0, s23, 8192
  s_waitcnt lgkmcnt(0)
  v_mfma_f32_16x16x32_bf16 v[56:59], v[24:27], v[196:199], v[56:59]
  v_mfma_f32_16x16x32_bf16 v[60:63], v[28:31], v[196:199], v[60:63]
  s_waitcnt vmcnt(4) lgkmcnt(0)
  buffer_load_dwordx4 v224, s[4:7], s21 offen lds
  buffer_load_dwordx4 v225, s[8:11], s21 offen offset:1024 lds
  ds_read_b64_tr_b16 v[16:17], v2 offset:0
  ds_read_b64_tr_b16 v[18:19], v2 offset:512
  ds_read_b64_tr_b16 v[20:21], v3 offset:0
  ds_read_b64_tr_b16 v[22:23], v3 offset:512
  s_add_u32 m0, s23, 10240
  s_nop 0
  v_cvt_pk_bf16_f32 v32, v48, v49
  v_cvt_pk_bf16_f32 v33, v50, v51
  v_cvt_pk_bf16_f32 v34, v52, v53
  v_cvt_pk_bf16_f32 v35, v54, v55
  v_cvt_pk_bf16_f32 v36, v56, v57
  v_cvt_pk_bf16_f32 v37, v58, v59
  v_cvt_pk_bf16_f32 v38, v60, v61
  v_cvt_pk_bf16_f32 v39, v62, v63
  v_cvt_pk_bf16_f32 v40, v64, v65
  v_cvt_pk_bf16_f32 v41, v66, v67
  v_cvt_pk_bf16_f32 v42, v68, v69
  v_cvt_pk_bf16_f32 v43, v70, v71
  v_cvt_pk_bf16_f32 v44, v72, v73
  v_cvt_pk_bf16_f32 v45, v74, v75
  v_cvt_pk_bf16_f32 v46, v76, v77
  v_cvt_pk_bf16_f32 v47, v78, v79
  ds_write_b128 v6, v[32:35] offset:16
  ds_write_b128 v6, v[36:39] offset:3088
  s_mov_b64 exec, s[42:43]
  ds_write_b128 v6, v[40:43] offset:0
  ds_write_b128 v6, v[44:47] offset:3072
  s_mov_b64 exec, -1
  v_subrev_u32 v6, s77, v6
  s_waitcnt lgkmcnt(0)
  buffer_load_dwordx4 v226, s[4:7], s21 offen lds
  buffer_load_dwordx4 v227, s[8:11], s21 offen offset:1024 lds
  ds_read_b64_tr_b16 v[24:25], v4 offset:0
  ds_read_b64_tr_b16 v[26:27], v4 offset:512
  ds_read_b64_tr_b16 v[28:29], v5 offset:0
  ds_read_b64_tr_b16 v[30:31], v5 offset:512
  v_add_u32 v7, s77, v7
  v_add_u32 v8, s77, v8
  v_mfma_f32_16x16x32_bf16 v[48:51], v[16:19], v[176:179], 0
  v_mfma_f32_16x16x32_bf16 v[52:55], v[20:23], v[176:179], 0
  v_mfma_f32_16x16x32_bf16 v[64:67], v[16:19], v[200:203], 0
  v_mfma_f32_16x16x32_bf16 v[68:71], v[20:23], v[200:203], 0
  s_add_u32 m0, s23, 0
  s_waitcnt vmcnt(4) lgkmcnt(0)
  buffer_load_dwordx4 v228, s[4:7], s21 offen lds
  buffer_load_dwordx4 v229, s[8:11], s21 offen offset:1024 lds
  ds_read_b64_tr_b16 v[16:17], v2 offset:4096
  ds_read_b64_tr_b16 v[18:19], v2 offset:4608
  ds_read_b64_tr_b16 v[20:21], v3 offset:4096
  ds_read_b64_tr_b16 v[22:23], v3 offset:4608
  v_mfma_f32_16x16x32_bf16 v[56:59], v[24:27], v[176:179], 0
  v_mfma_f32_16x16x32_bf16 v[60:63], v[28:31], v[176:179], 0
  v_mfma_f32_16x16x32_bf16 v[72:75], v[24:27], v[200:203], 0
  v_mfma_f32_16x16x32_bf16 v[76:79], v[28:31], v[200:203], 0
  s_add_u32 m0, s23, 2048
  s_waitcnt lgkmcnt(0)
  s_barrier
  buffer_load_dwordx4 v230, s[4:7], s21 offen lds
  buffer_load_dwordx4 v231, s[8:11], s21 offen offset:1024 lds
  ds_read_b64_tr_b16 v[24:25], v4 offset:4096
  ds_read_b64_tr_b16 v[26:27], v4 offset:4608
  ds_read_b64_tr_b16 v[28:29], v5 offset:4096
  ds_read_b64_tr_b16 v[30:31], v5 offset:4608
  ds_read_b128 v[32:35], v8 offset:18464
  ds_read_b128 v[36:39], v8 offset:18720
  ds_read_b128 v[40:43], v8 offset:18976
  ds_read_b128 v[44:47], v8 offset:21536
  v_mfma_f32_16x16x32_bf16 v[48:51], v[16:19], v[180:183], v[48:51]
  v_mfma_f32_16x16x32_bf16 v[52:55], v[20:23], v[180:183], v[52:55]
  s_add_u32 m0, s23, 4096
  s_waitcnt vmcnt(4) lgkmcnt(0)
  buffer_load_dwordx4 v232, s[4:7], s21 offen lds
  buffer_load_dwordx4 v233, s[8:11], s21 offen offset:1024 lds
  ds_read_b64_tr_b16 v[16:17], v2 offset:8192
  ds_read_b64_tr_b16 v[18:19], v2 offset:8704
  ds_read_b64_tr_b16 v[20:21], v3 offset:8192
  ds_read_b64_tr_b16 v[22:23], v3 offset:8704
  v_mfma_f32_16x16x32_bf16 v[104:107], v[128:131], v[32:35], v[104:107]
  v_mfma_f32_16x16x32_bf16 v[108:111], v[128:131], v[36:39], v[108:111]
  v_mfma_f32_16x16x32_bf16 v[112:115], v[128:131], v[40:43], v[112:115]
  v_mfma_f32_16x16x32_bf16 v[104:107], v[132:135], v[44:47], v[104:107]
  ds_read_b128 v[32:35], v8 offset:21792
  ds_read_b128 v[36:39], v8 offset:22048
  ds_read_b128 v[40:43], v7 offset:0
  ds_read_b128 v[44:47], v7 offset:256
  v_mfma_f32_16x16x32_bf16 v[56:59], v[24:27], v[180:183], v[56:59]
  v_mfma_f32_16x16x32_bf16 v[60:63], v[28:31], v[180:183], v[60:63]
  s_add_u32 m0, s23, 6144
  s_waitcnt lgkmcnt(0)
  buffer_load_dwordx4 v234, s[4:7], s21 offen lds
  buffer_load_dwordx4 v235, s[8:11], s21 offen offset:1024 lds
  ds_read_b64_tr_b16 v[24:25], v4 offset:8192
  ds_read_b64_tr_b16 v[26:27], v4 offset:8704
  ds_read_b64_tr_b16 v[28:29], v5 offset:8192
  ds_read_b64_tr_b16 v[30:31], v5 offset:8704
  v_mfma_f32_16x16x32_bf16 v[108:111], v[132:135], v[32:35], v[108:111]
  v_mfma_f32_16x16x32_bf16 v[112:115], v[132:135], v[36:39], v[112:115]
  v_mfma_f32_16x16x32_bf16 v[92:95], v[136:139], v[40:43], v[92:95]
  v_mfma_f32_16x16x32_bf16 v[96:99], v[136:139], v[44:47], v[96:99]
  ds_read_b128 v[32:35], v7 offset:512
  ds_read_b128 v[36:39], v7 offset:3072
  ds_read_b128 v[40:43], v7 offset:3328
  ds_read_b128 v[44:47], v7 offset:3584
  v_mfma_f32_16x16x32_bf16 v[48:51], v[16:19], v[184:187], v[48:51]
  v_mfma_f32_16x16x32_bf16 v[52:55], v[20:23], v[184:187], v[52:55]
  s_add_u32 m0, s23, 8192
  s_waitcnt vmcnt(4) lgkmcnt(0)
  buffer_load_dwordx4 v236, s[4:7], s21 offen lds
  buffer_load_dwordx4 v237, s[8:11], s21 offen offset:1024 lds
  ds_read_b64_tr_b16 v[16:17], v2 offset:0
  ds_read_b64_tr_b16 v[18:19], v2 offset:512
  ds_read_b64_tr_b16 v[20:21], v3 offset:0
  ds_read_b64_tr_b16 v[22:23], v3 offset:512
  v_mfma_f32_16x16x32_bf16 v[100:103], v[136:139], v[32:35], v[100:103]
  v_mfma_f32_16x16x32_bf16 v[92:95], v[140:143], v[36:39], v[92:95]
  v_mfma_f32_16x16x32_bf16 v[96:99], v[140:143], v[40:43], v[96:99]
  v_mfma_f32_16x16x32_bf16 v[100:103], v[140:143], v[44:47], v[100:103]
  ds_read_b128 v[32:35], v7 offset:18464
  ds_read_b128 v[36:39], v7 offset:18720
  ds_read_b128 v[40:43], v7 offset:18976
  ds_read_b128 v[44:47], v7 offset:21536
  v_mfma_f32_16x16x32_bf16 v[56:59], v[24:27], v[184:187], v[56:59]
  v_mfma_f32_16x16x32_bf16 v[60:63], v[28:31], v[184:187], v[60:63]
  v_xor_b32 v128, 0x80008000, v128
  v_xor_b32 v129, 0x80008000, v129
  v_xor_b32 v130, 0x80008000, v130
  v_xor_b32 v131, 0x80008000, v131
  v_xor_b32 v132, 0x80008000, v132
  v_xor_b32 v133, 0x80008000, v133
  v_xor_b32 v134, 0x80008000, v134
  v_xor_b32 v135, 0x80008000, v135
  s_add_u32 m0, s23, 10240
  s_waitcnt lgkmcnt(0)
  buffer_load_dwordx4 v238, s[4:7], s21 offen lds
  buffer_load_dwordx4 v239, s[8:11], s21 offen offset:1024 lds
  ds_read_b64_tr_b16 v[24:25], v4 offset:0
  ds_read_b64_tr_b16 v[26:27], v4 offset:512
  ds_read_b64_tr_b16 v[28:29], v5 offset:0
  ds_read_b64_tr_b16 v[30:31], v5 offset:512
  v_mfma_f32_16x16x32_bf16 v[80:83], v[144:147], v[32:35], v[80:83]
  v_mfma_f32_16x16x32_bf16 v[84:87], v[144:147], v[36:39], v[84:87]
  v_mfma_f32_16x16x32_bf16 v[88:91], v[144:147], v[40:43], v[88:91]
  v_mfma_f32_16x16x32_bf16 v[80:83], v[148:151], v[44:47], v[80:83]
  ds_read_b128 v[32:35], v7 offset:21792
  ds_read_b128 v[36:39], v7 offset:22048
  ds_read_b128 v[40:43], v8 offset:0
  ds_read_b128 v[44:47], v8 offset:256
  v_mfma_f32_16x16x32_bf16 v[48:51], v[16:19], v[188:191], v[48:51]
  v_mfma_f32_16x16x32_bf16 v[52:55], v[20:23], v[188:191], v[52:55]
  s_add_u32 m0, s23, 0
  s_waitcnt vmcnt(4) lgkmcnt(0)
  s_mov_b32 s21, 640
  buffer_load_dwordx4 v240, s[4:7], s21 offen lds
  buffer_load_dwordx4 v241, s[8:11], s21 offen offset:1024 lds
  ds_read_b64_tr_b16 v[16:17], v2 offset:4096
  ds_read_b64_tr_b16 v[18:19], v2 offset:4608
  ds_read_b64_tr_b16 v[20:21], v3 offset:4096
  ds_read_b64_tr_b16 v[22:23], v3 offset:4608
  v_mfma_f32_16x16x32_bf16 v[84:87], v[148:151], v[32:35], v[84:87]
  v_mfma_f32_16x16x32_bf16 v[88:91], v[148:151], v[36:39], v[88:91]
  v_mfma_f32_16x16x32_bf16 v[116:119], v[128:131], v[40:43], v[116:119]
  v_mfma_f32_16x16x32_bf16 v[120:123], v[128:131], v[44:47], v[120:123]
  ds_read_b128 v[32:35], v8 offset:512
  ds_read_b128 v[36:39], v8 offset:3072
  ds_read_b128 v[40:43], v8 offset:3328
  ds_read_b128 v[44:47], v8 offset:3584
  v_mfma_f32_16x16x32_bf16 v[56:59], v[24:27], v[188:191], v[56:59]
  v_mfma_f32_16x16x32_bf16 v[60:63], v[28:31], v[188:191], v[60:63]
  s_add_u32 m0, s23, 2048
  s_waitcnt lgkmcnt(0)
  buffer_load_dwordx4 v242, s[4:7], s21 offen lds
  buffer_load_dwordx4 v243, s[8:11], s21 offen offset:1024 lds
  ds_read_b64_tr_b16 v[24:25], v4 offset:4096
  ds_read_b64_tr_b16 v[26:27], v4 offset:4608
  ds_read_b64_tr_b16 v[28:29], v5 offset:4096
  ds_read_b64_tr_b16 v[30:31], v5 offset:4608
  v_mfma_f32_16x16x32_bf16 v[124:127], v[128:131], v[32:35], v[124:127]
  v_mfma_f32_16x16x32_bf16 v[116:119], v[132:135], v[36:39], v[116:119]
  v_mfma_f32_16x16x32_bf16 v[120:123], v[132:135], v[40:43], v[120:123]
  v_mfma_f32_16x16x32_bf16 v[124:127], v[132:135], v[44:47], v[124:127]
  v_mfma_f32_16x16x32_bf16 v[48:51], v[16:19], v[192:195], v[48:51]
  v_mfma_f32_16x16x32_bf16 v[52:55], v[20:23], v[192:195], v[52:55]
  s_add_u32 m0, s23, 4096
  s_waitcnt vmcnt(4) lgkmcnt(0)
  buffer_load_dwordx4 v244, s[4:7], s21 offen lds
  buffer_load_dwordx4 v245, s[8:11], s21 offen offset:1024 lds
  ds_read_b64_tr_b16 v[16:17], v2 offset:8192
  ds_read_b64_tr_b16 v[18:19], v2 offset:8704
  ds_read_b64_tr_b16 v[20:21], v3 offset:8192
  ds_read_b64_tr_b16 v[22:23], v3 offset:8704
  v_mfma_f32_16x16x32_bf16 v[56:59], v[24:27], v[192:195], v[56:59]
  v_mfma_f32_16x16x32_bf16 v[60:63], v[28:31], v[192:195], v[60:63]
  s_add_u32 m0, s23, 6144
  s_waitcnt lgkmcnt(0)
  buffer_load_dwordx4 v246, s[4:7], s21 offen lds
  buffer_load_dwordx4 v247, s[8:11], s21 offen offset:1024 lds
  ds_read_b64_tr_b16 v[24:25], v4 offset:8192
  ds_read_b64_tr_b16 v[26:27], v4 offset:8704
  ds_read_b64_tr_b16 v[28:29], v5 offset:8192
  ds_read_b64_tr_b16 v[30:31], v5 offset:8704
  v_mfma_f32_16x16x32_bf16 v[48:51], v[16:19], v[196:199], v[48:51]
  v_mfma_f32_16x16x32_bf16 v[52:55], v[20:23], v[196:199], v[52:55]
  s_add_u32 m0, s23, 8192
  s_waitcnt lgkmcnt(0)
  v_mfma_f32_16x16x32_bf16 v[56:59], v[24:27], v[196:199], v[56:59]
  v_mfma_f32_16x16x32_bf16 v[60:63], v[28:31], v[196:199], v[60:63]
  s_waitcnt vmcnt(4) lgkmcnt(0)
  buffer_load_dwordx4 v224, s[4:7], s21 offen lds
  buffer_load_dwordx4 v225, s[8:11], s21 offen offset:1024 lds
  ds_read_b64_tr_b16 v[16:17], v2 offset:0
  ds_read_b64_tr_b16 v[18:19], v2 offset:512
  ds_read_b64_tr_b16 v[20:21], v3 offset:0
  ds_read_b64_tr_b16 v[22:23], v3 offset:512
  s_add_u32 m0, s23, 10240
  s_nop 0
  v_cvt_pk_bf16_f32 v32, v48, v49
  v_cvt_pk_bf16_f32 v33, v50, v51
  v_cvt_pk_bf16_f32 v34, v52, v53
  v_cvt_pk_bf16_f32 v35, v54, v55
  v_cvt_pk_bf16_f32 v36, v56, v57
  v_cvt_pk_bf16_f32 v37, v58, v59
  v_cvt_pk_bf16_f32 v38, v60, v61
  v_cvt_pk_bf16_f32 v39, v62, v63
  v_cvt_pk_bf16_f32 v40, v64, v65
  v_cvt_pk_bf16_f32 v41, v66, v67
  v_cvt_pk_bf16_f32 v42, v68, v69
  v_cvt_pk_bf16_f32 v43, v70, v71
  v_cvt_pk_bf16_f32 v44, v72, v73
  v_cvt_pk_bf16_f32 v45, v74, v75
  v_cvt_pk_bf16_f32 v46, v76, v77
  v_cvt_pk_bf16_f32 v47, v78, v79
  ds_write_b128 v6, v[32:35] offset:16
  ds_write_b128 v6, v[36:39] offset:3088
  s_mov_b64 exec, s[42:43]
  ds_write_b128 v6, v[40:43] offset:0
  ds_write_b128 v6, v[44:47] offset:3072
  s_mov_b64 exec, -1
  v_add_u32 v6, s77, v6
  s_waitcnt lgkmcnt(0)
  buffer_load_dwordx4 v226, s[4:7], s21 offen lds
  buffer_load_dwordx4 v227, s[8:11], s21 offen offset:1024 lds
  ds_read_b64_tr_b16 v[24:25], v4 offset:0
  ds_read_b64_tr_b16 v[26:27], v4 offset:512
  ds_read_b64_tr_b16 v[28:29], v5 offset:0
  ds_read_b64_tr_b16 v[30:31], v5 offset:512
  v_subrev_u32 v7, s77, v7
  v_subrev_u32 v8, s77, v8
  v_mfma_f32_16x16x32_bf16 v[48:51], v[16:19], v[176:179], 0
  v_mfma_f32_16x16x32_bf16 v[52:55], v[20:23], v[176:179], 0
  v_mfma_f32_16x16x32_bf16 v[64:67], v[16:19], v[200:203], 0
  v_mfma_f32_16x16x32_bf16 v[68:71], v[20:23], v[200:203], 0
  s_add_u32 m0, s23, 0
  s_waitcnt vmcnt(4) lgkmcnt(0)
  buffer_load_dwordx4 v228, s[4:7], s21 offen lds
  buffer_load_dwordx4 v229, s[8:11], s21 offen offset:1024 lds
  ds_read_b64_tr_b16 v[16:17], v2 offset:4096
  ds_read_b64_tr_b16 v[18:19], v2 offset:4608
  ds_read_b64_tr_b16 v[20:21], v3 offset:4096
  ds_read_b64_tr_b16 v[22:23], v3 offset:4608
  v_mfma_f32_16x16x32_bf16 v[56:59], v[24:27], v[176:179], 0
  v_mfma_f32_16x16x32_bf16 v[60:63], v[28:31], v[176:179], 0
  v_mfma_f32_16x16x32_bf16 v[72:75], v[24:27], v[200:203], 0
  v_mfma_f32_16x16x32_bf16 v[76:79], v[28:31], v[200:203], 0
  s_add_u32 m0, s23, 2048
  s_waitcnt lgkmcnt(0)
  s_barrier
  buffer_load_dwordx4 v230, s[4:7], s21 offen lds
  buffer_load_dwordx4 v231, s[8:11], s21 offen offset:1024 lds
  ds_read_b64_tr_b16 v[24:25], v4 offset:4096
  ds_read_b64_tr_b16 v[26:27], v4 offset:4608
  ds_read_b64_tr_b16 v[28:29], v5 offset:4096
  ds_read_b64_tr_b16 v[30:31], v5 offset:4608
  ds_read_b128 v[32:35], v8 offset:18464
  ds_read_b128 v[36:39], v8 offset:18720
  ds_read_b128 v[40:43], v8 offset:18976
  ds_read_b128 v[44:47], v8 offset:21536
  v_mfma_f32_16x16x32_bf16 v[48:51], v[16:19], v[180:183], v[48:51]
  v_mfma_f32_16x16x32_bf16 v[52:55], v[20:23], v[180:183], v[52:55]
  s_add_u32 m0, s23, 4096
  s_waitcnt vmcnt(4) lgkmcnt(0)
  buffer_load_dwordx4 v232, s[4:7], s21 offen lds
  buffer_load_dwordx4 v233, s[8:11], s21 offen offset:1024 lds
  ds_read_b64_tr_b16 v[16:17], v2 offset:8192
  ds_read_b64_tr_b16 v[18:19], v2 offset:8704
  ds_read_b64_tr_b16 v[20:21], v3 offset:8192
  ds_read_b64_tr_b16 v[22:23], v3 offset:8704
  v_mfma_f32_16x16x32_bf16 v[92:95], v[128:131], v[32:35], v[92:95]
  v_mfma_f32_16x16x32_bf16 v[96:99], v[128:131], v[36:39], v[96:99]
  v_mfma_f32_16x16x32_bf16 v[100:103], v[128:131], v[40:43], v[100:103]
  v_mfma_f32_16x16x32_bf16 v[92:95], v[132:135], v[44:47], v[92:95]
  ds_read_b128 v[32:35], v8 offset:21792
  ds_read_b128 v[36:39], v8 offset:22048
  ds_read_b128 v[40:43], v7 offset:0
  ds_read_b128 v[44:47], v7 offset:256
  v_mfma_f32_16x16x32_bf16 v[56:59], v[24:27], v[180:183], v[56:59]
  v_mfma_f32_16x16x32_bf16 v[60:63], v[28:31], v[180:183], v[60:63]
  s_add_u32 m0, s23, 6144
  s_waitcnt lgkmcnt(0)
  buffer_load_dwordx4 v234, s[4:7], s21 offen lds
  buffer_load_dwordx4 v235, s[8:11], s21 offen offset:1024 lds
  ds_read_b64_tr_b16 v[24:25], v4 offset:8192
  ds_read_b64_tr_b16 v[26:27], v4 offset:8704
  ds_read_b64_tr_b16 v[28:29], v5 offset:8192
  ds_read_b64_tr_b16 v[30:31], v5 offset:8704
  v_mfma_f32_16x16x32_bf16 v[96:99], v[132:135], v[32:35], v[96:99]
  v_mfma_f32_16x16x32_bf16 v[100:103], v[132:135], v[36:39], v[100:103]
  v_mfma_f32_16x16x32_bf16 v[104:107], v[136:139], v[40:43], v[104:107]
  v_mfma_f32_16x16x32_bf16 v[108:111], v[136:139], v[44:47], v[108:111]
  ds_read_b128 v[32:35], v7 offset:512
  ds_read_b128 v[36:39], v7 offset:3072
  ds_read_b128 v[40:43], v7 offset:3328
  ds_read_b128 v[44:47], v7 offset:3584
  v_mfma_f32_16x16x32_bf16 v[48:51], v[16:19], v[184:187], v[48:51]
  v_mfma_f32_16x16x32_bf16 v[52:55], v[20:23], v[184:187], v[52:55]
  s_add_u32 m0, s23, 8192
  s_waitcnt vmcnt(4) lgkmcnt(0)
  buffer_load_dwordx4 v236, s[4:7], s21 offen lds
  buffer_load_dwordx4 v237, s[8:11], s21 offen offset:1024 lds
  ds_read_b64_tr_b16 v[16:17], v2 offset:0
  ds_read_b64_tr_b16 v[18:19], v2 offset:512
  ds_read_b64_tr_b16 v[20:21], v3 offset:0
  ds_read_b64_tr_b16 v[22:23], v3 offset:512
  v_mfma_f32_16x16x32_bf16 v[112:115], v[136:139], v[32:35], v[112:115]
  v_mfma_f32_16x16x32_bf16 v[104:107], v[140:143], v[36:39], v[104:107]
  v_mfma_f32_16x16x32_bf16 v[108:111], v[140:143], v[40:43], v[108:111]
  v_mfma_f32_16x16x32_bf16 v[112:115], v[140:143], v[44:47], v[112:115]
  ds_read_b128 v[32:35], v8 offset:0
  ds_read_b128 v[36:39], v8 offset:256
  ds_read_b128 v[40:43], v8 offset:512
  ds_read_b128 v[44:47], v8 offset:3072
  v_mfma_f32_16x16x32_bf16 v[56:59], v[24:27], v[184:187], v[56:59]
  v_mfma_f32_16x16x32_bf16 v[60:63], v[28:31], v[184:187], v[60:63]
  v_xor_b32 v128, 0x80008000, v128
  v_xor_b32 v129, 0x80008000, v129
  v_xor_b32 v130, 0x80008000, v130
  v_xor_b32 v131, 0x80008000, v131
  v_xor_b32 v132, 0x80008000, v132
  v_xor_b32 v133, 0x80008000, v133
  v_xor_b32 v134, 0x80008000, v134
  v_xor_b32 v135, 0x80008000, v135
  s_add_u32 m0, s23, 10240
  s_waitcnt lgkmcnt(0)
  buffer_load_dwordx4 v238, s[4:7], s21 offen lds
  buffer_load_dwordx4 v239, s[8:11], s21 offen offset:1024 lds
  ds_read_b64_tr_b16 v[24:25], v4 offset:0
  ds_read_b64_tr_b16 v[26:27], v4 offset:512
  ds_read_b64_tr_b16 v[28:29], v5 offset:0
  ds_read_b64_tr_b16 v[30:31], v5 offset:512
  v_mfma_f32_16x16x32_bf16 v[80:83], v[144:147], v[32:35], v[80:83]
  v_mfma_f32_16x16x32_bf16 v[84:87], v[144:147], v[36:39], v[84:87]
  v_mfma_f32_16x16x32_bf16 v[88:91], v[144:147], v[40:43], v[88:91]
  v_mfma_f32_16x16x32_bf16 v[80:83], v[148:151], v[44:47], v[80:83]
  ds_read_b128 v[32:35], v8 offset:3328
  ds_read_b128 v[36:39], v8 offset:3584
  ds_read_b128 v[40:43], v7 offset:18464
  ds_read_b128 v[44:47], v7 offset:18720
  v_mfma_f32_16x16x32_bf16 v[48:51], v[16:19], v[188:191], v[48:51]
  v_mfma_f32_16x16x32_bf16 v[52:55], v[20:23], v[188:191], v[52:55]
  s_add_u32 m0, s23, 0
  s_waitcnt vmcnt(4) lgkmcnt(0)
  s_mov_b32 s21, 768
  buffer_load_dwordx4 v240, s[4:7], s21 offen lds
  buffer_load_dwordx4 v241, s[8:11], s21 offen offset:1024 lds
  ds_read_b64_tr_b16 v[16:17], v2 offset:4096
  ds_read_b64_tr_b16 v[18:19], v2 offset:4608
  ds_read_b64_tr_b16 v[20:21], v3 offset:4096
  ds_read_b64_tr_b16 v[22:23], v3 offset:4608
  v_mfma_f32_16x16x32_bf16 v[84:87], v[148:151], v[32:35], v[84:87]
  v_mfma_f32_16x16x32_bf16 v[88:91], v[148:151], v[36:39], v[88:91]
  v_mfma_f32_16x16x32_bf16 v[116:119], v[128:131], v[40:43], v[116:119]
  v_mfma_f32_16x16x32_bf16 v[120:123], v[128:131], v[44:47], v[120:123]
  ds_read_b128 v[32:35], v7 offset:18976
  ds_read_b128 v[36:39], v7 offset:21536
  ds_read_b128 v[40:43], v7 offset:21792
  ds_read_b128 v[44:47], v7 offset:22048
  v_mfma_f32_16x16x32_bf16 v[56:59], v[24:27], v[188:191], v[56:59]
  v_mfma_f32_16x16x32_bf16 v[60:63], v[28:31], v[188:191], v[60:63]
  s_add_u32 m0, s23, 2048
  s_waitcnt lgkmcnt(0)
  buffer_load_dwordx4 v242, s[4:7], s21 offen lds
  buffer_load_dwordx4 v243, s[8:11], s21 offen offset:1024 lds
  ds_read_b64_tr_b16 v[24:25], v4 offset:4096
  ds_read_b64_tr_b16 v[26:27], v4 offset:4608
  ds_read_b64_tr_b16 v[28:29], v5 offset:4096
  ds_read_b64_tr_b16 v[30:31], v5 offset:4608
  v_mfma_f32_16x16x32_bf16 v[124:127], v[128:131], v[32:35], v[124:127]
  v_mfma_f32_16x16x32_bf16 v[116:119], v[132:135], v[36:39], v[116:119]
  v_mfma_f32_16x16x32_bf16 v[120:123], v[132:135], v[40:43], v[120:123]
  v_mfma_f32_16x16x32_bf16 v[124:127], v[132:135], v[44:47], v[124:127]
  v_mfma_f32_16x16x32_bf16 v[48:51], v[16:19], v[192:195], v[48:51]
  v_mfma_f32_16x16x32_bf16 v[52:55], v[20:23], v[192:195], v[52:55]
  s_add_u32 m0, s23, 4096
  s_waitcnt vmcnt(4) lgkmcnt(0)
  buffer_load_dwordx4 v244, s[4:7], s21 offen lds
  buffer_load_dwordx4 v245, s[8:11], s21 offen offset:1024 lds
  ds_read_b64_tr_b16 v[16:17], v2 offset:8192
  ds_read_b64_tr_b16 v[18:19], v2 offset:8704
  ds_read_b64_tr_b16 v[20:21], v3 offset:8192
  ds_read_b64_tr_b16 v[22:23], v3 offset:8704
  v_mfma_f32_16x16x32_bf16 v[56:59], v[24:27], v[192:195], v[56:59]
  v_mfma_f32_16x16x32_bf16 v[60:63], v[28:31], v[192:195], v[60:63]
  s_add_u32 m0, s23, 6144
  s_waitcnt lgkmcnt(0)
  buffer_load_dwordx4 v246, s[4:7], s21 offen lds
  buffer_load_dwordx4 v247, s[8:11], s21 offen offset:1024 lds
  ds_read_b64_tr_b16 v[24:25], v4 offset:8192
  ds_read_b64_tr_b16 v[26:27], v4 offset:8704
  ds_read_b64_tr_b16 v[28:29], v5 offset:8192
  ds_read_b64_tr_b16 v[30:31], v5 offset:8704
  v_mfma_f32_16x16x32_bf16 v[48:51], v[16:19], v[196:199], v[48:51]
  v_mfma_f32_16x16x32_bf16 v[52:55], v[20:23], v[196:199], v[52:55]
  s_add_u32 m0, s23, 8192
  s_waitcnt lgkmcnt(0)
  v_mfma_f32_16x16x32_bf16 v[56:59], v[24:27], v[196:199], v[56:59]
  v_mfma_f32_16x16x32_bf16 v[60:63], v[28:31], v[196:199], v[60:63]
  s_waitcnt vmcnt(4) lgkmcnt(0)
  buffer_load_dwordx4 v224, s[4:7], s21 offen lds
  buffer_load_dwordx4 v225, s[8:11], s21 offen offset:1024 lds
  ds_read_b64_tr_b16 v[16:17], v2 offset:0
  ds_read_b64_tr_b16 v[18:19], v2 offset:512
  ds_read_b64_tr_b16 v[20:21], v3 offset:0
  ds_read_b64_tr_b16 v[22:23], v3 offset:512
  s_add_u32 m0, s23, 10240
  s_nop 0
  v_cvt_pk_bf16_f32 v32, v48, v49
  v_cvt_pk_bf16_f32 v33, v50, v51
  v_cvt_pk_bf16_f32 v34, v52, v53
  v_cvt_pk_bf16_f32 v35, v54, v55
  v_cvt_pk_bf16_f32 v36, v56, v57
  v_cvt_pk_bf16_f32 v37, v58, v59
  v_cvt_pk_bf16_f32 v38, v60, v61
  v_cvt_pk_bf16_f32 v39, v62, v63
  v_cvt_pk_bf16_f32 v40, v64, v65
  v_cvt_pk_bf16_f32 v41, v66, v67
  v_cvt_pk_bf16_f32 v42, v68, v69
  v_cvt_pk_bf16_f32 v43, v70, v71
  v_cvt_pk_bf16_f32 v44, v72, v73
  v_cvt_pk_bf16_f32 v45, v74, v75
  v_cvt_pk_bf16_f32 v46, v76, v77
  v_cvt_pk_bf16_f32 v47, v78, v79
  ds_write_b128 v6, v[32:35] offset:16
  ds_write_b128 v6, v[36:39] offset:3088
  s_mov_b64 exec, s[42:43]
  ds_write_b128 v6, v[40:43] offset:0
  ds_write_b128 v6, v[44:47] offset:3072
  s_mov_b64 exec, -1
  v_subrev_u32 v6, s77, v6
  s_waitcnt lgkmcnt(0)
  buffer_load_dwordx4 v226, s[4:7], s21 offen lds
  buffer_load_dwordx4 v227, s[8:11], s21 offen offset:1024 lds
  ds_read_b64_tr_b16 v[24:25], v4 offset:0
  ds_read_b64_tr_b16 v[26:27], v4 offset:512
  ds_read_b64_tr_b16 v[28:29], v5 offset:0
  ds_read_b64_tr_b16 v[30:31], v5 offset:512
  v_add_u32 v7, s77, v7
  v_add_u32 v8, s77, v8
  v_mfma_f32_16x16x32_bf16 v[48:51], v[16:19], v[176:179], 0
  v_mfma_f32_16x16x32_bf16 v[52:55], v[20:23], v[176:179], 0
  v_mfma_f32_16x16x32_bf16 v[64:67], v[16:19], v[200:203], 0
  v_mfma_f32_16x16x32_bf16 v[68:71], v[20:23], v[200:203], 0
  s_add_u32 m0, s23, 0
  s_waitcnt vmcnt(4) lgkmcnt(0)
  buffer_load_dwordx4 v228, s[4:7], s21 offen lds
  buffer_load_dwordx4 v229, s[8:11], s21 offen offset:1024 lds
  ds_read_b64_tr_b16 v[16:17], v2 offset:4096
  ds_read_b64_tr_b16 v[18:19], v2 offset:4608
  ds_read_b64_tr_b16 v[20:21], v3 offset:4096
  ds_read_b64_tr_b16 v[22:23], v3 offset:4608
  v_mfma_f32_16x16x32_bf16 v[56:59], v[24:27], v[176:179], 0
  v_mfma_f32_16x16x32_bf16 v[60:63], v[28:31], v[176:179], 0
  v_mfma_f32_16x16x32_bf16 v[72:75], v[24:27], v[200:203], 0
  v_mfma_f32_16x16x32_bf16 v[76:79], v[28:31], v[200:203], 0
  s_add_u32 m0, s23, 2048
  s_waitcnt lgkmcnt(0)
  s_barrier
  buffer_load_dwordx4 v230, s[4:7], s21 offen lds
  buffer_load_dwordx4 v231, s[8:11], s21 offen offset:1024 lds
  ds_read_b64_tr_b16 v[24:25], v4 offset:4096
  ds_read_b64_tr_b16 v[26:27], v4 offset:4608
  ds_read_b64_tr_b16 v[28:29], v5 offset:4096
  ds_read_b64_tr_b16 v[30:31], v5 offset:4608
  ds_read_b128 v[32:35], v8 offset:18464
  ds_read_b128 v[36:39], v8 offset:18720
  ds_read_b128 v[40:43], v8 offset:18976
  ds_read_b128 v[44:47], v8 offset:21536
  v_mfma_f32_16x16x32_bf16 v[48:51], v[16:19], v[180:183], v[48:51]
  v_mfma_f32_16x16x32_bf16 v[52:55], v[20:23], v[180:183], v[52:55]
  s_add_u32 m0, s23, 4096
  s_waitcnt vmcnt(4) lgkmcnt(0)
  buffer_load_dwordx4 v232, s[4:7], s21 offen lds
  buffer_load_dwordx4 v233, s[8:11], s21 offen offset:1024 lds
  ds_read_b64_tr_b16 v[16:17], v2 offset:8192
  ds_read_b64_tr_b16 v[18:19], v2 offset:8704
  ds_read_b64_tr_b16 v[20:21], v3 offset:8192
  ds_read_b64_tr_b16 v[22:23], v3 offset:8704
  v_mfma_f32_16x16x32_bf16 v[92:95], v[152:155], v[32:35], v[92:95]
  v_mfma_f32_16x16x32_bf16 v[96:99], v[152:155], v[36:39], v[96:99]
  v_mfma_f32_16x16x32_bf16 v[100:103], v[152:155], v[40:43], v[100:103]
  v_mfma_f32_16x16x32_bf16 v[92:95], v[156:159], v[44:47], v[92:95]
  ds_read_b128 v[32:35], v8 offset:21792
  ds_read_b128 v[36:39], v8 offset:22048
  ds_read_b128 v[40:43], v7 offset:0
  ds_read_b128 v[44:47], v7 offset:256
  v_mfma_f32_16x16x32_bf16 v[56:59], v[24:27], v[180:183], v[56:59]
  v_mfma_f32_16x16x32_bf16 v[60:63], v[28:31], v[180:183], v[60:63]
  s_add_u32 m0, s23, 6144
  s_waitcnt lgkmcnt(0)
  buffer_load_dwordx4 v234, s[4:7], s21 offen lds
  buffer_load_dwordx4 v235, s[8:11], s21 offen offset:1024 lds
  ds_read_b64_tr_b16 v[24:25], v4 offset:8192
  ds_read_b64_tr_b16 v[26:27], v4 offset:8704
  ds_read_b64_tr_b16 v[28:29], v5 offset:8192
  ds_read_b64_tr_b16 v[30:31], v5 offset:8704
  v_mfma_f32_16x16x32_bf16 v[96:99], v[156:159], v[32:35], v[96:99]
  v_mfma_f32_16x16x32_bf16 v[100:103], v[156:159], v[36:39], v[100:103]
  v_mfma_f32_16x16x32_bf16 v[104:107], v[160:163], v[40:43], v[104:107]
  v_mfma_f32_16x16x32_bf16 v[108:111], v[160:163], v[44:47], v[108:111]
  ds_read_b128 v[32:35], v7 offset:512
  ds_read_b128 v[36:39], v7 offset:3072
  ds_read_b128 v[40:43], v7 offset:3328
  ds_read_b128 v[44:47], v7 offset:3584
  v_mfma_f32_16x16x32_bf16 v[48:51], v[16:19], v[184:187], v[48:51]
  v_mfma_f32_16x16x32_bf16 v[52:55], v[20:23], v[184:187], v[52:55]
  s_add_u32 m0, s23, 8192
  s_waitcnt vmcnt(4) lgkmcnt(0)
  buffer_load_dwordx4 v236, s[4:7], s21 offen lds
  buffer_load_dwordx4 v237, s[8:11], s21 offen offset:1024 lds
  ds_read_b64_tr_b16 v[16:17], v2 offset:0
  ds_read_b64_tr_b16 v[18:19], v2 offset:512
  ds_read_b64_tr_b16 v[20:21], v3 offset:0
  ds_read_b64_tr_b16 v[22:23], v3 offset:512
  v_mfma_f32_16x16x32_bf16 v[112:115], v[160:163], v[32:35], v[112:115]
  v_mfma_f32_16x16x32_bf16 v[104:107], v[164:167], v[36:39], v[104:107]
  v_mfma_f32_16x16x32_bf16 v[108:111], v[164:167], v[40:43], v[108:111]
  v_mfma_f32_16x16x32_bf16 v[112:115], v[164:167], v[44:47], v[112:115]
  ds_read_b128 v[32:35], v8 offset:0
  ds_read_b128 v[36:39], v8 offset:256
  ds_read_b128 v[40:43], v8 offset:512
  ds_read_b128 v[44:47], v8 offset:3072
  v_mfma_f32_16x16x32_bf16 v[56:59], v[24:27], v[184:187], v[56:59]
  v_mfma_f32_16x16x32_bf16 v[60:63], v[28:31], v[184:187], v[60:63]
  v_xor_b32 v152, 0x80008000, v152
  v_xor_b32 v153, 0x80008000, v153
  v_xor_b32 v154, 0x80008000, v154
  v_xor_b32 v155, 0x80008000, v155
  v_xor_b32 v156, 0x80008000, v156
  v_xor_b32 v157, 0x80008000, v157
  v_xor_b32 v158, 0x80008000, v158
  v_xor_b32 v159, 0x80008000, v159
  s_add_u32 m0, s23, 10240
  s_waitcnt lgkmcnt(0)
  buffer_load_dwordx4 v238, s[4:7], s21 offen lds
  buffer_load_dwordx4 v239, s[8:11], s21 offen offset:1024 lds
  ds_read_b64_tr_b16 v[24:25], v4 offset:0
  ds_read_b64_tr_b16 v[26:27], v4 offset:512
  ds_read_b64_tr_b16 v[28:29], v5 offset:0
  ds_read_b64_tr_b16 v[30:31], v5 offset:512
  v_mfma_f32_16x16x32_bf16 v[80:83], v[168:171], v[32:35], v[80:83]
  v_mfma_f32_16x16x32_bf16 v[84:87], v[168:171], v[36:39], v[84:87]
  v_mfma_f32_16x16x32_bf16 v[88:91], v[168:171], v[40:43], v[88:91]
  v_mfma_f32_16x16x32_bf16 v[80:83], v[172:175], v[44:47], v[80:83]
  ds_read_b128 v[32:35], v8 offset:3328
  ds_read_b128 v[36:39], v8 offset:3584
  ds_read_b128 v[40:43], v7 offset:18464
  ds_read_b128 v[44:47], v7 offset:18720
  v_mfma_f32_16x16x32_bf16 v[48:51], v[16:19], v[188:191], v[48:51]
  v_mfma_f32_16x16x32_bf16 v[52:55], v[20:23], v[188:191], v[52:55]
  s_add_u32 m0, s23, 0
  s_waitcnt vmcnt(4) lgkmcnt(0)
  s_mov_b32 s21, 896
  buffer_load_dwordx4 v240, s[4:7], s21 offen lds
  buffer_load_dwordx4 v241, s[8:11], s21 offen offset:1024 lds
  ds_read_b64_tr_b16 v[16:17], v2 offset:4096
  ds_read_b64_tr_b16 v[18:19], v2 offset:4608
  ds_read_b64_tr_b16 v[20:21], v3 offset:4096
  ds_read_b64_tr_b16 v[22:23], v3 offset:4608
  v_mfma_f32_16x16x32_bf16 v[84:87], v[172:175], v[32:35], v[84:87]
  v_mfma_f32_16x16x32_bf16 v[88:91], v[172:175], v[36:39], v[88:91]
  v_mfma_f32_16x16x32_bf16 v[116:119], v[152:155], v[40:43], v[116:119]
  v_mfma_f32_16x16x32_bf16 v[120:123], v[152:155], v[44:47], v[120:123]
  ds_read_b128 v[32:35], v7 offset:18976
  ds_read_b128 v[36:39], v7 offset:21536
  ds_read_b128 v[40:43], v7 offset:21792
  ds_read_b128 v[44:47], v7 offset:22048
  v_mfma_f32_16x16x32_bf16 v[56:59], v[24:27], v[188:191], v[56:59]
  v_mfma_f32_16x16x32_bf16 v[60:63], v[28:31], v[188:191], v[60:63]
  s_add_u32 m0, s23, 2048
  s_waitcnt lgkmcnt(0)
  buffer_load_dwordx4 v242, s[4:7], s21 offen lds
  buffer_load_dwordx4 v243, s[8:11], s21 offen offset:1024 lds
  ds_read_b64_tr_b16 v[24:25], v4 offset:4096
  ds_read_b64_tr_b16 v[26:27], v4 offset:4608
  ds_read_b64_tr_b16 v[28:29], v5 offset:4096
  ds_read_b64_tr_b16 v[30:31], v5 offset:4608
  v_mfma_f32_16x16x32_bf16 v[124:127], v[152:155], v[32:35], v[124:127]
  v_mfma_f32_16x16x32_bf16 v[116:119], v[156:159], v[36:39], v[116:119]
  v_mfma_f32_16x16x32_bf16 v[120:123], v[156:159], v[40:43], v[120:123]
  v_mfma_f32_16x16x32_bf16 v[124:127], v[156:159], v[44:47], v[124:127]
  v_mfma_f32_16x16x32_bf16 v[48:51], v[16:19], v[192:195], v[48:51]
  v_mfma_f32_16x16x32_bf16 v[52:55], v[20:23], v[192:195], v[52:55]
  s_add_u32 m0, s23, 4096
  s_waitcnt vmcnt(4) lgkmcnt(0)
  buffer_load_dwordx4 v244, s[4:7], s21 offen lds
  buffer_load_dwordx4 v245, s[8:11], s21 offen offset:1024 lds
  ds_read_b64_tr_b16 v[16:17], v2 offset:8192
  ds_read_b64_tr_b16 v[18:19], v2 offset:8704
  ds_read_b64_tr_b16 v[20:21], v3 offset:8192
  ds_read_b64_tr_b16 v[22:23], v3 offset:8704
  v_mfma_f32_16x16x32_bf16 v[56:59], v[24:27], v[192:195], v[56:59]
  v_mfma_f32_16x16x32_bf16 v[60:63], v[28:31], v[192:195], v[60:63]
  s_add_u32 m0, s23, 6144
  s_waitcnt lgkmcnt(0)
  buffer_load_dwordx4 v246, s[4:7], s21 offen lds
  buffer_load_dwordx4 v247, s[8:11], s21 offen offset:1024 lds
  ds_read_b64_tr_b16 v[24:25], v4 offset:8192
  ds_read_b64_tr_b16 v[26:27], v4 offset:8704
  ds_read_b64_tr_b16 v[28:29], v5 offset:8192
  ds_read_b64_tr_b16 v[30:31], v5 offset:8704
  v_mfma_f32_16x16x32_bf16 v[48:51], v[16:19], v[196:199], v[48:51]
  v_mfma_f32_16x16x32_bf16 v[52:55], v[20:23], v[196:199], v[52:55]
  s_add_u32 m0, s23, 8192
  s_waitcnt lgkmcnt(0)
  v_mfma_f32_16x16x32_bf16 v[56:59], v[24:27], v[196:199], v[56:59]
  v_mfma_f32_16x16x32_bf16 v[60:63], v[28:31], v[196:199], v[60:63]
  s_waitcnt vmcnt(4) lgkmcnt(0)
  buffer_load_dwordx4 v224, s[4:7], s21 offen lds
  buffer_load_dwordx4 v225, s[8:11], s21 offen offset:1024 lds
  ds_read_b64_tr_b16 v[16:17], v2 offset:0
  ds_read_b64_tr_b16 v[18:19], v2 offset:512
  ds_read_b64_tr_b16 v[20:21], v3 offset:0
  ds_read_b64_tr_b16 v[22:23], v3 offset:512
  s_add_u32 m0, s23, 10240
  s_nop 0
  v_cvt_pk_bf16_f32 v32, v48, v49
  v_cvt_pk_bf16_f32 v33, v50, v51
  v_cvt_pk_bf16_f32 v34, v52, v53
  v_cvt_pk_bf16_f32 v35, v54, v55
  v_cvt_pk_bf16_f32 v36, v56, v57
  v_cvt_pk_bf16_f32 v37, v58, v59
  v_cvt_pk_bf16_f32 v38, v60, v61
  v_cvt_pk_bf16_f32 v39, v62, v63
  v_cvt_pk_bf16_f32 v40, v64, v65
  v_cvt_pk_bf16_f32 v41, v66, v67
  v_cvt_pk_bf16_f32 v42, v68, v69
  v_cvt_pk_bf16_f32 v43, v70, v71
  v_cvt_pk_bf16_f32 v44, v72, v73
  v_cvt_pk_bf16_f32 v45, v74, v75
  v_cvt_pk_bf16_f32 v46, v76, v77
  v_cvt_pk_bf16_f32 v47, v78, v79
  ds_write_b128 v6, v[32:35] offset:16
  ds_write_b128 v6, v[36:39] offset:3088
  s_mov_b64 exec, s[42:43]
  ds_write_b128 v6, v[40:43] offset:0
  ds_write_b128 v6, v[44:47] offset:3072
  s_mov_b64 exec, -1
  v_add_u32 v6, s77, v6
  s_waitcnt lgkmcnt(0)
  buffer_load_dwordx4 v226, s[4:7], s21 offen lds
  buffer_load_dwordx4 v227, s[8:11], s21 offen offset:1024 lds
  ds_read_b64_tr_b16 v[24:25], v4 offset:0
  ds_read_b64_tr_b16 v[26:27], v4 offset:512
  ds_read_b64_tr_b16 v[28:29], v5 offset:0
  ds_read_b64_tr_b16 v[30:31], v5 offset:512
  v_subrev_u32 v7, s77, v7
  v_subrev_u32 v8, s77, v8
  v_mfma_f32_16x16x32_bf16 v[48:51], v[16:19], v[176:179], 0
  v_mfma_f32_16x16x32_bf16 v[52:55], v[20:23], v[176:179], 0
  v_mfma_f32_16x16x32_bf16 v[64:67], v[16:19], v[200:203], 0
  v_mfma_f32_16x16x32_bf16 v[68:71], v[20:23], v[200:203], 0
  s_add_u32 m0, s23, 0
  s_waitcnt vmcnt(4) lgkmcnt(0)
  buffer_load_dwordx4 v228, s[4:7], s21 offen lds
  buffer_load_dwordx4 v229, s[8:11], s21 offen offset:1024 lds
  ds_read_b64_tr_b16 v[16:17], v2 offset:4096
  ds_read_b64_tr_b16 v[18:19], v2 offset:4608
  ds_read_b64_tr_b16 v[20:21], v3 offset:4096
  ds_read_b64_tr_b16 v[22:23], v3 offset:4608
  v_mfma_f32_16x16x32_bf16 v[56:59], v[24:27], v[176:179], 0
  v_mfma_f32_16x16x32_bf16 v[60:63], v[28:31], v[176:179], 0
  v_mfma_f32_16x16x32_bf16 v[72:75], v[24:27], v[200:203], 0
  v_mfma_f32_16x16x32_bf16 v[76:79], v[28:31], v[200:203], 0
  s_add_u32 m0, s23, 2048
  s_waitcnt lgkmcnt(0)
  s_barrier
  buffer_load_dwordx4 v230, s[4:7], s21 offen lds
  buffer_load_dwordx4 v231, s[8:11], s21 offen offset:1024 lds
  ds_read_b64_tr_b16 v[24:25], v4 offset:4096
  ds_read_b64_tr_b16 v[26:27], v4 offset:4608
  ds_read_b64_tr_b16 v[28:29], v5 offset:4096
  ds_read_b64_tr_b16 v[30:31], v5 offset:4608
  ds_read_b128 v[32:35], v8 offset:0
  ds_read_b128 v[36:39], v8 offset:256
  ds_read_b128 v[40:43], v8 offset:512
  ds_read_b128 v[44:47], v8 offset:3072
  v_mfma_f32_16x16x32_bf16 v[48:51], v[16:19], v[180:183], v[48:51]
  v_mfma_f32_16x16x32_bf16 v[52:55], v[20:23], v[180:183], v[52:55]
  s_add_u32 m0, s23, 4096
  s_waitcnt vmcnt(4) lgkmcnt(0)
  buffer_load_dwordx4 v232, s[4:7], s21 offen lds
  buffer_load_dwordx4 v233, s[8:11], s21 offen offset:1024 lds
  ds_read_b64_tr_b16 v[16:17], v2 offset:8192
  ds_read_b64_tr_b16 v[18:19], v2 offset:8704
  ds_read_b64_tr_b16 v[20:21], v3 offset:8192
  ds_read_b64_tr_b16 v[22:23], v3 offset:8704
  v_mfma_f32_16x16x32_bf16 v[92:95], v[128:131], v[32:35], v[92:95]
  v_mfma_f32_16x16x32_bf16 v[96:99], v[128:131], v[36:39], v[96:99]
  v_mfma_f32_16x16x32_bf16 v[100:103], v[128:131], v[40:43], v[100:103]
  v_mfma_f32_16x16x32_bf16 v[92:95], v[132:135], v[44:47], v[92:95]
  ds_read_b128 v[32:35], v8 offset:3328
  ds_read_b128 v[36:39], v8 offset:3584
  ds_read_b128 v[40:43], v7 offset:0
  ds_read_b128 v[44:47], v7 offset:256
  v_mfma_f32_16x16x32_bf16 v[56:59], v[24:27], v[180:183], v[56:59]
  v_mfma_f32_16x16x32_bf16 v[60:63], v[28:31], v[180:183], v[60:63]
  s_add_u32 m0, s23, 6144
  s_waitcnt lgkmcnt(0)
  buffer_load_dwordx4 v234, s[4:7], s21 offen lds
  buffer_load_dwordx4 v235, s[8:11], s21 offen offset:1024 lds
  ds_read_b64_tr_b16 v[24:25], v4 offset:8192
  ds_read_b64_tr_b16 v[26:27], v4 offset:8704
  ds_read_b64_tr_b16 v[28:29], v5 offset:8192
  ds_read_b64_tr_b16 v[30:31], v5 offset:8704
  v_mfma_f32_16x16x32_bf16 v[96:99], v[132:135], v[32:35], v[96:99]
  v_mfma_f32_16x16x32_bf16 v[100:103], v[132:135], v[36:39], v[100:103]
  v_mfma_f32_16x16x32_bf16 v[116:119], v[136:139], v[40:43], v[116:119]
  v_mfma_f32_16x16x32_bf16 v[120:123], v[136:139], v[44:47], v[120:123]
  ds_read_b128 v[32:35], v7 offset:512
  ds_read_b128 v[36:39], v7 offset:3072
  ds_read_b128 v[40:43], v7 offset:3328
  ds_read_b128 v[44:47], v7 offset:3584
  v_mfma_f32_16x16x32_bf16 v[48:51], v[16:19], v[184:187], v[48:51]
  v_mfma_f32_16x16x32_bf16 v[52:55], v[20:23], v[184:187], v[52:55]
  s_add_u32 m0, s23, 8192
  s_waitcnt vmcnt(4) lgkmcnt(0)
  buffer_load_dwordx4 v236, s[4:7], s21 offen lds
  buffer_load_dwordx4 v237, s[8:11], s21 offen offset:1024 lds
  ds_read_b64_tr_b16 v[16:17], v2 offset:0
  ds_read_b64_tr_b16 v[18:19], v2 offset:512
  ds_read_b64_tr_b16 v[20:21], v3 offset:0
  ds_read_b64_tr_b16 v[22:23], v3 offset:512
  v_mfma_f32_16x16x32_bf16 v[124:127], v[136:139], v[32:35], v[124:127]
  v_mfma_f32_16x16x32_bf16 v[116:119], v[140:143], v[36:39], v[116:119]
  v_mfma_f32_16x16x32_bf16 v[120:123], v[140:143], v[40:43], v[120:123]
  v_mfma_f32_16x16x32_bf16 v[124:127], v[140:143], v[44:47], v[124:127]
  ds_read_b128 v[32:35], v8 offset:18464
  ds_read_b128 v[36:39], v8 offset:18720
  ds_read_b128 v[40:43], v8 offset:18976
  ds_read_b128 v[44:47], v8 offset:21536
  v_mfma_f32_16x16x32_bf16 v[56:59], v[24:27], v[184:187], v[56:59]
  v_mfma_f32_16x16x32_bf16 v[60:63], v[28:31], v[184:187], v[60:63]
  v_xor_b32 v128, 0x80008000, v128
  v_xor_b32 v129, 0x80008000, v129
  v_xor_b32 v130, 0x80008000, v130
  v_xor_b32 v131, 0x80008000, v131
  v_xor_b32 v132, 0x80008000, v132
  v_xor_b32 v133, 0x80008000, v133
  v_xor_b32 v134, 0x80008000, v134
  v_xor_b32 v135, 0x80008000, v135
  s_add_u32 m0, s23, 10240
  s_waitcnt lgkmcnt(0)
  buffer_load_dwordx4 v238, s[4:7], s21 offen lds
  buffer_load_dwordx4 v239, s[8:11], s21 offen offset:1024 lds
  ds_read_b64_tr_b16 v[24:25], v4 offset:0
  ds_read_b64_tr_b16 v[26:27], v4 offset:512
  ds_read_b64_tr_b16 v[28:29], v5 offset:0
  ds_read_b64_tr_b16 v[30:31], v5 offset:512
  v_mfma_f32_16x16x32_bf16 v[80:83], v[144:147], v[32:35], v[80:83]
  v_mfma_f32_16x16x32_bf16 v[84:87], v[144:147], v[36:39], v[84:87]
  v_mfma_f32_16x16x32_bf16 v[88:91], v[144:147], v[40:43], v[88:91]
  v_mfma_f32_16x16x32_bf16 v[80:83], v[148:151], v[44:47], v[80:83]
  ds_read_b128 v[32:35], v8 offset:21792
  ds_read_b128 v[36:39], v8 offset:22048
  ds_read_b128 v[40:43], v7 offset:18464
  ds_read_b128 v[44:47], v7 offset:18720
  v_mfma_f32_16x16x32_bf16 v[48:51], v[16:19], v[188:191], v[48:51]
  v_mfma_f32_16x16x32_bf16 v[52:55], v[20:23], v[188:191], v[52:55]
  s_add_u32 m0, s23, 0
  s_waitcnt vmcnt(4) lgkmcnt(0)
  s_mov_b32 s21, 0
  buffer_load_dwordx4 v240, s[4:7], s21 offen lds
  buffer_load_dwordx4 v241, s[8:11], s21 offen offset:1024 lds
  ds_read_b64_tr_b16 v[16:17], v2 offset:4096
  ds_read_b64_tr_b16 v[18:19], v2 offset:4608
  ds_read_b64_tr_b16 v[20:21], v3 offset:4096
  ds_read_b64_tr_b16 v[22:23], v3 offset:4608
  v_mfma_f32_16x16x32_bf16 v[84:87], v[148:151], v[32:35], v[84:87]
  v_mfma_f32_16x16x32_bf16 v[88:91], v[148:151], v[36:39], v[88:91]
  v_mfma_f32_16x16x32_bf16 v[104:107], v[128:131], v[40:43], v[104:107]
  v_mfma_f32_16x16x32_bf16 v[108:111], v[128:131], v[44:47], v[108:111]
  ds_read_b128 v[32:35], v7 offset:18976
  ds_read_b128 v[36:39], v7 offset:21536
  ds_read_b128 v[40:43], v7 offset:21792
  ds_read_b128 v[44:47], v7 offset:22048
  v_mfma_f32_16x16x32_bf16 v[56:59], v[24:27], v[188:191], v[56:59]
  v_mfma_f32_16x16x32_bf16 v[60:63], v[28:31], v[188:191], v[60:63]
  s_add_u32 m0, s23, 2048
  s_waitcnt lgkmcnt(0)
  buffer_load_dwordx4 v242, s[4:7], s21 offen lds
  buffer_load_dwordx4 v243, s[8:11], s21 offen offset:1024 lds
  ds_read_b64_tr_b16 v[24:25], v4 offset:4096
  ds_read_b64_tr_b16 v[26:27], v4 offset:4608
  ds_read_b64_tr_b16 v[28:29], v5 offset:4096
  ds_read_b64_tr_b16 v[30:31], v5 offset:4608
  v_mfma_f32_16x16x32_bf16 v[112:115], v[128:131], v[32:35], v[112:115]
  v_mfma_f32_16x16x32_bf16 v[104:107], v[132:135], v[36:39], v[104:107]
  v_mfma_f32_16x16x32_bf16 v[108:111], v[132:135], v[40:43], v[108:111]
  v_mfma_f32_16x16x32_bf16 v[112:115], v[132:135], v[44:47], v[112:115]
  v_mfma_f32_16x16x32_bf16 v[48:51], v[16:19], v[192:195], v[48:51]
  v_mfma_f32_16x16x32_bf16 v[52:55], v[20:23], v[192:195], v[52:55]
  s_add_u32 m0, s23, 4096
  s_waitcnt vmcnt(4) lgkmcnt(0)
  buffer_load_dwordx4 v244, s[4:7], s21 offen lds
  buffer_load_dwordx4 v245, s[8:11], s21 offen offset:1024 lds
  ds_read_b64_tr_b16 v[16:17], v2 offset:8192
  ds_read_b64_tr_b16 v[18:19], v2 offset:8704
  ds_read_b64_tr_b16 v[20:21], v3 offset:8192
  ds_read_b64_tr_b16 v[22:23], v3 offset:8704
  v_mfma_f32_16x16x32_bf16 v[56:59], v[24:27], v[192:195], v[56:59]
  v_mfma_f32_16x16x32_bf16 v[60:63], v[28:31], v[192:195], v[60:63]
  s_add_u32 m0, s23, 6144
  s_waitcnt lgkmcnt(0)
  buffer_load_dwordx4 v246, s[4:7], s21 offen lds
  buffer_load_dwordx4 v247, s[8:11], s21 offen offset:1024 lds
  ds_read_b64_tr_b16 v[24:25], v4 offset:8192
  ds_read_b64_tr_b16 v[26:27], v4 offset:8704
  ds_read_b64_tr_b16 v[28:29], v5 offset:8192
  ds_read_b64_tr_b16 v[30:31], v5 offset:8704
  v_mfma_f32_16x16x32_bf16 v[48:51], v[16:19], v[196:199], v[48:51]
  v_mfma_f32_16x16x32_bf16 v[52:55], v[20:23], v[196:199], v[52:55]
  s_add_u32 m0, s23, 8192
  s_waitcnt lgkmcnt(0)
  v_mfma_f32_16x16x32_bf16 v[56:59], v[24:27], v[196:199], v[56:59]
  v_mfma_f32_16x16x32_bf16 v[60:63], v[28:31], v[196:199], v[60:63]
  s_waitcnt vmcnt(4) lgkmcnt(0)
  buffer_load_dwordx4 v224, s[4:7], s21 offen lds
  buffer_load_dwordx4 v225, s[8:11], s21 offen offset:1024 lds
  ds_read_b64_tr_b16 v[16:17], v2 offset:0
  ds_read_b64_tr_b16 v[18:19], v2 offset:512
  ds_read_b64_tr_b16 v[20:21], v3 offset:0
  ds_read_b64_tr_b16 v[22:23], v3 offset:512
  s_add_u32 s37, s44, 4096
  buffer_load_dwordx4 v[128:131], v10, s[12:15], s44 offen offset:0
  buffer_load_dwordx4 v[132:135], v10, s[12:15], s44 offen offset:1024
  buffer_load_dwordx4 v[136:139], v10, s[12:15], s37 offen offset:0
  buffer_load_dwordx4 v[140:143], v10, s[12:15], s37 offen offset:1024
  s_add_u32 m0, s23, 10240
  v_cvt_pk_bf16_f32 v32, v48, v49
  v_cvt_pk_bf16_f32 v33, v50, v51
  v_cvt_pk_bf16_f32 v34, v52, v53
  v_cvt_pk_bf16_f32 v35, v54, v55
  v_cvt_pk_bf16_f32 v36, v56, v57
  v_cvt_pk_bf16_f32 v37, v58, v59
  v_cvt_pk_bf16_f32 v38, v60, v61
  v_cvt_pk_bf16_f32 v39, v62, v63
  v_cvt_pk_bf16_f32 v40, v64, v65
  v_cvt_pk_bf16_f32 v41, v66, v67
  v_cvt_pk_bf16_f32 v42, v68, v69
  v_cvt_pk_bf16_f32 v43, v70, v71
  v_cvt_pk_bf16_f32 v44, v72, v73
  v_cvt_pk_bf16_f32 v45, v74, v75
  v_cvt_pk_bf16_f32 v46, v76, v77
  v_cvt_pk_bf16_f32 v47, v78, v79
  ds_write_b128 v6, v[32:35] offset:16
  ds_write_b128 v6, v[36:39] offset:3088
  s_mov_b64 exec, s[42:43]
  ds_write_b128 v6, v[40:43] offset:0
  ds_write_b128 v6, v[44:47] offset:3072
  s_mov_b64 exec, -1
  v_subrev_u32 v6, s77, v6
  s_waitcnt lgkmcnt(0)
  buffer_load_dwordx4 v226, s[4:7], s21 offen lds
  buffer_load_dwordx4 v227, s[8:11], s21 offen offset:1024 lds
  ds_read_b64_tr_b16 v[24:25], v4 offset:0
  ds_read_b64_tr_b16 v[26:27], v4 offset:512
  ds_read_b64_tr_b16 v[28:29], v5 offset:0
  ds_read_b64_tr_b16 v[30:31], v5 offset:512
  v_add_u32 v7, s77, v7
  v_add_u32 v8, s77, v8
  v_mfma_f32_16x16x32_bf16 v[48:51], v[16:19], v[176:179], 0
  v_mfma_f32_16x16x32_bf16 v[52:55], v[20:23], v[176:179], 0
  v_mfma_f32_16x16x32_bf16 v[64:67], v[16:19], v[200:203], 0
  v_mfma_f32_16x16x32_bf16 v[68:71], v[20:23], v[200:203], 0
  s_add_u32 m0, s23, 0
  s_waitcnt vmcnt(8) lgkmcnt(0)
  buffer_load_dwordx4 v228, s[4:7], s21 offen lds
  buffer_load_dwordx4 v229, s[8:11], s21 offen offset:1024 lds
  ds_read_b64_tr_b16 v[16:17], v2 offset:4096
  ds_read_b64_tr_b16 v[18:19], v2 offset:4608
  ds_read_b64_tr_b16 v[20:21], v3 offset:4096
  ds_read_b64_tr_b16 v[22:23], v3 offset:4608
  v_mfma_f32_16x16x32_bf16 v[56:59], v[24:27], v[176:179], 0
  v_mfma_f32_16x16x32_bf16 v[60:63], v[28:31], v[176:179], 0
  v_mfma_f32_16x16x32_bf16 v[72:75], v[24:27], v[200:203], 0
  v_mfma_f32_16x16x32_bf16 v[76:79], v[28:31], v[200:203], 0
  s_add_u32 m0, s23, 2048
  s_waitcnt lgkmcnt(0)
  s_barrier
  buffer_load_dwordx4 v230, s[4:7], s21 offen lds
  buffer_load_dwordx4 v231, s[8:11], s21 offen offset:1024 lds
  ds_read_b64_tr_b16 v[24:25], v4 offset:4096
  ds_read_b64_tr_b16 v[26:27], v4 offset:4608
  ds_read_b64_tr_b16 v[28:29], v5 offset:4096
  ds_read_b64_tr_b16 v[30:31], v5 offset:4608
  ds_read_b128 v[32:35], v8 offset:0
  ds_read_b128 v[36:39], v8 offset:256
  ds_read_b128 v[40:43], v8 offset:512
  ds_read_b128 v[44:47], v8 offset:3072
  v_mfma_f32_16x16x32_bf16 v[48:51], v[16:19], v[180:183], v[48:51]
  v_mfma_f32_16x16x32_bf16 v[52:55], v[20:23], v[180:183], v[52:55]
  s_add_u32 m0, s23, 4096
  s_waitcnt vmcnt(4) lgkmcnt(0)
  buffer_load_dwordx4 v232, s[4:7], s21 offen lds
  buffer_load_dwordx4 v233, s[8:11], s21 offen offset:1024 lds
  ds_read_b64_tr_b16 v[16:17], v2 offset:8192
  ds_read_b64_tr_b16 v[18:19], v2 offset:8704
  ds_read_b64_tr_b16 v[20:21], v3 offset:8192
  ds_read_b64_tr_b16 v[22:23], v3 offset:8704
  v_mfma_f32_16x16x32_bf16 v[92:95], v[152:155], v[32:35], v[92:95]
  v_mfma_f32_16x16x32_bf16 v[96:99], v[152:155], v[36:39], v[96:99]
  v_mfma_f32_16x16x32_bf16 v[100:103], v[152:155], v[40:43], v[100:103]
  v_mfma_f32_16x16x32_bf16 v[92:95], v[156:159], v[44:47], v[92:95]
  ds_read_b128 v[32:35], v8 offset:3328
  ds_read_b128 v[36:39], v8 offset:3584
  ds_read_b128 v[40:43], v7 offset:0
  ds_read_b128 v[44:47], v7 offset:256
  v_mfma_f32_16x16x32_bf16 v[56:59], v[24:27], v[180:183], v[56:59]
  v_mfma_f32_16x16x32_bf16 v[60:63], v[28:31], v[180:183], v[60:63]
  s_add_u32 m0, s23, 6144
  s_waitcnt lgkmcnt(0)
  buffer_load_dwordx4 v234, s[4:7], s21 offen lds
  buffer_load_dwordx4 v235, s[8:11], s21 offen offset:1024 lds
  ds_read_b64_tr_b16 v[24:25], v4 offset:8192
  ds_read_b64_tr_b16 v[26:27], v4 offset:8704
  ds_read_b64_tr_b16 v[28:29], v5 offset:8192
  ds_read_b64_tr_b16 v[30:31], v5 offset:8704
  v_mfma_f32_16x16x32_bf16 v[96:99], v[156:159], v[32:35], v[96:99]
  v_mfma_f32_16x16x32_bf16 v[100:103], v[156:159], v[36:39], v[100:103]
  v_mfma_f32_16x16x32_bf16 v[116:119], v[160:163], v[40:43], v[116:119]
  v_mfma_f32_16x16x32_bf16 v[120:123], v[160:163], v[44:47], v[120:123]
  ds_read_b128 v[32:35], v7 offset:512
  ds_read_b128 v[36:39], v7 offset:3072
  ds_read_b128 v[40:43], v7 offset:3328
  ds_read_b128 v[44:47], v7 offset:3584
  v_mfma_f32_16x16x32_bf16 v[48:51], v[16:19], v[184:187], v[48:51]
  v_mfma_f32_16x16x32_bf16 v[52:55], v[20:23], v[184:187], v[52:55]
  s_add_u32 m0, s23, 8192
  s_waitcnt vmcnt(4) lgkmcnt(0)
  buffer_load_dwordx4 v236, s[4:7], s21 offen lds
  buffer_load_dwordx4 v237, s[8:11], s21 offen offset:1024 lds
  ds_read_b64_tr_b16 v[16:17], v2 offset:0
  ds_read_b64_tr_b16 v[18:19], v2 offset:512
  ds_read_b64_tr_b16 v[20:21], v3 offset:0
  ds_read_b64_tr_b16 v[22:23], v3 offset:512
  v_mfma_f32_16x16x32_bf16 v[124:127], v[160:163], v[32:35], v[124:127]
  v_mfma_f32_16x16x32_bf16 v[116:119], v[164:167], v[36:39], v[116:119]
  v_mfma_f32_16x16x32_bf16 v[120:123], v[164:167], v[40:43], v[120:123]
  v_mfma_f32_16x16x32_bf16 v[124:127], v[164:167], v[44:47], v[124:127]
  ds_read_b128 v[32:35], v8 offset:18464
  ds_read_b128 v[36:39], v8 offset:18720
  ds_read_b128 v[40:43], v8 offset:18976
  ds_read_b128 v[44:47], v8 offset:21536
  v_mfma_f32_16x16x32_bf16 v[56:59], v[24:27], v[184:187], v[56:59]
  v_mfma_f32_16x16x32_bf16 v[60:63], v[28:31], v[184:187], v[60:63]
  v_xor_b32 v152, 0x80008000, v152
  v_xor_b32 v153, 0x80008000, v153
  v_xor_b32 v154, 0x80008000, v154
  v_xor_b32 v155, 0x80008000, v155
  v_xor_b32 v156, 0x80008000, v156
  v_xor_b32 v157, 0x80008000, v157
  v_xor_b32 v158, 0x80008000, v158
  v_xor_b32 v159, 0x80008000, v159
  s_add_u32 m0, s23, 10240
  s_waitcnt lgkmcnt(0)
  buffer_load_dwordx4 v238, s[4:7], s21 offen lds
  buffer_load_dwordx4 v239, s[8:11], s21 offen offset:1024 lds
  ds_read_b64_tr_b16 v[24:25], v4 offset:0
  ds_read_b64_tr_b16 v[26:27], v4 offset:512
  ds_read_b64_tr_b16 v[28:29], v5 offset:0
  ds_read_b64_tr_b16 v[30:31], v5 offset:512
  v_mfma_f32_16x16x32_bf16 v[80:83], v[168:171], v[32:35], v[80:83]
  v_mfma_f32_16x16x32_bf16 v[84:87], v[168:171], v[36:39], v[84:87]
  v_mfma_f32_16x16x32_bf16 v[88:91], v[168:171], v[40:43], v[88:91]
  v_mfma_f32_16x16x32_bf16 v[80:83], v[172:175], v[44:47], v[80:83]
  ds_read_b128 v[32:35], v8 offset:21792
  ds_read_b128 v[36:39], v8 offset:22048
  ds_read_b128 v[40:43], v7 offset:18464
  ds_read_b128 v[44:47], v7 offset:18720
  v_mfma_f32_16x16x32_bf16 v[48:51], v[16:19], v[188:191], v[48:51]
  v_mfma_f32_16x16x32_bf16 v[52:55], v[20:23], v[188:191], v[52:55]
  s_add_u32 m0, s23, 0
  s_waitcnt vmcnt(4) lgkmcnt(0)
  s_mov_b32 s21, 128
  buffer_load_dwordx4 v240, s[4:7], s21 offen lds
  buffer_load_dwordx4 v241, s[8:11], s21 offen offset:1024 lds
  ds_read_b64_tr_b16 v[16:17], v2 offset:4096
  ds_read_b64_tr_b16 v[18:19], v2 offset:4608
  ds_read_b64_tr_b16 v[20:21], v3 offset:4096
  ds_read_b64_tr_b16 v[22:23], v3 offset:4608
  v_mfma_f32_16x16x32_bf16 v[84:87], v[172:175], v[32:35], v[84:87]
  v_mfma_f32_16x16x32_bf16 v[88:91], v[172:175], v[36:39], v[88:91]
  v_mfma_f32_16x16x32_bf16 v[104:107], v[152:155], v[40:43], v[104:107]
  v_mfma_f32_16x16x32_bf16 v[108:111], v[152:155], v[44:47], v[108:111]
  ds_read_b128 v[32:35], v7 offset:18976
  ds_read_b128 v[36:39], v7 offset:21536
  ds_read_b128 v[40:43], v7 offset:21792
  ds_read_b128 v[44:47], v7 offset:22048
  v_mfma_f32_16x16x32_bf16 v[56:59], v[24:27], v[188:191], v[56:59]
  v_mfma_f32_16x16x32_bf16 v[60:63], v[28:31], v[188:191], v[60:63]
  s_add_u32 m0, s23, 2048
  s_waitcnt lgkmcnt(0)
  buffer_load_dwordx4 v242, s[4:7], s21 offen lds
  buffer_load_dwordx4 v243, s[8:11], s21 offen offset:1024 lds
  ds_read_b64_tr_b16 v[24:25], v4 offset:4096
  ds_read_b64_tr_b16 v[26:27], v4 offset:4608
  ds_read_b64_tr_b16 v[28:29], v5 offset:4096
  ds_read_b64_tr_b16 v[30:31], v5 offset:4608
  v_mfma_f32_16x16x32_bf16 v[112:115], v[152:155], v[32:35], v[112:115]
  v_mfma_f32_16x16x32_bf16 v[104:107], v[156:159], v[36:39], v[104:107]
  v_mfma_f32_16x16x32_bf16 v[108:111], v[156:159], v[40:43], v[108:111]
  v_mfma_f32_16x16x32_bf16 v[112:115], v[156:159], v[44:47], v[112:115]
  v_mfma_f32_16x16x32_bf16 v[48:51], v[16:19], v[192:195], v[48:51]
  v_mfma_f32_16x16x32_bf16 v[52:55], v[20:23], v[192:195], v[52:55]
  s_add_u32 m0, s23, 4096
  s_waitcnt vmcnt(4) lgkmcnt(0)
  buffer_load_dwordx4 v244, s[4:7], s21 offen lds
  buffer_load_dwordx4 v245, s[8:11], s21 offen offset:1024 lds
  ds_read_b64_tr_b16 v[16:17], v2 offset:8192
  ds_read_b64_tr_b16 v[18:19], v2 offset:8704
  ds_read_b64_tr_b16 v[20:21], v3 offset:8192
  ds_read_b64_tr_b16 v[22:23], v3 offset:8704
  v_mfma_f32_16x16x32_bf16 v[56:59], v[24:27], v[192:195], v[56:59]
  v_mfma_f32_16x16x32_bf16 v[60:63], v[28:31], v[192:195], v[60:63]
  s_add_u32 m0, s23, 6144
  s_waitcnt lgkmcnt(0)
  buffer_load_dwordx4 v246, s[4:7], s21 offen lds
  buffer_load_dwordx4 v247, s[8:11], s21 offen offset:1024 lds
  ds_read_b64_tr_b16 v[24:25], v4 offset:8192
  ds_read_b64_tr_b16 v[26:27], v4 offset:8704
  ds_read_b64_tr_b16 v[28:29], v5 offset:8192
  ds_read_b64_tr_b16 v[30:31], v5 offset:8704
  v_mfma_f32_16x16x32_bf16 v[48:51], v[16:19], v[196:199], v[48:51]
  v_mfma_f32_16x16x32_bf16 v[52:55], v[20:23], v[196:199], v[52:55]
  s_add_u32 m0, s23, 8192
  s_waitcnt lgkmcnt(0)
  v_mfma_f32_16x16x32_bf16 v[56:59], v[24:27], v[196:199], v[56:59]
  v_mfma_f32_16x16x32_bf16 v[60:63], v[28:31], v[196:199], v[60:63]
  s_waitcnt vmcnt(4) lgkmcnt(0)
  buffer_load_dwordx4 v224, s[4:7], s21 offen lds
  buffer_load_dwordx4 v225, s[8:11], s21 offen offset:1024 lds
  ds_read_b64_tr_b16 v[16:17], v2 offset:0
  ds_read_b64_tr_b16 v[18:19], v2 offset:512
  ds_read_b64_tr_b16 v[20:21], v3 offset:0
  ds_read_b64_tr_b16 v[22:23], v3 offset:512
  s_add_u32 s37, s44, 4096
  buffer_load_dwordx4 v[152:155], v10, s[12:15], s44 offen offset:2048
  buffer_load_dwordx4 v[156:159], v10, s[12:15], s44 offen offset:3072
  buffer_load_dwordx4 v[160:163], v10, s[12:15], s37 offen offset:2048
  buffer_load_dwordx4 v[164:167], v10, s[12:15], s37 offen offset:3072
  s_add_u32 m0, s23, 10240
  v_cvt_pk_bf16_f32 v32, v48, v49
  v_cvt_pk_bf16_f32 v33, v50, v51
  v_cvt_pk_bf16_f32 v34, v52, v53
  v_cvt_pk_bf16_f32 v35, v54, v55
  v_cvt_pk_bf16_f32 v36, v56, v57
  v_cvt_pk_bf16_f32 v37, v58, v59
  v_cvt_pk_bf16_f32 v38, v60, v61
  v_cvt_pk_bf16_f32 v39, v62, v63
  v_cvt_pk_bf16_f32 v40, v64, v65
  v_cvt_pk_bf16_f32 v41, v66, v67
  v_cvt_pk_bf16_f32 v42, v68, v69
  v_cvt_pk_bf16_f32 v43, v70, v71
  v_cvt_pk_bf16_f32 v44, v72, v73
  v_cvt_pk_bf16_f32 v45, v74, v75
  v_cvt_pk_bf16_f32 v46, v76, v77
  v_cvt_pk_bf16_f32 v47, v78, v79
  ds_write_b128 v6, v[32:35] offset:16
  ds_write_b128 v6, v[36:39] offset:3088
  s_mov_b64 exec, s[42:43]
  ds_write_b128 v6, v[40:43] offset:0
  ds_write_b128 v6, v[44:47] offset:3072
  s_mov_b64 exec, -1
  v_add_u32 v6, s77, v6
  s_waitcnt lgkmcnt(0)
  buffer_load_dwordx4 v226, s[4:7], s21 offen lds
  buffer_load_dwordx4 v227, s[8:11], s21 offen offset:1024 lds
  ds_read_b64_tr_b16 v[24:25], v4 offset:0
  ds_read_b64_tr_b16 v[26:27], v4 offset:512
  ds_read_b64_tr_b16 v[28:29], v5 offset:0
  ds_read_b64_tr_b16 v[30:31], v5 offset:512
  v_subrev_u32 v7, s77, v7
  v_subrev_u32 v8, s77, v8
  v_mfma_f32_16x16x32_bf16 v[48:51], v[16:19], v[176:179], 0
  v_mfma_f32_16x16x32_bf16 v[52:55], v[20:23], v[176:179], 0
  v_mfma_f32_16x16x32_bf16 v[64:67], v[16:19], v[200:203], 0
  v_mfma_f32_16x16x32_bf16 v[68:71], v[20:23], v[200:203], 0
  s_add_u32 m0, s23, 0
  s_waitcnt vmcnt(8) lgkmcnt(0)
  buffer_load_dwordx4 v228, s[4:7], s21 offen lds
  buffer_load_dwordx4 v229, s[8:11], s21 offen offset:1024 lds
  ds_read_b64_tr_b16 v[16:17], v2 offset:4096
  ds_read_b64_tr_b16 v[18:19], v2 offset:4608
  ds_read_b64_tr_b16 v[20:21], v3 offset:4096
  ds_read_b64_tr_b16 v[22:23], v3 offset:4608
  v_mfma_f32_16x16x32_bf16 v[56:59], v[24:27], v[176:179], 0
  v_mfma_f32_16x16x32_bf16 v[60:63], v[28:31], v[176:179], 0
  v_mfma_f32_16x16x32_bf16 v[72:75], v[24:27], v[200:203], 0
  v_mfma_f32_16x16x32_bf16 v[76:79], v[28:31], v[200:203], 0
  s_add_u32 m0, s23, 2048
  s_waitcnt lgkmcnt(0)
  s_barrier
  buffer_load_dwordx4 v230, s[4:7], s21 offen lds
  buffer_load_dwordx4 v231, s[8:11], s21 offen offset:1024 lds
  ds_read_b64_tr_b16 v[24:25], v4 offset:4096
  ds_read_b64_tr_b16 v[26:27], v4 offset:4608
  ds_read_b64_tr_b16 v[28:29], v5 offset:4096
  ds_read_b64_tr_b16 v[30:31], v5 offset:4608
  ds_read_b128 v[32:35], v7 offset:0
  ds_read_b128 v[36:39], v7 offset:256
  ds_read_b128 v[40:43], v7 offset:512
  ds_read_b128 v[44:47], v7 offset:3072
  v_mfma_f32_16x16x32_bf16 v[48:51], v[16:19], v[180:183], v[48:51]
  v_mfma_f32_16x16x32_bf16 v[52:55], v[20:23], v[180:183], v[52:55]
  s_add_u32 m0, s23, 4096
  s_waitcnt vmcnt(4) lgkmcnt(0)
  buffer_load_dwordx4 v232, s[4:7], s21 offen lds
  buffer_load_dwordx4 v233, s[8:11], s21 offen offset:1024 lds
  ds_read_b64_tr_b16 v[16:17], v2 offset:8192
  ds_read_b64_tr_b16 v[18:19], v2 offset:8704
  ds_read_b64_tr_b16 v[20:21], v3 offset:8192
  ds_read_b64_tr_b16 v[22:23], v3 offset:8704
  v_mfma_f32_16x16x32_bf16 v[80:83], v[128:131], v[32:35], v[80:83]
  v_mfma_f32_16x16x32_bf16 v[84:87], v[128:131], v[36:39], v[84:87]
  v_mfma_f32_16x16x32_bf16 v[88:91], v[128:131], v[40:43], v[88:91]
  v_mfma_f32_16x16x32_bf16 v[80:83], v[132:135], v[44:47], v[80:83]
  ds_read_b128 v[32:35], v7 offset:3328
  ds_read_b128 v[36:39], v7 offset:3584
  ds_read_b128 v[40:43], v7 offset:18464
  ds_read_b128 v[44:47], v7 offset:18720
  v_mfma_f32_16x16x32_bf16 v[56:59], v[24:27], v[180:183], v[56:59]
  v_mfma_f32_16x16x32_bf16 v[60:63], v[28:31], v[180:183], v[60:63]
  s_add_u32 m0, s23, 6144
  s_waitcnt lgkmcnt(0)
  buffer_load_dwordx4 v234, s[4:7], s21 offen lds
  buffer_load_dwordx4 v235, s[8:11], s21 offen offset:1024 lds
  ds_read_b64_tr_b16 v[24:25], v4 offset:8192
  ds_read_b64_tr_b16 v[26:27], v4 offset:8704
  ds_read_b64_tr_b16 v[28:29], v5 offset:8192
  ds_read_b64_tr_b16 v[30:31], v5 offset:8704
  v_mfma_f32_16x16x32_bf16 v[84:87], v[132:135], v[32:35], v[84:87]
  v_mfma_f32_16x16x32_bf16 v[88:91], v[132:135], v[36:39], v[88:91]
  v_mfma_f32_16x16x32_bf16 v[92:95], v[136:139], v[40:43], v[92:95]
  v_mfma_f32_16x16x32_bf16 v[96:99], v[136:139], v[44:47], v[96:99]
  ds_read_b128 v[32:35], v7 offset:18976
  ds_read_b128 v[36:39], v7 offset:21536
  ds_read_b128 v[40:43], v7 offset:21792
  ds_read_b128 v[44:47], v7 offset:22048
  v_mfma_f32_16x16x32_bf16 v[48:51], v[16:19], v[184:187], v[48:51]
  v_mfma_f32_16x16x32_bf16 v[52:55], v[20:23], v[184:187], v[52:55]
  s_add_u32 m0, s23, 8192
  s_waitcnt vmcnt(4) lgkmcnt(0)
  buffer_load_dwordx4 v236, s[4:7], s21 offen lds
  buffer_load_dwordx4 v237, s[8:11], s21 offen offset:1024 lds
  ds_read_b64_tr_b16 v[16:17], v2 offset:0
  ds_read_b64_tr_b16 v[18:19], v2 offset:512
  ds_read_b64_tr_b16 v[20:21], v3 offset:0
  ds_read_b64_tr_b16 v[22:23], v3 offset:512
  v_mfma_f32_16x16x32_bf16 v[100:103], v[136:139], v[32:35], v[100:103]
  v_mfma_f32_16x16x32_bf16 v[92:95], v[140:143], v[36:39], v[92:95]
  v_mfma_f32_16x16x32_bf16 v[96:99], v[140:143], v[40:43], v[96:99]
  v_mfma_f32_16x16x32_bf16 v[100:103], v[140:143], v[44:47], v[100:103]
  ds_read_b128 v[32:35], v8 offset:0
  ds_read_b128 v[36:39], v8 offset:256
  ds_read_b128 v[40:43], v8 offset:512
  ds_read_b128 v[44:47], v8 offset:3072
  v_mfma_f32_16x16x32_bf16 v[56:59], v[24:27], v[184:187], v[56:59]
  v_mfma_f32_16x16x32_bf16 v[60:63], v[28:31], v[184:187], v[60:63]
  s_add_u32 m0, s23, 10240
  s_waitcnt lgkmcnt(0)
  buffer_load_dwordx4 v238, s[4:7], s21 offen lds
  buffer_load_dwordx4 v239, s[8:11], s21 offen offset:1024 lds
  ds_read_b64_tr_b16 v[24:25], v4 offset:0
  ds_read_b64_tr_b16 v[26:27], v4 offset:512
  ds_read_b64_tr_b16 v[28:29], v5 offset:0
  ds_read_b64_tr_b16 v[30:31], v5 offset:512
  v_mfma_f32_16x16x32_bf16 v[104:107], v[136:139], v[32:35], v[104:107]
  v_mfma_f32_16x16x32_bf16 v[108:111], v[136:139], v[36:39], v[108:111]
  v_mfma_f32_16x16x32_bf16 v[112:115], v[136:139], v[40:43], v[112:115]
  v_mfma_f32_16x16x32_bf16 v[104:107], v[140:143], v[44:47], v[104:107]
  ds_read_b128 v[32:35], v8 offset:3328
  ds_read_b128 v[36:39], v8 offset:3584
  ds_read_b128 v[40:43], v8 offset:18464
  ds_read_b128 v[44:47], v8 offset:18720
  v_mfma_f32_16x16x32_bf16 v[48:51], v[16:19], v[188:191], v[48:51]
  v_mfma_f32_16x16x32_bf16 v[52:55], v[20:23], v[188:191], v[52:55]
  s_waitcnt vmcnt(4) lgkmcnt(0)
  ds_read_b64_tr_b16 v[16:17], v2 offset:4096
  ds_read_b64_tr_b16 v[18:19], v2 offset:4608
  ds_read_b64_tr_b16 v[20:21], v3 offset:4096
  ds_read_b64_tr_b16 v[22:23], v3 offset:4608
  v_mfma_f32_16x16x32_bf16 v[108:111], v[140:143], v[32:35], v[108:111]
  v_mfma_f32_16x16x32_bf16 v[112:115], v[140:143], v[36:39], v[112:115]
  v_mfma_f32_16x16x32_bf16 v[116:119], v[136:139], v[40:43], v[116:119]
  v_mfma_f32_16x16x32_bf16 v[120:123], v[136:139], v[44:47], v[120:123]
  ds_read_b128 v[32:35], v8 offset:18976
  ds_read_b128 v[36:39], v8 offset:21536
  ds_read_b128 v[40:43], v8 offset:21792
  ds_read_b128 v[44:47], v8 offset:22048
  v_mfma_f32_16x16x32_bf16 v[56:59], v[24:27], v[188:191], v[56:59]
  v_mfma_f32_16x16x32_bf16 v[60:63], v[28:31], v[188:191], v[60:63]
  s_waitcnt lgkmcnt(0)
  ds_read_b64_tr_b16 v[24:25], v4 offset:4096
  ds_read_b64_tr_b16 v[26:27], v4 offset:4608
  ds_read_b64_tr_b16 v[28:29], v5 offset:4096
  ds_read_b64_tr_b16 v[30:31], v5 offset:4608
  v_mfma_f32_16x16x32_bf16 v[124:127], v[136:139], v[32:35], v[124:127]
  v_mfma_f32_16x16x32_bf16 v[116:119], v[140:143], v[36:39], v[116:119]
  v_mfma_f32_16x16x32_bf16 v[120:123], v[140:143], v[40:43], v[120:123]
  v_mfma_f32_16x16x32_bf16 v[124:127], v[140:143], v[44:47], v[124:127]
  v_mfma_f32_16x16x32_bf16 v[48:51], v[16:19], v[192:195], v[48:51]
  v_mfma_f32_16x16x32_bf16 v[52:55], v[20:23], v[192:195], v[52:55]
  s_waitcnt vmcnt(0) lgkmcnt(0)
  ds_read_b64_tr_b16 v[16:17], v2 offset:8192
  ds_read_b64_tr_b16 v[18:19], v2 offset:8704
  ds_read_b64_tr_b16 v[20:21], v3 offset:8192
  ds_read_b64_tr_b16 v[22:23], v3 offset:8704
  v_mfma_f32_16x16x32_bf16 v[56:59], v[24:27], v[192:195], v[56:59]
  v_mfma_f32_16x16x32_bf16 v[60:63], v[28:31], v[192:195], v[60:63]
  s_waitcnt lgkmcnt(0)
  ds_read_b64_tr_b16 v[24:25], v4 offset:8192
  ds_read_b64_tr_b16 v[26:27], v4 offset:8704
  ds_read_b64_tr_b16 v[28:29], v5 offset:8192
  ds_read_b64_tr_b16 v[30:31], v5 offset:8704
  v_mfma_f32_16x16x32_bf16 v[48:51], v[16:19], v[196:199], v[48:51]
  v_mfma_f32_16x16x32_bf16 v[52:55], v[20:23], v[196:199], v[52:55]
  s_waitcnt lgkmcnt(0)
  v_mfma_f32_16x16x32_bf16 v[56:59], v[24:27], v[196:199], v[56:59]
  v_mfma_f32_16x16x32_bf16 v[60:63], v[28:31], v[196:199], v[60:63]
  s_branch K2_TAIL
K2_VG:
  s_waitcnt lgkmcnt(0)
  ds_read_b64_tr_b16 v[204:205], v252 offset:2080
  ds_read_b64_tr_b16 v[206:207], v252 offset:2336
  ds_read_b64_tr_b16 v[208:209], v252 offset:4128
  ds_read_b64_tr_b16 v[210:211], v252 offset:4384
  ds_read_b64_tr_b16 v[212:213], v252 offset:6176
  ds_read_b64_tr_b16 v[214:215], v252 offset:6432
  ds_read_b64_tr_b16 v[216:217], v252 offset:8224
  ds_read_b64_tr_b16 v[218:219], v252 offset:8480
  ds_read_b64_tr_b16 v[220:221], v252 offset:10272
  ds_read_b64_tr_b16 v[222:223], v252 offset:10528
  v_mov_b32 v240, v16
  v_mov_b32 v241, v17
  v_mov_b32 v242, v18
  v_mov_b32 v243, v19
  v_mov_b32 v244, v20
  v_mov_b32 v245, v21
  v_mov_b32 v246, v22
  v_mov_b32 v247, v23
  s_waitcnt lgkmcnt(0)
  buffer_load_dwordx4 v22, s[4:7], s21 offen lds
  buffer_load_dwordx4 v23, s[8:11], s21 offen offset:1024 lds
  s_add_u32 m0, s23, 8192
  s_lshl_b32 s46, s3, 3
  v_readlane_b32 s72, v254, s46
  s_add_u32 s46, s46, 1
  v_readlane_b32 s73, v254, s46
  s_add_u32 s46, s46, 1
  v_readlane_b32 s74, v254, s46
  s_add_u32 s46, s46, 1
  v_readlane_b32 s75, v254, s46
  s_add_u32 s46, s46, 1
  v_readlane_b32 s76, v254, s46
  s_mul_i32 s46, s2, 625
  s_add_u32 s45, s46, 15
  s_lshr_b32 s45, s45, 4
  s_add_u32 s46, s46, 640
  s_lshr_b32 s46, s46, 4
  s_sub_u32 s46, s46, s45
  s_mov_b32 s81, 0
  s_cmp_lt_u32 s72, s46
  s_cselect_b32 s47, 1, 0
  s_or_b32 s81, s81, s47
  s_cmp_lt_u32 s73, s46
  s_cselect_b32 s47, 2, 0
  s_or_b32 s81, s81, s47
  s_cmp_lt_u32 s74, s46
  s_cselect_b32 s47, 4, 0
  s_or_b32 s81, s81, s47
  s_cmp_lt_u32 s75, s46
  s_cselect_b32 s47, 8, 0
  s_or_b32 s81, s81, s47
  s_cmp_lt_u32 s76, s46
  s_cselect_b32 s47, 16, 0
  s_or_b32 s81, s81, s47
  s_add_u32 s72, s72, s45
  s_lshl_b32 s72, s72, 10
  s_add_u32 s73, s73, s45
  s_lshl_b32 s73, s73, 10
  s_add_u32 s74, s74, s45
  s_lshl_b32 s74, s74, 10
  s_add_u32 s75, s75, s45
  s_lshl_b32 s75, s75, 10
  s_add_u32 s76, s76, s45
  s_lshl_b32 s76, s76, 10
  s_waitcnt vmcnt(4) lgkmcnt(0)
  buffer_load_dwordx4 v224, s[4:7], s21 offen lds
  buffer_load_dwordx4 v225, s[8:11], s21 offen offset:1024 lds
  ds_read_b64_tr_b16 v[16:17], v2 offset:0
  ds_read_b64_tr_b16 v[18:19], v2 offset:512
  ds_read_b64_tr_b16 v[20:21], v3 offset:0
  ds_read_b64_tr_b16 v[22:23], v3 offset:512
  s_add_u32 m0, s23, 10240
  s_waitcnt lgkmcnt(0)
  buffer_load_dwordx4 v226, s[4:7], s21 offen lds
  buffer_load_dwordx4 v227, s[8:11], s21 offen offset:1024 lds
  ds_read_b64_tr_b16 v[24:25], v4 offset:0
  ds_read_b64_tr_b16 v[26:27], v4 offset:512
  ds_read_b64_tr_b16 v[28:29], v5 offset:0
  ds_read_b64_tr_b16 v[30:31], v5 offset:512
  v_mfma_f32_16x16x32_bf16 v[48:51], v[16:19], v[176:179], 0
  v_mfma_f32_16x16x32_bf16 v[52:55], v[20:23], v[176:179], 0
  v_mfma_f32_16x16x32_bf16 v[64:67], v[16:19], v[200:203], 0
  v_mfma_f32_16x16x32_bf16 v[68:71], v[20:23], v[200:203], 0
  s_add_u32 m0, s23, 0
  s_waitcnt vmcnt(4) lgkmcnt(0)
  buffer_load_dwordx4 v228, s[4:7], s21 offen lds
  buffer_load_dwordx4 v229, s[8:11], s21 offen offset:1024 lds
  ds_read_b64_tr_b16 v[16:17], v2 offset:4096
  ds_read_b64_tr_b16 v[18:19], v2 offset:4608
  ds_read_b64_tr_b16 v[20:21], v3 offset:4096
  ds_read_b64_tr_b16 v[22:23], v3 offset:4608
  v_mfma_f32_16x16x32_bf16 v[56:59], v[24:27], v[176:179], 0
  v_mfma_f32_16x16x32_bf16 v[60:63], v[28:31], v[176:179], 0
  v_mfma_f32_16x16x32_bf16 v[72:75], v[24:27], v[200:203], 0
  v_mfma_f32_16x16x32_bf16 v[76:79], v[28:31], v[200:203], 0
  s_add_u32 m0, s23, 2048
  s_waitcnt lgkmcnt(0)
  s_barrier
  buffer_load_dwordx4 v230, s[4:7], s21 offen lds
  buffer_load_dwordx4 v231, s[8:11], s21 offen offset:1024 lds
  ds_read_b64_tr_b16 v[24:25], v4 offset:4096
  ds_read_b64_tr_b16 v[26:27], v4 offset:4608
  ds_read_b64_tr_b16 v[28:29], v5 offset:4096
  ds_read_b64_tr_b16 v[30:31], v5 offset:4608
  v_mfma_f32_16x16x32_bf16 v[48:51], v[16:19], v[180:183], v[48:51]
  v_mfma_f32_16x16x32_bf16 v[52:55], v[20:23], v[180:183], v[52:55]
  v_mfma_f32_16x16x32_bf16 v[64:67], v[16:19], v[204:207], v[64:67]
  v_mfma_f32_16x16x32_bf16 v[68:71], v[20:23], v[204:207], v[68:71]
  s_add_u32 m0, s23, 4096
  s_waitcnt vmcnt(4) lgkmcnt(0)
  buffer_load_dwordx4 v232, s[4:7], s21 offen lds
  buffer_load_dwordx4 v233, s[8:11], s21 offen offset:1024 lds
  ds_read_b64_tr_b16 v[16:17], v2 offset:8192
  ds_read_b64_tr_b16 v[18:19], v2 offset:8704
  ds_read_b64_tr_b16 v[20:21], v3 offset:8192
  ds_read_b64_tr_b16 v[22:23], v3 offset:8704
  v_mfma_f32_16x16x32_bf16 v[56:59], v[24:27], v[180:183], v[56:59]
  v_mfma_f32_16x16x32_bf16 v[60:63], v[28:31], v[180:183], v[60:63]
  v_mfma_f32_16x16x32_bf16 v[72:75], v[24:27], v[204:207], v[72:75]
  v_mfma_f32_16x16x32_bf16 v[76:79], v[28:31], v[204:207], v[76:79]
  s_add_u32 m0, s23, 6144
  s_waitcnt lgkmcnt(0)
  buffer_load_dwordx4 v234, s[4:7], s21 offen lds
  buffer_load_dwordx4 v235, s[8:11], s21 offen offset:1024 lds
  ds_read_b64_tr_b16 v[24:25], v4 offset:8192
  ds_read_b64_tr_b16 v[26:27], v4 offset:8704
  ds_read_b64_tr_b16 v[28:29], v5 offset:8192
  ds_read_b64_tr_b16 v[30:31], v5 offset:8704
  v_mfma_f32_16x16x32_bf16 v[48:51], v[16:19], v[184:187], v[48:51]
  v_mfma_f32_16x16x32_bf16 v[52:55], v[20:23], v[184:187], v[52:55]
  v_mfma_f32_16x16x32_bf16 v[64:67], v[16:19], v[208:211], v[64:67]
  v_mfma_f32_16x16x32_bf16 v[68:71], v[20:23], v[208:211], v[68:71]
  s_add_u32 m0, s23, 8192
  s_waitcnt vmcnt(4) lgkmcnt(0)
  buffer_load_dwordx4 v236, s[4:7], s21 offen lds
  buffer_load_dwordx4 v237, s[8:11], s21 offen offset:1024 lds
  ds_read_b64_tr_b16 v[16:17], v2 offset:0
  ds_read_b64_tr_b16 v[18:19], v2 offset:512
  ds_read_b64_tr_b16 v[20:21], v3 offset:0
  ds_read_b64_tr_b16 v[22:23], v3 offset:512
  v_mfma_f32_16x16x32_bf16 v[56:59], v[24:27], v[184:187], v[56:59]
  v_mfma_f32_16x16x32_bf16 v[60:63], v[28:31], v[184:187], v[60:63]
  v_mfma_f32_16x16x32_bf16 v[72:75], v[24:27], v[208:211], v[72:75]
  v_mfma_f32_16x16x32_bf16 v[76:79], v[28:31], v[208:211], v[76:79]
  s_add_u32 m0, s23, 10240
  s_waitcnt lgkmcnt(0)
  buffer_load_dwordx4 v238, s[4:7], s21 offen lds
  buffer_load_dwordx4 v239, s[8:11], s21 offen offset:1024 lds
  ds_read_b64_tr_b16 v[24:25], v4 offset:0
  ds_read_b64_tr_b16 v[26:27], v4 offset:512
  ds_read_b64_tr_b16 v[28:29], v5 offset:0
  ds_read_b64_tr_b16 v[30:31], v5 offset:512
  v_mfma_f32_16x16x32_bf16 v[48:51], v[16:19], v[188:191], v[48:51]
  v_mfma_f32_16x16x32_bf16 v[52:55], v[20:23], v[188:191], v[52:55]
  v_mfma_f32_16x16x32_bf16 v[64:67], v[16:19], v[212:215], v[64:67]
  v_mfma_f32_16x16x32_bf16 v[68:71], v[20:23], v[212:215], v[68:71]
  s_add_u32 m0, s23, 0
  s_waitcnt vmcnt(4) lgkmcnt(0)
  s_mov_b32 s21, 256
  buffer_load_dwordx4 v240, s[4:7], s21 offen lds
  buffer_load_dwordx4 v241, s[8:11], s21 offen offset:1024 lds
  ds_read_b64_tr_b16 v[16:17], v2 offset:4096
  ds_read_b64_tr_b16 v[18:19], v2 offset:4608
  ds_read_b64_tr_b16 v[20:21], v3 offset:4096
  ds_read_b64_tr_b16 v[22:23], v3 offset:4608
  v_mfma_f32_16x16x32_bf16 v[56:59], v[24:27], v[188:191], v[56:59]
  v_mfma_f32_16x16x32_bf16 v[60:63], v[28:31], v[188:191], v[60:63]
  v_mfma_f32_16x16x32_bf16 v[72:75], v[24:27], v[212:215], v[72:75]
  v_mfma_f32_16x16x32_bf16 v[76:79], v[28:31], v[212:215], v[76:79]
  s_add_u32 m0, s23, 2048
  s_waitcnt lgkmcnt(0)
  buffer_load_dwordx4 v242, s[4:7], s21 offen lds
  buffer_load_dwordx4 v243, s[8:11], s21 offen offset:1024 lds
  ds_read_b64_tr_b16 v[24:25], v4 offset:4096
  ds_read_b64_tr_b16 v[26:27], v4 offset:4608
  ds_read_b64_tr_b16 v[28:29], v5 offset:4096
  ds_read_b64_tr_b16 v[30:31], v5 offset:4608
  v_mfma_f32_16x16x32_bf16 v[48:51], v[16:19], v[192:195], v[48:51]
  v_mfma_f32_16x16x32_bf16 v[52:55], v[20:23], v[192:195], v[52:55]
  v_mfma_f32_16x16x32_bf16 v[64:67], v[16:19], v[216:219], v[64:67]
  v_mfma_f32_16x16x32_bf16 v[68:71], v[20:23], v[216:219], v[68:71]
  s_add_u32 m0, s23, 4096
  s_waitcnt vmcnt(4) lgkmcnt(0)
  buffer_load_dwordx4 v244, s[4:7], s21 offen lds
  buffer_load_dwordx4 v245, s[8:11], s21 offen offset:1024 lds
  ds_read_b64_tr_b16 v[16:17], v2 offset:8192
  ds_read_b64_tr_b16 v[18:19], v2 offset:8704
  ds_read_b64_tr_b16 v[20:21], v3 offset:8192
  ds_read_b64_tr_b16 v[22:23], v3 offset:8704
  v_mfma_f32_16x16x32_bf16 v[56:59], v[24:27], v[192:195], v[56:59]
  v_mfma_f32_16x16x32_bf16 v[60:63], v[28:31], v[192:195], v[60:63]
  v_mfma_f32_16x16x32_bf16 v[72:75], v[24:27], v[216:219], v[72:75]
  v_mfma_f32_16x16x32_bf16 v[76:79], v[28:31], v[216:219], v[76:79]
  s_add_u32 m0, s23, 6144
  s_waitcnt lgkmcnt(0)
  buffer_load_dwordx4 v246, s[4:7], s21 offen lds
  buffer_load_dwordx4 v247, s[8:11], s21 offen offset:1024 lds
  ds_read_b64_tr_b16 v[24:25], v4 offset:8192
  ds_read_b64_tr_b16 v[26:27], v4 offset:8704
  ds_read_b64_tr_b16 v[28:29], v5 offset:8192
  ds_read_b64_tr_b16 v[30:31], v5 offset:8704
  v_mfma_f32_16x16x32_bf16 v[48:51], v[16:19], v[196:199], v[48:51]
  v_mfma_f32_16x16x32_bf16 v[52:55], v[20:23], v[196:199], v[52:55]
  v_mfma_f32_16x16x32_bf16 v[64:67], v[16:19], v[220:223], v[64:67]
  v_mfma_f32_16x16x32_bf16 v[68:71], v[20:23], v[220:223], v[68:71]
  s_add_u32 m0, s23, 8192
  s_waitcnt lgkmcnt(0)
  v_mfma_f32_16x16x32_bf16 v[56:59], v[24:27], v[196:199], v[56:59]
  v_mfma_f32_16x16x32_bf16 v[60:63], v[28:31], v[196:199], v[60:63]
  v_mfma_f32_16x16x32_bf16 v[72:75], v[24:27], v[220:223], v[72:75]
  v_mfma_f32_16x16x32_bf16 v[76:79], v[28:31], v[220:223], v[76:79]
  s_waitcnt vmcnt(4) lgkmcnt(0)
  buffer_load_dwordx4 v224, s[4:7], s21 offen lds
  buffer_load_dwordx4 v225, s[8:11], s21 offen offset:1024 lds
  ds_read_b64_tr_b16 v[16:17], v2 offset:0
  ds_read_b64_tr_b16 v[18:19], v2 offset:512
  ds_read_b64_tr_b16 v[20:21], v3 offset:0
  ds_read_b64_tr_b16 v[22:23], v3 offset:512
  s_add_u32 m0, s23, 10240
  s_nop 0
  v_cvt_pk_bf16_f32 v32, v48, v49
  v_cvt_pk_bf16_f32 v33, v50, v51
  v_cvt_pk_bf16_f32 v34, v52, v53
  v_cvt_pk_bf16_f32 v35, v54, v55
  v_cvt_pk_bf16_f32 v36, v56, v57
  v_cvt_pk_bf16_f32 v37, v58, v59
  v_cvt_pk_bf16_f32 v38, v60, v61
  v_cvt_pk_bf16_f32 v39, v62, v63
  v_cvt_pk_bf16_f32 v40, v64, v65
  v_cvt_pk_bf16_f32 v41, v66, v67
  v_cvt_pk_bf16_f32 v42, v68, v69
  v_cvt_pk_bf16_f32 v43, v70, v71
  v_cvt_pk_bf16_f32 v44, v72, v73
  v_cvt_pk_bf16_f32 v45, v74, v75
  v_cvt_pk_bf16_f32 v46, v76, v77
  v_cvt_pk_bf16_f32 v47, v78, v79
  ds_write_b128 v6, v[32:35] offset:16
  ds_write_b128 v6, v[36:39] offset:3088
  s_mov_b64 exec, s[42:43]
  ds_write_b128 v6, v[40:43] offset:0
  ds_write_b128 v6, v[44:47] offset:3072
  s_mov_b64 exec, -1
  v_add_u32 v6, s77, v6
  s_waitcnt lgkmcnt(0)
  buffer_load_dwordx4 v226, s[4:7], s21 offen lds
  buffer_load_dwordx4 v227, s[8:11], s21 offen offset:1024 lds
  ds_read_b64_tr_b16 v[24:25], v4 offset:0
  ds_read_b64_tr_b16 v[26:27], v4 offset:512
  ds_read_b64_tr_b16 v[28:29], v5 offset:0
  ds_read_b64_tr_b16 v[30:31], v5 offset:512
  v_mfma_f32_16x16x32_bf16 v[48:51], v[16:19], v[176:179], 0
  v_mfma_f32_16x16x32_bf16 v[52:55], v[20:23], v[176:179], 0
  v_mfma_f32_16x16x32_bf16 v[64:67], v[16:19], v[200:203], 0
  v_mfma_f32_16x16x32_bf16 v[68:71], v[20:23], v[200:203], 0
  s_add_u32 m0, s23, 0
  s_waitcnt vmcnt(4) lgkmcnt(0)
  buffer_load_dwordx4 v228, s[4:7], s21 offen lds
  buffer_load_dwordx4 v229, s[8:11], s21 offen offset:1024 lds
  ds_read_b64_tr_b16 v[16:17], v2 offset:4096
  ds_read_b64_tr_b16 v[18:19], v2 offset:4608
  ds_read_b64_tr_b16 v[20:21], v3 offset:4096
  ds_read_b64_tr_b16 v[22:23], v3 offset:4608
  v_mfma_f32_16x16x32_bf16 v[56:59], v[24:27], v[176:179], 0
  v_mfma_f32_16x16x32_bf16 v[60:63], v[28:31], v[176:179], 0
  v_mfma_f32_16x16x32_bf16 v[72:75], v[24:27], v[200:203], 0
  v_mfma_f32_16x16x32_bf16 v[76:79], v[28:31], v[200:203], 0
  s_add_u32 m0, s23, 2048
  s_waitcnt lgkmcnt(0)
  s_barrier
  buffer_load_dwordx4 v230, s[4:7], s21 offen lds
  buffer_load_dwordx4 v231, s[8:11], s21 offen offset:1024 lds
  ds_read_b64_tr_b16 v[24:25], v4 offset:4096
  ds_read_b64_tr_b16 v[26:27], v4 offset:4608
  ds_read_b64_tr_b16 v[28:29], v5 offset:4096
  ds_read_b64_tr_b16 v[30:31], v5 offset:4608
  ds_read_b128 v[32:35], v8 offset:18464
  ds_read_b128 v[36:39], v8 offset:18720
  ds_read_b128 v[40:43], v8 offset:18976
  ds_read_b128 v[44:47], v8 offset:21536
  v_mfma_f32_16x16x32_bf16 v[48:51], v[16:19], v[180:183], v[48:51]
  v_mfma_f32_16x16x32_bf16 v[52:55], v[20:23], v[180:183], v[52:55]
  v_mfma_f32_16x16x32_bf16 v[64:67], v[16:19], v[204:207], v[64:67]
  v_mfma_f32_16x16x32_bf16 v[68:71], v[20:23], v[204:207], v[68:71]
  s_add_u32 m0, s23, 4096
  s_waitcnt vmcnt(4) lgkmcnt(0)
  buffer_load_dwordx4 v232, s[4:7], s21 offen lds
  buffer_load_dwordx4 v233, s[8:11], s21 offen offset:1024 lds
  ds_read_b64_tr_b16 v[16:17], v2 offset:8192
  ds_read_b64_tr_b16 v[18:19], v2 offset:8704
  ds_read_b64_tr_b16 v[20:21], v3 offset:8192
  ds_read_b64_tr_b16 v[22:23], v3 offset:8704
  v_mfma_f32_16x16x32_bf16 v[104:107], v[152:155], v[32:35], v[104:107]
  v_mfma_f32_16x16x32_bf16 v[108:111], v[152:155], v[36:39], v[108:111]
  v_mfma_f32_16x16x32_bf16 v[112:115], v[152:155], v[40:43], v[112:115]
  v_mfma_f32_16x16x32_bf16 v[104:107], v[156:159], v[44:47], v[104:107]
  ds_read_b128 v[32:35], v8 offset:21792
  ds_read_b128 v[36:39], v8 offset:22048
  ds_read_b128 v[40:43], v7 offset:0
  ds_read_b128 v[44:47], v7 offset:256
  v_mfma_f32_16x16x32_bf16 v[56:59], v[24:27], v[180:183], v[56:59]
  v_mfma_f32_16x16x32_bf16 v[60:63], v[28:31], v[180:183], v[60:63]
  v_mfma_f32_16x16x32_bf16 v[72:75], v[24:27], v[204:207], v[72:75]
  v_mfma_f32_16x16x32_bf16 v[76:79], v[28:31], v[204:207], v[76:79]
  s_add_u32 m0, s23, 6144
  s_waitcnt lgkmcnt(0)
  buffer_load_dwordx4 v234, s[4:7], s21 offen lds
  buffer_load_dwordx4 v235, s[8:11], s21 offen offset:1024 lds
  ds_read_b64_tr_b16 v[24:25], v4 offset:8192
  ds_read_b64_tr_b16 v[26:27], v4 offset:8704
  ds_read_b64_tr_b16 v[28:29], v5 offset:8192
  ds_read_b64_tr_b16 v[30:31], v5 offset:8704
  v_mfma_f32_16x16x32_bf16 v[108:111], v[156:159], v[32:35], v[108:111]
  v_mfma_f32_16x16x32_bf16 v[112:115], v[156:159], v[36:39], v[112:115]
  v_mfma_f32_16x16x32_bf16 v[92:95], v[160:163], v[40:43], v[92:95]
  v_mfma_f32_16x16x32_bf16 v[96:99], v[160:163], v[44:47], v[96:99]
  ds_read_b128 v[32:35], v7 offset:512
  ds_read_b128 v[36:39], v7 offset:3072
  ds_read_b128 v[40:43], v7 offset:3328
  ds_read_b128 v[44:47], v7 offset:3584
  v_mfma_f32_16x16x32_bf16 v[48:51], v[16:19], v[184:187], v[48:51]
  v_mfma_f32_16x16x32_bf16 v[52:55], v[20:23], v[184:187], v[52:55]
  v_mfma_f32_16x16x32_bf16 v[64:67], v[16:19], v[208:211], v[64:67]
  v_mfma_f32_16x16x32_bf16 v[68:71], v[20:23], v[208:211], v[68:71]
  s_add_u32 m0, s23, 8192
  s_waitcnt vmcnt(4) lgkmcnt(0)
  buffer_load_dwordx4 v236, s[4:7], s21 offen lds
  buffer_load_dwordx4 v237, s[8:11], s21 offen offset:1024 lds
  ds_read_b64_tr_b16 v[16:17], v2 offset:0
  ds_read_b64_tr_b16 v[18:19], v2 offset:512
  ds_read_b64_tr_b16 v[20:21], v3 offset:0
  ds_read_b64_tr_b16 v[22:23], v3 offset:512
  v_mfma_f32_16x16x32_bf16 v[100:103], v[160:163], v[32:35], v[100:103]
  v_mfma_f32_16x16x32_bf16 v[92:95], v[164:167], v[36:39], v[92:95]
  v_mfma_f32_16x16x32_bf16 v[96:99], v[164:167], v[40:43], v[96:99]
  v_mfma_f32_16x16x32_bf16 v[100:103], v[164:167], v[44:47], v[100:103]
  ds_read_b128 v[32:35], v7 offset:18464
  ds_read_b128 v[36:39], v7 offset:18720
  ds_read_b128 v[40:43], v7 offset:18976
  ds_read_b128 v[44:47], v7 offset:21536
  v_mfma_f32_16x16x32_bf16 v[56:59], v[24:27], v[184:187], v[56:59]
  v_mfma_f32_16x16x32_bf16 v[60:63], v[28:31], v[184:187], v[60:63]
  v_mfma_f32_16x16x32_bf16 v[72:75], v[24:27], v[208:211], v[72:75]
  v_mfma_f32_16x16x32_bf16 v[76:79], v[28:31], v[208:211], v[76:79]
  v_xor_b32 v152, 0x80008000, v152
  v_xor_b32 v153, 0x80008000, v153
  v_xor_b32 v154, 0x80008000, v154
  v_xor_b32 v155, 0x80008000, v155
  v_xor_b32 v156, 0x80008000, v156
  v_xor_b32 v157, 0x80008000, v157
  v_xor_b32 v158, 0x80008000, v158
  v_xor_b32 v159, 0x80008000, v159
  s_add_u32 m0, s23, 10240
  s_waitcnt lgkmcnt(0)
  buffer_load_dwordx4 v238, s[4:7], s21 offen lds
  buffer_load_dwordx4 v239, s[8:11], s21 offen offset:1024 lds
  ds_read_b64_tr_b16 v[24:25], v4 offset:0
  ds_read_b64_tr_b16 v[26:27], v4 offset:512
  ds_read_b64_tr_b16 v[28:29], v5 offset:0
  ds_read_b64_tr_b16 v[30:31], v5 offset:512
  v_mfma_f32_16x16x32_bf16 v[80:83], v[168:171], v[32:35], v[80:83]
  v_mfma_f32_16x16x32_bf16 v[84:87], v[168:171], v[36:39], v[84:87]
  v_mfma_f32_16x16x32_bf16 v[88:91], v[168:171], v[40:43], v[88:91]
  v_mfma_f32_16x16x32_bf16 v[80:83], v[172:175], v[44:47], v[80:83]
  ds_read_b128 v[32:35], v7 offset:21792
  ds_read_b128 v[36:39], v7 offset:22048
  ds_read_b128 v[40:43], v8 offset:0
  ds_read_b128 v[44:47], v8 offset:256
  v_mfma_f32_16x16x32_bf16 v[48:51], v[16:19], v[188:191], v[48:51]
  v_mfma_f32_16x16x32_bf16 v[52:55], v[20:23], v[188:191], v[52:55]
  v_mfma_f32_16x16x32_bf16 v[64:67], v[16:19], v[212:215], v[64:67]
  v_mfma_f32_16x16x32_bf16 v[68:71], v[20:23], v[212:215], v[68:71]
  s_add_u32 m0, s23, 0
  s_waitcnt vmcnt(4) lgkmcnt(0)
  s_mov_b32 s21, 512
  buffer_load_dwordx4 v240, s[4:7], s21 offen lds
  buffer_load_dwordx4 v241, s[8:11], s21 offen offset:1024 lds
  ds_read_b64_tr_b16 v[16:17], v2 offset:4096
  ds_read_b64_tr_b16 v[18:19], v2 offset:4608
  ds_read_b64_tr_b16 v[20:21], v3 offset:4096
  ds_read_b64_tr_b16 v[22:23], v3 offset:4608
  v_mfma_f32_16x16x32_bf16 v[84:87], v[172:175], v[32:35], v[84:87]
  v_mfma_f32_16x16x32_bf16 v[88:91], v[172:175], v[36:39], v[88:91]
  v_mfma_f32_16x16x32_bf16 v[116:119], v[152:155], v[40:43], v[116:119]
  v_mfma_f32_16x16x32_bf16 v[120:123], v[152:155], v[44:47], v[120:123]
  ds_read_b128 v[32:35], v8 offset:512
  ds_read_b128 v[36:39], v8 offset:3072
  ds_read_b128 v[40:43], v8 offset:3328
  ds_read_b128 v[44:47], v8 offset:3584
  v_mfma_f32_16x16x32_bf16 v[56:59], v[24:27], v[188:191], v[56:59]
  v_mfma_f32_16x16x32_bf16 v[60:63], v[28:31], v[188:191], v[60:63]
  v_mfma_f32_16x16x32_bf16 v[72:75], v[24:27], v[212:215], v[72:75]
  v_mfma_f32_16x16x32_bf16 v[76:79], v[28:31], v[212:215], v[76:79]
  s_add_u32 m0, s23, 2048
  s_waitcnt lgkmcnt(0)
  buffer_load_dwordx4 v242, s[4:7], s21 offen lds
  buffer_load_dwordx4 v243, s[8:11], s21 offen offset:1024 lds
  ds_read_b64_tr_b16 v[24:25], v4 offset:4096
  ds_read_b64_tr_b16 v[26:27], v4 offset:4608
  ds_read_b64_tr_b16 v[28:29], v5 offset:4096
  ds_read_b64_tr_b16 v[30:31], v5 offset:4608
  v_mfma_f32_16x16x32_bf16 v[124:127], v[152:155], v[32:35], v[124:127]
  v_mfma_f32_16x16x32_bf16 v[116:119], v[156:159], v[36:39], v[116:119]
  v_mfma_f32_16x16x32_bf16 v[120:123], v[156:159], v[40:43], v[120:123]
  v_mfma_f32_16x16x32_bf16 v[124:127], v[156:159], v[44:47], v[124:127]
  v_mfma_f32_16x16x32_bf16 v[48:51], v[16:19], v[192:195], v[48:51]
  v_mfma_f32_16x16x32_bf16 v[52:55], v[20:23], v[192:195], v[52:55]
  v_mfma_f32_16x16x32_bf16 v[64:67], v[16:19], v[216:219], v[64:67]
  v_mfma_f32_16x16x32_bf16 v[68:71], v[20:23], v[216:219], v[68:71]
  s_add_u32 m0, s23, 4096
  s_waitcnt vmcnt(4) lgkmcnt(0)
  buffer_load_dwordx4 v244, s[4:7], s21 offen lds
  buffer_load_dwordx4 v245, s[8:11], s21 offen offset:1024 lds
  ds_read_b64_tr_b16 v[16:17], v2 offset:8192
  ds_read_b64_tr_b16 v[18:19], v2 offset:8704
  ds_read_b64_tr_b16 v[20:21], v3 offset:8192
  ds_read_b64_tr_b16 v[22:23], v3 offset:8704
  v_mfma_f32_16x16x32_bf16 v[56:59], v[24:27], v[192:195], v[56:59]
  v_mfma_f32_16x16x32_bf16 v[60:63], v[28:31], v[192:195], v[60:63]
  v_mfma_f32_16x16x32_bf16 v[72:75], v[24:27], v[216:219], v[72:75]
  v_mfma_f32_16x16x32_bf16 v[76:79], v[28:31], v[216:219], v[76:79]
  s_add_u32 m0, s23, 6144
  s_waitcnt lgkmcnt(0)
  buffer_load_dwordx4 v246, s[4:7], s21 offen lds
  buffer_load_dwordx4 v247, s[8:11], s21 offen offset:1024 lds
  ds_read_b64_tr_b16 v[24:25], v4 offset:8192
  ds_read_b64_tr_b16 v[26:27], v4 offset:8704
  ds_read_b64_tr_b16 v[28:29], v5 offset:8192
  ds_read_b64_tr_b16 v[30:31], v5 offset:8704
  v_mfma_f32_16x16x32_bf16 v[48:51], v[16:19], v[196:199], v[48:51]
  v_mfma_f32_16x16x32_bf16 v[52:55], v[20:23], v[196:199], v[52:55]
  v_mfma_f32_16x16x32_bf16 v[64:67], v[16:19], v[220:223], v[64:67]
  v_mfma_f32_16x16x32_bf16 v[68:71], v[20:23], v[220:223], v[68:71]
  s_add_u32 m0, s23, 8192
  s_waitcnt lgkmcnt(0)
  v_mfma_f32_16x16x32_bf16 v[56:59], v[24:27], v[196:199], v[56:59]
  v_mfma_f32_16x16x32_bf16 v[60:63], v[28:31], v[196:199], v[60:63]
  v_mfma_f32_16x16x32_bf16 v[72:75], v[24:27], v[220:223], v[72:75]
  v_mfma_f32_16x16x32_bf16 v[76:79], v[28:31], v[220:223], v[76:79]
  s_waitcnt vmcnt(4) lgkmcnt(0)
  buffer_load_dwordx4 v224, s[4:7], s21 offen lds
  buffer_load_dwordx4 v225, s[8:11], s21 offen offset:1024 lds
  ds_read_b64_tr_b16 v[16:17], v2 offset:0
  ds_read_b64_tr_b16 v[18:19], v2 offset:512
  ds_read_b64_tr_b16 v[20:21], v3 offset:0
  ds_read_b64_tr_b16 v[22:23], v3 offset:512
  s_add_u32 m0, s23, 10240
  s_nop 0
  v_cvt_pk_bf16_f32 v32, v48, v49
  v_cvt_pk_bf16_f32 v33, v50, v51
  v_cvt_pk_bf16_f32 v34, v52, v53
  v_cvt_pk_bf16_f32 v35, v54, v55
  v_cvt_pk_bf16_f32 v36, v56, v57
  v_cvt_pk_bf16_f32 v37, v58, v59
  v_cvt_pk_bf16_f32 v38, v60, v61
  v_cvt_pk_bf16_f32 v39, v62, v63
  v_cvt_pk_bf16_f32 v40, v64, v65
  v_cvt_pk_bf16_f32 v41, v66, v67
  v_cvt_pk_bf16_f32 v42, v68, v69
  v_cvt_pk_bf16_f32 v43, v70, v71
  v_cvt_pk_bf16_f32 v44, v72, v73
  v_cvt_pk_bf16_f32 v45, v74, v75
  v_cvt_pk_bf16_f32 v46, v76, v77
  v_cvt_pk_bf16_f32 v47, v78, v79
  ds_write_b128 v6, v[32:35] offset:16
  ds_write_b128 v6, v[36:39] offset:3088
  s_mov_b64 exec, s[42:43]
  ds_write_b128 v6, v[40:43] offset:0
  ds_write_b128 v6, v[44:47] offset:3072
  s_mov_b64 exec, -1
  v_subrev_u32 v6, s77, v6
  s_waitcnt lgkmcnt(0)
  buffer_load_dwordx4 v226, s[4:7], s21 offen lds
  buffer_load_dwordx4 v227, s[8:11], s21 offen offset:1024 lds
  ds_read_b64_tr_b16 v[24:25], v4 offset:0
  ds_read_b64_tr_b16 v[26:27], v4 offset:512
  ds_read_b64_tr_b16 v[28:29], v5 offset:0
  ds_read_b64_tr_b16 v[30:31], v5 offset:512
  v_add_u32 v7, s77, v7
  v_add_u32 v8, s77, v8
  v_mfma_f32_16x16x32_bf16 v[48:51], v[16:19], v[176:179], 0
  v_mfma_f32_16x16x32_bf16 v[52:55], v[20:23], v[176:179], 0
  v_mfma_f32_16x16x32_bf16 v[64:67], v[16:19], v[200:203], 0
  v_mfma_f32_16x16x32_bf16 v[68:71], v[20:23], v[200:203], 0
  s_add_u32 m0, s23, 0
  s_waitcnt vmcnt(4) lgkmcnt(0)
  buffer_load_dwordx4 v228, s[4:7], s21 offen lds
  buffer_load_dwordx4 v229, s[8:11], s21 offen offset:1024 lds
  ds_read_b64_tr_b16 v[16:17], v2 offset:4096
  ds_read_b64_tr_b16 v[18:19], v2 offset:4608
  ds_read_b64_tr_b16 v[20:21], v3 offset:4096
  ds_read_b64_tr_b16 v[22:23], v3 offset:4608
  v_mfma_f32_16x16x32_bf16 v[56:59], v[24:27], v[176:179], 0
  v_mfma_f32_16x16x32_bf16 v[60:63], v[28:31], v[176:179], 0
  v_mfma_f32_16x16x32_bf16 v[72:75], v[24:27], v[200:203], 0
  v_mfma_f32_16x16x32_bf16 v[76:79], v[28:31], v[200:203], 0
  s_add_u32 m0, s23, 2048
  s_waitcnt lgkmcnt(0)
  s_barrier
  buffer_load_dwordx4 v230, s[4:7], s21 offen lds
  buffer_load_dwordx4 v231, s[8:11], s21 offen offset:1024 lds
  ds_read_b64_tr_b16 v[24:25], v4 offset:4096
  ds_read_b64_tr_b16 v[26:27], v4 offset:4608
  ds_read_b64_tr_b16 v[28:29], v5 offset:4096
  ds_read_b64_tr_b16 v[30:31], v5 offset:4608
  ds_read_b128 v[32:35], v8 offset:18464
  ds_read_b128 v[36:39], v8 offset:18720
  ds_read_b128 v[40:43], v8 offset:18976
  ds_read_b128 v[44:47], v8 offset:21536
  v_mfma_f32_16x16x32_bf16 v[48:51], v[16:19], v[180:183], v[48:51]
  v_mfma_f32_16x16x32_bf16 v[52:55], v[20:23], v[180:183], v[52:55]
  v_mfma_f32_16x16x32_bf16 v[64:67], v[16:19], v[204:207], v[64:67]
  v_mfma_f32_16x16x32_bf16 v[68:71], v[20:23], v[204:207], v[68:71]
  s_add_u32 m0, s23, 4096
  s_waitcnt vmcnt(4) lgkmcnt(0)
  buffer_load_dwordx4 v232, s[4:7], s21 offen lds
  buffer_load_dwordx4 v233, s[8:11], s21 offen offset:1024 lds
  ds_read_b64_tr_b16 v[16:17], v2 offset:8192
  ds_read_b64_tr_b16 v[18:19], v2 offset:8704
  ds_read_b64_tr_b16 v[20:21], v3 offset:8192
  ds_read_b64_tr_b16 v[22:23], v3 offset:8704
  v_mfma_f32_16x16x32_bf16 v[104:107], v[128:131], v[32:35], v[104:107]
  v_mfma_f32_16x16x32_bf16 v[108:111], v[128:131], v[36:39], v[108:111]
  v_mfma_f32_16x16x32_bf16 v[112:115], v[128:131], v[40:43], v[112:115]
  v_mfma_f32_16x16x32_bf16 v[104:107], v[132:135], v[44:47], v[104:107]
  ds_read_b128 v[32:35], v8 offset:21792
  ds_read_b128 v[36:39], v8 offset:22048
  ds_read_b128 v[40:43], v7 offset:0
  ds_read_b128 v[44:47], v7 offset:256
  v_mfma_f32_16x16x32_bf16 v[56:59], v[24:27], v[180:183], v[56:59]
  v_mfma_f32_16x16x32_bf16 v[60:63], v[28:31], v[180:183], v[60:63]
  v_mfma_f32_16x16x32_bf16 v[72:75], v[24:27], v[204:207], v[72:75]
  v_mfma_f32_16x16x32_bf16 v[76:79], v[28:31], v[204:207], v[76:79]
  s_add_u32 m0, s23, 6144
  s_waitcnt lgkmcnt(0)
  buffer_load_dwordx4 v234, s[4:7], s21 offen lds
  buffer_load_dwordx4 v235, s[8:11], s21 offen offset:1024 lds
  ds_read_b64_tr_b16 v[24:25], v4 offset:8192
  ds_read_b64_tr_b16 v[26:27], v4 offset:8704
  ds_read_b64_tr_b16 v[28:29], v5 offset:8192
  ds_read_b64_tr_b16 v[30:31], v5 offset:8704
  v_mfma_f32_16x16x32_bf16 v[108:111], v[132:135], v[32:35], v[108:111]
  v_mfma_f32_16x16x32_bf16 v[112:115], v[132:135], v[36:39], v[112:115]
  v_mfma_f32_16x16x32_bf16 v[92:95], v[136:139], v[40:43], v[92:95]
  v_mfma_f32_16x16x32_bf16 v[96:99], v[136:139], v[44:47], v[96:99]
  ds_read_b128 v[32:35], v7 offset:512
  ds_read_b128 v[36:39], v7 offset:3072
  ds_read_b128 v[40:43], v7 offset:3328
  ds_read_b128 v[44:47], v7 offset:3584
  v_mfma_f32_16x16x32_bf16 v[48:51], v[16:19], v[184:187], v[48:51]
  v_mfma_f32_16x16x32_bf16 v[52:55], v[20:23], v[184:187], v[52:55]
  v_mfma_f32_16x16x32_bf16 v[64:67], v[16:19], v[208:211], v[64:67]
  v_mfma_f32_16x16x32_bf16 v[68:71], v[20:23], v[208:211], v[68:71]
  s_add_u32 m0, s23, 8192
  s_waitcnt vmcnt(4) lgkmcnt(0)
  buffer_load_dwordx4 v236, s[4:7], s21 offen lds
  buffer_load_dwordx4 v237, s[8:11], s21 offen offset:1024 lds
  ds_read_b64_tr_b16 v[16:17], v2 offset:0
  ds_read_b64_tr_b16 v[18:19], v2 offset:512
  ds_read_b64_tr_b16 v[20:21], v3 offset:0
  ds_read_b64_tr_b16 v[22:23], v3 offset:512
  v_mfma_f32_16x16x32_bf16 v[100:103], v[136:139], v[32:35], v[100:103]
  v_mfma_f32_16x16x32_bf16 v[92:95], v[140:143], v[36:39], v[92:95]
  v_mfma_f32_16x16x32_bf16 v[96:99], v[140:143], v[40:43], v[96:99]
  v_mfma_f32_16x16x32_bf16 v[100:103], v[140:143], v[44:47], v[100:103]
  ds_read_b128 v[32:35], v7 offset:18464
  ds_read_b128 v[36:39], v7 offset:18720
  ds_read_b128 v[40:43], v7 offset:18976
  ds_read_b128 v[44:47], v7 offset:21536
  v_mfma_f32_16x16x32_bf16 v[56:59], v[24:27], v[184:187], v[56:59]
  v_mfma_f32_16x16x32_bf16 v[60:63], v[28:31], v[184:187], v[60:63]
  v_mfma_f32_16x16x32_bf16 v[72:75], v[24:27], v[208:211], v[72:75]
  v_mfma_f32_16x16x32_bf16 v[76:79], v[28:31], v[208:211], v[76:79]
  v_xor_b32 v128, 0x80008000, v128
  v_xor_b32 v129, 0x80008000, v129
  v_xor_b32 v130, 0x80008000, v130
  v_xor_b32 v131, 0x80008000, v131
  v_xor_b32 v132, 0x80008000, v132
  v_xor_b32 v133, 0x80008000, v133
  v_xor_b32 v134, 0x80008000, v134
  v_xor_b32 v135, 0x80008000, v135
  s_add_u32 m0, s23, 10240
  s_waitcnt lgkmcnt(0)
  buffer_load_dwordx4 v238, s[4:7], s21 offen lds
  buffer_load_dwordx4 v239, s[8:11], s21 offen offset:1024 lds
  ds_read_b64_tr_b16 v[24:25], v4 offset:0
  ds_read_b64_tr_b16 v[26:27], v4 offset:512
  ds_read_b64_tr_b16 v[28:29], v5 offset:0
  ds_read_b64_tr_b16 v[30:31], v5 offset:512
  v_mfma_f32_16x16x32_bf16 v[80:83], v[144:147], v[32:35], v[80:83]
  v_mfma_f32_16x16x32_bf16 v[84:87], v[144:147], v[36:39], v[84:87]
  v_mfma_f32_16x16x32_bf16 v[88:91], v[144:147], v[40:43], v[88:91]
  v_mfma_f32_16x16x32_bf16 v[80:83], v[148:151], v[44:47], v[80:83]
  ds_read_b128 v[32:35], v7 offset:21792
  ds_read_b128 v[36:39], v7 offset:22048
  ds_read_b128 v[40:43], v8 offset:0
  ds_read_b128 v[44:47], v8 offset:256
  v_mfma_f32_16x16x32_bf16 v[48:51], v[16:19], v[188:191], v[48:51]
  v_mfma_f32_16x16x32_bf16 v[52:55], v[20:23], v[188:191], v[52:55]
  v_mfma_f32_16x16x32_bf16 v[64:67], v[16:19], v[212:215], v[64:67]
  v_mfma_f32_16x16x32_bf16 v[68:71], v[20:23], v[212:215], v[68:71]
  s_add_u32 m0, s23, 0
  s_waitcnt vmcnt(4) lgkmcnt(0)
  s_mov_b32 s21, 640
  buffer_load_dwordx4 v240, s[4:7], s21 offen lds
  buffer_load_dwordx4 v241, s[8:11], s21 offen offset:1024 lds
  ds_read_b64_tr_b16 v[16:17], v2 offset:4096
  ds_read_b64_tr_b16 v[18:19], v2 offset:4608
  ds_read_b64_tr_b16 v[20:21], v3 offset:4096
  ds_read_b64_tr_b16 v[22:23], v3 offset:4608
  v_mfma_f32_16x16x32_bf16 v[84:87], v[148:151], v[32:35], v[84:87]
  v_mfma_f32_16x16x32_bf16 v[88:91], v[148:151], v[36:39], v[88:91]
  v_mfma_f32_16x16x32_bf16 v[116:119], v[128:131], v[40:43], v[116:119]
  v_mfma_f32_16x16x32_bf16 v[120:123], v[128:131], v[44:47], v[120:123]
  ds_read_b128 v[32:35], v8 offset:512
  ds_read_b128 v[36:39], v8 offset:3072
  ds_read_b128 v[40:43], v8 offset:3328
  ds_read_b128 v[44:47], v8 offset:3584
  v_mfma_f32_16x16x32_bf16 v[56:59], v[24:27], v[188:191], v[56:59]
  v_mfma_f32_16x16x32_bf16 v[60:63], v[28:31], v[188:191], v[60:63]
  v_mfma_f32_16x16x32_bf16 v[72:75], v[24:27], v[212:215], v[72:75]
  v_mfma_f32_16x16x32_bf16 v[76:79], v[28:31], v[212:215], v[76:79]
  s_add_u32 m0, s23, 2048
  s_waitcnt lgkmcnt(0)
  buffer_load_dwordx4 v242, s[4:7], s21 offen lds
  buffer_load_dwordx4 v243, s[8:11], s21 offen offset:1024 lds
  ds_read_b64_tr_b16 v[24:25], v4 offset:4096
  ds_read_b64_tr_b16 v[26:27], v4 offset:4608
  ds_read_b64_tr_b16 v[28:29], v5 offset:4096
  ds_read_b64_tr_b16 v[30:31], v5 offset:4608
  v_mfma_f32_16x16x32_bf16 v[124:127], v[128:131], v[32:35], v[124:127]
  v_mfma_f32_16x16x32_bf16 v[116:119], v[132:135], v[36:39], v[116:119]
  v_mfma_f32_16x16x32_bf16 v[120:123], v[132:135], v[40:43], v[120:123]
  v_mfma_f32_16x16x32_bf16 v[124:127], v[132:135], v[44:47], v[124:127]
  v_mfma_f32_16x16x32_bf16 v[48:51], v[16:19], v[192:195], v[48:51]
  v_mfma_f32_16x16x32_bf16 v[52:55], v[20:23], v[192:195], v[52:55]
  v_mfma_f32_16x16x32_bf16 v[64:67], v[16:19], v[216:219], v[64:67]
  v_mfma_f32_16x16x32_bf16 v[68:71], v[20:23], v[216:219], v[68:71]
  s_add_u32 m0, s23, 4096
  s_waitcnt vmcnt(4) lgkmcnt(0)
  buffer_load_dwordx4 v244, s[4:7], s21 offen lds
  buffer_load_dwordx4 v245, s[8:11], s21 offen offset:1024 lds
  ds_read_b64_tr_b16 v[16:17], v2 offset:8192
  ds_read_b64_tr_b16 v[18:19], v2 offset:8704
  ds_read_b64_tr_b16 v[20:21], v3 offset:8192
  ds_read_b64_tr_b16 v[22:23], v3 offset:8704
  v_mfma_f32_16x16x32_bf16 v[56:59], v[24:27], v[192:195], v[56:59]
  v_mfma_f32_16x16x32_bf16 v[60:63], v[28:31], v[192:195], v[60:63]
  v_mfma_f32_16x16x32_bf16 v[72:75], v[24:27], v[216:219], v[72:75]
  v_mfma_f32_16x16x32_bf16 v[76:79], v[28:31], v[216:219], v[76:79]
  s_add_u32 m0, s23, 6144
  s_waitcnt lgkmcnt(0)
  buffer_load_dwordx4 v246, s[4:7], s21 offen lds
  buffer_load_dwordx4 v247, s[8:11], s21 offen offset:1024 lds
  ds_read_b64_tr_b16 v[24:25], v4 offset:8192
  ds_read_b64_tr_b16 v[26:27], v4 offset:8704
  ds_read_b64_tr_b16 v[28:29], v5 offset:8192
  ds_read_b64_tr_b16 v[30:31], v5 offset:8704
  v_mfma_f32_16x16x32_bf16 v[48:51], v[16:19], v[196:199], v[48:51]
  v_mfma_f32_16x16x32_bf16 v[52:55], v[20:23], v[196:199], v[52:55]
  v_mfma_f32_16x16x32_bf16 v[64:67], v[16:19], v[220:223], v[64:67]
  v_mfma_f32_16x16x32_bf16 v[68:71], v[20:23], v[220:223], v[68:71]
  s_add_u32 m0, s23, 8192
  s_waitcnt lgkmcnt(0)
  v_mfma_f32_16x16x32_bf16 v[56:59], v[24:27], v[196:199], v[56:59]
  v_mfma_f32_16x16x32_bf16 v[60:63], v[28:31], v[196:199], v[60:63]
  v_mfma_f32_16x16x32_bf16 v[72:75], v[24:27], v[220:223], v[72:75]
  v_mfma_f32_16x16x32_bf16 v[76:79], v[28:31], v[220:223], v[76:79]
  s_waitcnt vmcnt(4) lgkmcnt(0)
  buffer_load_dwordx4 v224, s[4:7], s21 offen lds
  buffer_load_dwordx4 v225, s[8:11], s21 offen offset:1024 lds
  ds_read_b64_tr_b16 v[16:17], v2 offset:0
  ds_read_b64_tr_b16 v[18:19], v2 offset:512
  ds_read_b64_tr_b16 v[20:21], v3 offset:0
  ds_read_b64_tr_b16 v[22:23], v3 offset:512
  s_add_u32 m0, s23, 10240
  s_nop 0
  v_cvt_pk_bf16_f32 v32, v48, v49
  v_cvt_pk_bf16_f32 v33, v50, v51
  v_cvt_pk_bf16_f32 v34, v52, v53
  v_cvt_pk_bf16_f32 v35, v54, v55
  v_cvt_pk_bf16_f32 v36, v56, v57
  v_cvt_pk_bf16_f32 v37, v58, v59
  v_cvt_pk_bf16_f32 v38, v60, v61
  v_cvt_pk_bf16_f32 v39, v62, v63
  v_cvt_pk_bf16_f32 v40, v64, v65
  v_cvt_pk_bf16_f32 v41, v66, v67
  v_cvt_pk_bf16_f32 v42, v68, v69
  v_cvt_pk_bf16_f32 v43, v70, v71
  v_cvt_pk_bf16_f32 v44, v72, v73
  v_cvt_pk_bf16_f32 v45, v74, v75
  v_cvt_pk_bf16_f32 v46, v76, v77
  v_cvt_pk_bf16_f32 v47, v78, v79
  ds_write_b128 v6, v[32:35] offset:16
  ds_write_b128 v6, v[36:39] offset:3088
  s_mov_b64 exec, s[42:43]
  ds_write_b128 v6, v[40:43] offset:0
  ds_write_b128 v6, v[44:47] offset:3072
  s_mov_b64 exec, -1
  v_add_u32 v6, s77, v6
  s_waitcnt lgkmcnt(0)
  buffer_load_dwordx4 v226, s[4:7], s21 offen lds
  buffer_load_dwordx4 v227, s[8:11], s21 offen offset:1024 lds
  ds_read_b64_tr_b16 v[24:25], v4 offset:0
  ds_read_b64_tr_b16 v[26:27], v4 offset:512
  ds_read_b64_tr_b16 v[28:29], v5 offset:0
  ds_read_b64_tr_b16 v[30:31], v5 offset:512
  v_subrev_u32 v7, s77, v7
  v_subrev_u32 v8, s77, v8
  v_mfma_f32_16x16x32_bf16 v[48:51], v[16:19], v[176:179], 0
  v_mfma_f32_16x16x32_bf16 v[52:55], v[20:23], v[176:179], 0
  v_mfma_f32_16x16x32_bf16 v[64:67], v[16:19], v[200:203], 0
  v_mfma_f32_16x16x32_bf16 v[68:71], v[20:23], v[200:203], 0
  s_add_u32 m0, s23, 0
  s_waitcnt vmcnt(4) lgkmcnt(0)
  buffer_load_dwordx4 v228, s[4:7], s21 offen lds
  buffer_load_dwordx4 v229, s[8:11], s21 offen offset:1024 lds
  ds_read_b64_tr_b16 v[16:17], v2 offset:4096
  ds_read_b64_tr_b16 v[18:19], v2 offset:4608
  ds_read_b64_tr_b16 v[20:21], v3 offset:4096
  ds_read_b64_tr_b16 v[22:23], v3 offset:4608
  v_mfma_f32_16x16x32_bf16 v[56:59], v[24:27], v[176:179], 0
  v_mfma_f32_16x16x32_bf16 v[60:63], v[28:31], v[176:179], 0
  v_mfma_f32_16x16x32_bf16 v[72:75], v[24:27], v[200:203], 0
  v_mfma_f32_16x16x32_bf16 v[76:79], v[28:31], v[200:203], 0
  s_add_u32 m0, s23, 2048
  s_waitcnt lgkmcnt(0)
  s_barrier
  buffer_load_dwordx4 v230, s[4:7], s21 offen lds
  buffer_load_dwordx4 v231, s[8:11], s21 offen offset:1024 lds
  ds_read_b64_tr_b16 v[24:25], v4 offset:4096
  ds_read_b64_tr_b16 v[26:27], v4 offset:4608
  ds_read_b64_tr_b16 v[28:29], v5 offset:4096
  ds_read_b64_tr_b16 v[30:31], v5 offset:4608
  ds_read_b128 v[32:35], v8 offset:18464
  ds_read_b128 v[36:39], v8 offset:18720
  ds_read_b128 v[40:43], v8 offset:18976
  ds_read_b128 v[44:47], v8 offset:21536
  v_mfma_f32_16x16x32_bf16 v[48:51], v[16:19], v[180:183], v[48:51]
  v_mfma_f32_16x16x32_bf16 v[52:55], v[20:23], v[180:183], v[52:55]
  v_mfma_f32_16x16x32_bf16 v[64:67], v[16:19], v[204:207], v[64:67]
  v_mfma_f32_16x16x32_bf16 v[68:71], v[20:23], v[204:207], v[68:71]
  s_add_u32 m0, s23, 4096
  s_waitcnt vmcnt(4) lgkmcnt(0)
  buffer_load_dwordx4 v232, s[4:7], s21 offen lds
  buffer_load_dwordx4 v233, s[8:11], s21 offen offset:1024 lds
  ds_read_b64_tr_b16 v[16:17], v2 offset:8192
  ds_read_b64_tr_b16 v[18:19], v2 offset:8704
  ds_read_b64_tr_b16 v[20:21], v3 offset:8192
  ds_read_b64_tr_b16 v[22:23], v3 offset:8704
  v_mfma_f32_16x16x32_bf16 v[92:95], v[128:131], v[32:35], v[92:95]
  v_mfma_f32_16x16x32_bf16 v[96:99], v[128:131], v[36:39], v[96:99]
  v_mfma_f32_16x16x32_bf16 v[100:103], v[128:131], v[40:43], v[100:103]
  v_mfma_f32_16x16x32_bf16 v[92:95], v[132:135], v[44:47], v[92:95]
  ds_read_b128 v[32:35], v8 offset:21792
  ds_read_b128 v[36:39], v8 offset:22048
  ds_read_b128 v[40:43], v7 offset:0
  ds_read_b128 v[44:47], v7 offset:256
  v_mfma_f32_16x16x32_bf16 v[56:59], v[24:27], v[180:183], v[56:59]
  v_mfma_f32_16x16x32_bf16 v[60:63], v[28:31], v[180:183], v[60:63]
  v_mfma_f32_16x16x32_bf16 v[72:75], v[24:27], v[204:207], v[72:75]
  v_mfma_f32_16x16x32_bf16 v[76:79], v[28:31], v[204:207], v[76:79]
  s_add_u32 m0, s23, 6144
  s_waitcnt lgkmcnt(0)
  buffer_load_dwordx4 v234, s[4:7], s21 offen lds
  buffer_load_dwordx4 v235, s[8:11], s21 offen offset:1024 lds
  ds_read_b64_tr_b16 v[24:25], v4 offset:8192
  ds_read_b64_tr_b16 v[26:27], v4 offset:8704
  ds_read_b64_tr_b16 v[28:29], v5 offset:8192
  ds_read_b64_tr_b16 v[30:31], v5 offset:8704
  v_mfma_f32_16x16x32_bf16 v[96:99], v[132:135], v[32:35], v[96:99]
  v_mfma_f32_16x16x32_bf16 v[100:103], v[132:135], v[36:39], v[100:103]
  v_mfma_f32_16x16x32_bf16 v[104:107], v[136:139], v[40:43], v[104:107]
  v_mfma_f32_16x16x32_bf16 v[108:111], v[136:139], v[44:47], v[108:111]
  ds_read_b128 v[32:35], v7 offset:512
  ds_read_b128 v[36:39], v7 offset:3072
  ds_read_b128 v[40:43], v7 offset:3328
  ds_read_b128 v[44:47], v7 offset:3584
  v_mfma_f32_16x16x32_bf16 v[48:51], v[16:19], v[184:187], v[48:51]
  v_mfma_f32_16x16x32_bf16 v[52:55], v[20:23], v[184:187], v[52:55]
  v_mfma_f32_16x16x32_bf16 v[64:67], v[16:19], v[208:211], v[64:67]
  v_mfma_f32_16x16x32_bf16 v[68:71], v[20:23], v[208:211], v[68:71]
  s_add_u32 m0, s23, 8192
  s_waitcnt vmcnt(4) lgkmcnt(0)
  buffer_load_dwordx4 v236, s[4:7], s21 offen lds
  buffer_load_dwordx4 v237, s[8:11], s21 offen offset:1024 lds
  ds_read_b64_tr_b16 v[16:17], v2 offset:0
  ds_read_b64_tr_b16 v[18:19], v2 offset:512
  ds_read_b64_tr_b16 v[20:21], v3 offset:0
  ds_read_b64_tr_b16 v[22:23], v3 offset:512
  v_mfma_f32_16x16x32_bf16 v[112:115], v[136:139], v[32:35], v[112:115]
  v_mfma_f32_16x16x32_bf16 v[104:107], v[140:143], v[36:39], v[104:107]
  v_mfma_f32_16x16x32_bf16 v[108:111], v[140:143], v[40:43], v[108:111]
  v_mfma_f32_16x16x32_bf16 v[112:115], v[140:143], v[44:47], v[112:115]
  ds_read_b128 v[32:35], v8 offset:0
  ds_read_b128 v[36:39], v8 offset:256
  ds_read_b128 v[40:43], v8 offset:512
  ds_read_b128 v[44:47], v8 offset:3072
  v_mfma_f32_16x16x32_bf16 v[56:59], v[24:27], v[184:187], v[56:59]
  v_mfma_f32_16x16x32_bf16 v[60:63], v[28:31], v[184:187], v[60:63]
  v_mfma_f32_16x16x32_bf16 v[72:75], v[24:27], v[208:211], v[72:75]
  v_mfma_f32_16x16x32_bf16 v[76:79], v[28:31], v[208:211], v[76:79]
  v_xor_b32 v128, 0x80008000, v128
  v_xor_b32 v129, 0x80008000, v129
  v_xor_b32 v130, 0x80008000, v130
  v_xor_b32 v131, 0x80008000, v131
  v_xor_b32 v132, 0x80008000, v132
  v_xor_b32 v133, 0x80008000, v133
  v_xor_b32 v134, 0x80008000, v134
  v_xor_b32 v135, 0x80008000, v135
  s_add_u32 m0, s23, 10240
  s_waitcnt lgkmcnt(0)
  buffer_load_dwordx4 v238, s[4:7], s21 offen lds
  buffer_load_dwordx4 v239, s[8:11], s21 offen offset:1024 lds
  ds_read_b64_tr_b16 v[24:25], v4 offset:0
  ds_read_b64_tr_b16 v[26:27], v4 offset:512
  ds_read_b64_tr_b16 v[28:29], v5 offset:0
  ds_read_b64_tr_b16 v[30:31], v5 offset:512
  v_mfma_f32_16x16x32_bf16 v[80:83], v[144:147], v[32:35], v[80:83]
  v_mfma_f32_16x16x32_bf16 v[84:87], v[144:147], v[36:39], v[84:87]
  v_mfma_f32_16x16x32_bf16 v[88:91], v[144:147], v[40:43], v[88:91]
  v_mfma_f32_16x16x32_bf16 v[80:83], v[148:151], v[44:47], v[80:83]
  ds_read_b128 v[32:35], v8 offset:3328
  ds_read_b128 v[36:39], v8 offset:3584
  ds_read_b128 v[40:43], v7 offset:18464
  ds_read_b128 v[44:47], v7 offset:18720
  v_mfma_f32_16x16x32_bf16 v[48:51], v[16:19], v[188:191], v[48:51]
  v_mfma_f32_16x16x32_bf16 v[52:55], v[20:23], v[188:191], v[52:55]
  v_mfma_f32_16x16x32_bf16 v[64:67], v[16:19], v[212:215], v[64:67]
  v_mfma_f32_16x16x32_bf16 v[68:71], v[20:23], v[212:215], v[68:71]
  s_add_u32 m0, s23, 0
  s_waitcnt vmcnt(4) lgkmcnt(0)
  s_mov_b32 s21, 768
  buffer_load_dwordx4 v240, s[4:7], s21 offen lds
  buffer_load_dwordx4 v241, s[8:11], s21 offen offset:1024 lds
  ds_read_b64_tr_b16 v[16:17], v2 offset:4096
  ds_read_b64_tr_b16 v[18:19], v2 offset:4608
  ds_read_b64_tr_b16 v[20:21], v3 offset:4096
  ds_read_b64_tr_b16 v[22:23], v3 offset:4608
  v_mfma_f32_16x16x32_bf16 v[84:87], v[148:151], v[32:35], v[84:87]
  v_mfma_f32_16x16x32_bf16 v[88:91], v[148:151], v[36:39], v[88:91]
  v_mfma_f32_16x16x32_bf16 v[116:119], v[128:131], v[40:43], v[116:119]
  v_mfma_f32_16x16x32_bf16 v[120:123], v[128:131], v[44:47], v[120:123]
  ds_read_b128 v[32:35], v7 offset:18976
  ds_read_b128 v[36:39], v7 offset:21536
  ds_read_b128 v[40:43], v7 offset:21792
  ds_read_b128 v[44:47], v7 offset:22048
  v_mfma_f32_16x16x32_bf16 v[56:59], v[24:27], v[188:191], v[56:59]
  v_mfma_f32_16x16x32_bf16 v[60:63], v[28:31], v[188:191], v[60:63]
  v_mfma_f32_16x16x32_bf16 v[72:75], v[24:27], v[212:215], v[72:75]
  v_mfma_f32_16x16x32_bf16 v[76:79], v[28:31], v[212:215], v[76:79]
  s_add_u32 m0, s23, 2048
  s_waitcnt lgkmcnt(0)
  buffer_load_dwordx4 v242, s[4:7], s21 offen lds
  buffer_load_dwordx4 v243, s[8:11], s21 offen offset:1024 lds
  ds_read_b64_tr_b16 v[24:25], v4 offset:4096
  ds_read_b64_tr_b16 v[26:27], v4 offset:4608
  ds_read_b64_tr_b16 v[28:29], v5 offset:4096
  ds_read_b64_tr_b16 v[30:31], v5 offset:4608
  v_mfma_f32_16x16x32_bf16 v[124:127], v[128:131], v[32:35], v[124:127]
  v_mfma_f32_16x16x32_bf16 v[116:119], v[132:135], v[36:39], v[116:119]
  v_mfma_f32_16x16x32_bf16 v[120:123], v[132:135], v[40:43], v[120:123]
  v_mfma_f32_16x16x32_bf16 v[124:127], v[132:135], v[44:47], v[124:127]
  v_mfma_f32_16x16x32_bf16 v[48:51], v[16:19], v[192:195], v[48:51]
  v_mfma_f32_16x16x32_bf16 v[52:55], v[20:23], v[192:195], v[52:55]
  v_mfma_f32_16x16x32_bf16 v[64:67], v[16:19], v[216:219], v[64:67]
  v_mfma_f32_16x16x32_bf16 v[68:71], v[20:23], v[216:219], v[68:71]
  s_add_u32 m0, s23, 4096
  s_waitcnt vmcnt(4) lgkmcnt(0)
  buffer_load_dwordx4 v244, s[4:7], s21 offen lds
  buffer_load_dwordx4 v245, s[8:11], s21 offen offset:1024 lds
  ds_read_b64_tr_b16 v[16:17], v2 offset:8192
  ds_read_b64_tr_b16 v[18:19], v2 offset:8704
  ds_read_b64_tr_b16 v[20:21], v3 offset:8192
  ds_read_b64_tr_b16 v[22:23], v3 offset:8704
  v_mfma_f32_16x16x32_bf16 v[56:59], v[24:27], v[192:195], v[56:59]
  v_mfma_f32_16x16x32_bf16 v[60:63], v[28:31], v[192:195], v[60:63]
  v_mfma_f32_16x16x32_bf16 v[72:75], v[24:27], v[216:219], v[72:75]
  v_mfma_f32_16x16x32_bf16 v[76:79], v[28:31], v[216:219], v[76:79]
  s_add_u32 m0, s23, 6144
  s_waitcnt lgkmcnt(0)
  buffer_load_dwordx4 v246, s[4:7], s21 offen lds
  buffer_load_dwordx4 v247, s[8:11], s21 offen offset:1024 lds
  ds_read_b64_tr_b16 v[24:25], v4 offset:8192
  ds_read_b64_tr_b16 v[26:27], v4 offset:8704
  ds_read_b64_tr_b16 v[28:29], v5 offset:8192
  ds_read_b64_tr_b16 v[30:31], v5 offset:8704
  v_mfma_f32_16x16x32_bf16 v[48:51], v[16:19], v[196:199], v[48:51]
  v_mfma_f32_16x16x32_bf16 v[52:55], v[20:23], v[196:199], v[52:55]
  v_mfma_f32_16x16x32_bf16 v[64:67], v[16:19], v[220:223], v[64:67]
  v_mfma_f32_16x16x32_bf16 v[68:71], v[20:23], v[220:223], v[68:71]
  s_add_u32 m0, s23, 8192
  s_waitcnt lgkmcnt(0)
  v_mfma_f32_16x16x32_bf16 v[56:59], v[24:27], v[196:199], v[56:59]
  v_mfma_f32_16x16x32_bf16 v[60:63], v[28:31], v[196:199], v[60:63]
  v_mfma_f32_16x16x32_bf16 v[72:75], v[24:27], v[220:223], v[72:75]
  v_mfma_f32_16x16x32_bf16 v[76:79], v[28:31], v[220:223], v[76:79]
  s_waitcnt vmcnt(4) lgkmcnt(0)
  buffer_load_dwordx4 v224, s[4:7], s21 offen lds
  buffer_load_dwordx4 v225, s[8:11], s21 offen offset:1024 lds
  ds_read_b64_tr_b16 v[16:17], v2 offset:0
  ds_read_b64_tr_b16 v[18:19], v2 offset:512
  ds_read_b64_tr_b16 v[20:21], v3 offset:0
  ds_read_b64_tr_b16 v[22:23], v3 offset:512
  s_add_u32 m0, s23, 10240
  s_nop 0
  v_cvt_pk_bf16_f32 v32, v48, v49
  v_cvt_pk_bf16_f32 v33, v50, v51
  v_cvt_pk_bf16_f32 v34, v52, v53
  v_cvt_pk_bf16_f32 v35, v54, v55
  v_cvt_pk_bf16_f32 v36, v56, v57
  v_cvt_pk_bf16_f32 v37, v58, v59
  v_cvt_pk_bf16_f32 v38, v60, v61
  v_cvt_pk_bf16_f32 v39, v62, v63
  v_cvt_pk_bf16_f32 v40, v64, v65
  v_cvt_pk_bf16_f32 v41, v66, v67
  v_cvt_pk_bf16_f32 v42, v68, v69
  v_cvt_pk_bf16_f32 v43, v70, v71
  v_cvt_pk_bf16_f32 v44, v72, v73
  v_cvt_pk_bf16_f32 v45, v74, v75
  v_cvt_pk_bf16_f32 v46, v76, v77
  v_cvt_pk_bf16_f32 v47, v78, v79
  ds_write_b128 v6, v[32:35] offset:16
  ds_write_b128 v6, v[36:39] offset:3088
  s_mov_b64 exec, s[42:43]
  ds_write_b128 v6, v[40:43] offset:0
  ds_write_b128 v6, v[44:47] offset:3072
  s_mov_b64 exec, -1
  v_subrev_u32 v6, s77, v6
  s_waitcnt lgkmcnt(0)
  buffer_load_dwordx4 v226, s[4:7], s21 offen lds
  buffer_load_dwordx4 v227, s[8:11], s21 offen offset:1024 lds
  ds_read_b64_tr_b16 v[24:25], v4 offset:0
  ds_read_b64_tr_b16 v[26:27], v4 offset:512
  ds_read_b64_tr_b16 v[28:29], v5 offset:0
  ds_read_b64_tr_b16 v[30:31], v5 offset:512
  v_add_u32 v7, s77, v7
  v_add_u32 v8, s77, v8
  v_mfma_f32_16x16x32_bf16 v[48:51], v[16:19], v[176:179], 0
  v_mfma_f32_16x16x32_bf16 v[52:55], v[20:23], v[176:179], 0
  v_mfma_f32_16x16x32_bf16 v[64:67], v[16:19], v[200:203], 0
  v_mfma_f32_16x16x32_bf16 v[68:71], v[20:23], v[200:203], 0
  s_add_u32 m0, s23, 0
  s_waitcnt vmcnt(4) lgkmcnt(0)
  buffer_load_dwordx4 v228, s[4:7], s21 offen lds
  buffer_load_dwordx4 v229, s[8:11], s21 offen offset:1024 lds
  ds_read_b64_tr_b16 v[16:17], v2 offset:4096
  ds_read_b64_tr_b16 v[18:19], v2 offset:4608
  ds_read_b64_tr_b16 v[20:21], v3 offset:4096
  ds_read_b64_tr_b16 v[22:23], v3 offset:4608
  v_mfma_f32_16x16x32_bf16 v[56:59], v[24:27], v[176:179], 0
  v_mfma_f32_16x16x32_bf16 v[60:63], v[28:31], v[176:179], 0
  v_mfma_f32_16x16x32_bf16 v[72:75], v[24:27], v[200:203], 0
  v_mfma_f32_16x16x32_bf16 v[76:79], v[28:31], v[200:203], 0
  s_add_u32 m0, s23, 2048
  s_waitcnt lgkmcnt(0)
  s_barrier
  buffer_load_dwordx4 v230, s[4:7], s21 offen lds
  buffer_load_dwordx4 v231, s[8:11], s21 offen offset:1024 lds
  ds_read_b64_tr_b16 v[24:25], v4 offset:4096
  ds_read_b64_tr_b16 v[26:27], v4 offset:4608
  ds_read_b64_tr_b16 v[28:29], v5 offset:4096
  ds_read_b64_tr_b16 v[30:31], v5 offset:4608
  ds_read_b128 v[32:35], v8 offset:18464
  ds_read_b128 v[36:39], v8 offset:18720
  ds_read_b128 v[40:43], v8 offset:18976
  ds_read_b128 v[44:47], v8 offset:21536
  v_mfma_f32_16x16x32_bf16 v[48:51], v[16:19], v[180:183], v[48:51]
  v_mfma_f32_16x16x32_bf16 v[52:55], v[20:23], v[180:183], v[52:55]
  v_mfma_f32_16x16x32_bf16 v[64:67], v[16:19], v[204:207], v[64:67]
  v_mfma_f32_16x16x32_bf16 v[68:71], v[20:23], v[204:207], v[68:71]
  s_add_u32 m0, s23, 4096
  s_waitcnt vmcnt(4) lgkmcnt(0)
  buffer_load_dwordx4 v232, s[4:7], s21 offen lds
  buffer_load_dwordx4 v233, s[8:11], s21 offen offset:1024 lds
  ds_read_b64_tr_b16 v[16:17], v2 offset:8192
  ds_read_b64_tr_b16 v[18:19], v2 offset:8704
  ds_read_b64_tr_b16 v[20:21], v3 offset:8192
  ds_read_b64_tr_b16 v[22:23], v3 offset:8704
  v_mfma_f32_16x16x32_bf16 v[92:95], v[152:155], v[32:35], v[92:95]
  v_mfma_f32_16x16x32_bf16 v[96:99], v[152:155], v[36:39], v[96:99]
  v_mfma_f32_16x16x32_bf16 v[100:103], v[152:155], v[40:43], v[100:103]
  v_mfma_f32_16x16x32_bf16 v[92:95], v[156:159], v[44:47], v[92:95]
  ds_read_b128 v[32:35], v8 offset:21792
  ds_read_b128 v[36:39], v8 offset:22048
  ds_read_b128 v[40:43], v7 offset:0
  ds_read_b128 v[44:47], v7 offset:256
  v_mfma_f32_16x16x32_bf16 v[56:59], v[24:27], v[180:183], v[56:59]
  v_mfma_f32_16x16x32_bf16 v[60:63], v[28:31], v[180:183], v[60:63]
  v_mfma_f32_16x16x32_bf16 v[72:75], v[24:27], v[204:207], v[72:75]
  v_mfma_f32_16x16x32_bf16 v[76:79], v[28:31], v[204:207], v[76:79]
  s_add_u32 m0, s23, 6144
  s_waitcnt lgkmcnt(0)
  buffer_load_dwordx4 v234, s[4:7], s21 offen lds
  buffer_load_dwordx4 v235, s[8:11], s21 offen offset:1024 lds
  ds_read_b64_tr_b16 v[24:25], v4 offset:8192
  ds_read_b64_tr_b16 v[26:27], v4 offset:8704
  ds_read_b64_tr_b16 v[28:29], v5 offset:8192
  ds_read_b64_tr_b16 v[30:31], v5 offset:8704
  v_mfma_f32_16x16x32_bf16 v[96:99], v[156:159], v[32:35], v[96:99]
  v_mfma_f32_16x16x32_bf16 v[100:103], v[156:159], v[36:39], v[100:103]
  v_mfma_f32_16x16x32_bf16 v[104:107], v[160:163], v[40:43], v[104:107]
  v_mfma_f32_16x16x32_bf16 v[108:111], v[160:163], v[44:47], v[108:111]
  ds_read_b128 v[32:35], v7 offset:512
  ds_read_b128 v[36:39], v7 offset:3072
  ds_read_b128 v[40:43], v7 offset:3328
  ds_read_b128 v[44:47], v7 offset:3584
  v_mfma_f32_16x16x32_bf16 v[48:51], v[16:19], v[184:187], v[48:51]
  v_mfma_f32_16x16x32_bf16 v[52:55], v[20:23], v[184:187], v[52:55]
  v_mfma_f32_16x16x32_bf16 v[64:67], v[16:19], v[208:211], v[64:67]
  v_mfma_f32_16x16x32_bf16 v[68:71], v[20:23], v[208:211], v[68:71]
  s_add_u32 m0, s23, 8192
  s_waitcnt vmcnt(4) lgkmcnt(0)
  buffer_load_dwordx4 v236, s[4:7], s21 offen lds
  buffer_load_dwordx4 v237, s[8:11], s21 offen offset:1024 lds
  ds_read_b64_tr_b16 v[16:17], v2 offset:0
  ds_read_b64_tr_b16 v[18:19], v2 offset:512
  ds_read_b64_tr_b16 v[20:21], v3 offset:0
  ds_read_b64_tr_b16 v[22:23], v3 offset:512
  v_mfma_f32_16x16x32_bf16 v[112:115], v[160:163], v[32:35], v[112:115]
  v_mfma_f32_16x16x32_bf16 v[104:107], v[164:167], v[36:39], v[104:107]
  v_mfma_f32_16x16x32_bf16 v[108:111], v[164:167], v[40:43], v[108:111]
  v_mfma_f32_16x16x32_bf16 v[112:115], v[164:167], v[44:47], v[112:115]
  ds_read_b128 v[32:35], v8 offset:0
  ds_read_b128 v[36:39], v8 offset:256
  ds_read_b128 v[40:43], v8 offset:512
  ds_read_b128 v[44:47], v8 offset:3072
  v_mfma_f32_16x16x32_bf16 v[56:59], v[24:27], v[184:187], v[56:59]
  v_mfma_f32_16x16x32_bf16 v[60:63], v[28:31], v[184:187], v[60:63]
  v_mfma_f32_16x16x32_bf16 v[72:75], v[24:27], v[208:211], v[72:75]
  v_mfma_f32_16x16x32_bf16 v[76:79], v[28:31], v[208:211], v[76:79]
  v_xor_b32 v152, 0x80008000, v152
  v_xor_b32 v153, 0x80008000, v153
  v_xor_b32 v154, 0x80008000, v154
  v_xor_b32 v155, 0x80008000, v155
  v_xor_b32 v156, 0x80008000, v156
  v_xor_b32 v157, 0x80008000, v157
  v_xor_b32 v158, 0x80008000, v158
  v_xor_b32 v159, 0x80008000, v159
  s_add_u32 m0, s23, 10240
  s_waitcnt lgkmcnt(0)
  buffer_load_dwordx4 v238, s[4:7], s21 offen lds
  buffer_load_dwordx4 v239, s[8:11], s21 offen offset:1024 lds
  ds_read_b64_tr_b16 v[24:25], v4 offset:0
  ds_read_b64_tr_b16 v[26:27], v4 offset:512
  ds_read_b64_tr_b16 v[28:29], v5 offset:0
  ds_read_b64_tr_b16 v[30:31], v5 offset:512
  v_mfma_f32_16x16x32_bf16 v[80:83], v[168:171], v[32:35], v[80:83]
  v_mfma_f32_16x16x32_bf16 v[84:87], v[168:171], v[36:39], v[84:87]
  v_mfma_f32_16x16x32_bf16 v[88:91], v[168:171], v[40:43], v[88:91]
  v_mfma_f32_16x16x32_bf16 v[80:83], v[172:175], v[44:47], v[80:83]
  ds_read_b128 v[32:35], v8 offset:3328
  ds_read_b128 v[36:39], v8 offset:3584
  ds_read_b128 v[40:43], v7 offset:18464
  ds_read_b128 v[44:47], v7 offset:18720
  v_mfma_f32_16x16x32_bf16 v[48:51], v[16:19], v[188:191], v[48:51]
  v_mfma_f32_16x16x32_bf16 v[52:55], v[20:23], v[188:191], v[52:55]
  v_mfma_f32_16x16x32_bf16 v[64:67], v[16:19], v[212:215], v[64:67]
  v_mfma_f32_16x16x32_bf16 v[68:71], v[20:23], v[212:215], v[68:71]
  s_add_u32 m0, s23, 0
  s_waitcnt vmcnt(4) lgkmcnt(0)
  s_mov_b32 s21, 896
  buffer_load_dwordx4 v240, s[4:7], s21 offen lds
  buffer_load_dwordx4 v241, s[8:11], s21 offen offset:1024 lds
  ds_read_b64_tr_b16 v[16:17], v2 offset:4096
  ds_read_b64_tr_b16 v[18:19], v2 offset:4608
  ds_read_b64_tr_b16 v[20:21], v3 offset:4096
  ds_read_b64_tr_b16 v[22:23], v3 offset:4608
  v_mfma_f32_16x16x32_bf16 v[84:87], v[172:175], v[32:35], v[84:87]
  v_mfma_f32_16x16x32_bf16 v[88:91], v[172:175], v[36:39], v[88:91]
  v_mfma_f32_16x16x32_bf16 v[116:119], v[152:155], v[40:43], v[116:119]
  v_mfma_f32_16x16x32_bf16 v[120:123], v[152:155], v[44:47], v[120:123]
  ds_read_b128 v[32:35], v7 offset:18976
  ds_read_b128 v[36:39], v7 offset:21536
  ds_read_b128 v[40:43], v7 offset:21792
  ds_read_b128 v[44:47], v7 offset:22048
  v_mfma_f32_16x16x32_bf16 v[56:59], v[24:27], v[188:191], v[56:59]
  v_mfma_f32_16x16x32_bf16 v[60:63], v[28:31], v[188:191], v[60:63]
  v_mfma_f32_16x16x32_bf16 v[72:75], v[24:27], v[212:215], v[72:75]
  v_mfma_f32_16x16x32_bf16 v[76:79], v[28:31], v[212:215], v[76:79]
  s_add_u32 m0, s23, 2048
  s_waitcnt lgkmcnt(0)
  buffer_load_dwordx4 v242, s[4:7], s21 offen lds
  buffer_load_dwordx4 v243, s[8:11], s21 offen offset:1024 lds
  ds_read_b64_tr_b16 v[24:25], v4 offset:4096
  ds_read_b64_tr_b16 v[26:27], v4 offset:4608
  ds_read_b64_tr_b16 v[28:29], v5 offset:4096
  ds_read_b64_tr_b16 v[30:31], v5 offset:4608
  v_mfma_f32_16x16x32_bf16 v[124:127], v[152:155], v[32:35], v[124:127]
  v_mfma_f32_16x16x32_bf16 v[116:119], v[156:159], v[36:39], v[116:119]
  v_mfma_f32_16x16x32_bf16 v[120:123], v[156:159], v[40:43], v[120:123]
  v_mfma_f32_16x16x32_bf16 v[124:127], v[156:159], v[44:47], v[124:127]
  v_mfma_f32_16x16x32_bf16 v[48:51], v[16:19], v[192:195], v[48:51]
  v_mfma_f32_16x16x32_bf16 v[52:55], v[20:23], v[192:195], v[52:55]
  v_mfma_f32_16x16x32_bf16 v[64:67], v[16:19], v[216:219], v[64:67]
  v_mfma_f32_16x16x32_bf16 v[68:71], v[20:23], v[216:219], v[68:71]
  s_add_u32 m0, s23, 4096
  s_waitcnt vmcnt(4) lgkmcnt(0)
  buffer_load_dwordx4 v244, s[4:7], s21 offen lds
  buffer_load_dwordx4 v245, s[8:11], s21 offen offset:1024 lds
  ds_read_b64_tr_b16 v[16:17], v2 offset:8192
  ds_read_b64_tr_b16 v[18:19], v2 offset:8704
  ds_read_b64_tr_b16 v[20:21], v3 offset:8192
  ds_read_b64_tr_b16 v[22:23], v3 offset:8704
  v_mfma_f32_16x16x32_bf16 v[56:59], v[24:27], v[192:195], v[56:59]
  v_mfma_f32_16x16x32_bf16 v[60:63], v[28:31], v[192:195], v[60:63]
  v_mfma_f32_16x16x32_bf16 v[72:75], v[24:27], v[216:219], v[72:75]
  v_mfma_f32_16x16x32_bf16 v[76:79], v[28:31], v[216:219], v[76:79]
  s_add_u32 m0, s23, 6144
  s_waitcnt lgkmcnt(0)
  buffer_load_dwordx4 v246, s[4:7], s21 offen lds
  buffer_load_dwordx4 v247, s[8:11], s21 offen offset:1024 lds
  ds_read_b64_tr_b16 v[24:25], v4 offset:8192
  ds_read_b64_tr_b16 v[26:27], v4 offset:8704
  ds_read_b64_tr_b16 v[28:29], v5 offset:8192
  ds_read_b64_tr_b16 v[30:31], v5 offset:8704
  v_mfma_f32_16x16x32_bf16 v[48:51], v[16:19], v[196:199], v[48:51]
  v_mfma_f32_16x16x32_bf16 v[52:55], v[20:23], v[196:199], v[52:55]
  v_mfma_f32_16x16x32_bf16 v[64:67], v[16:19], v[220:223], v[64:67]
  v_mfma_f32_16x16x32_bf16 v[68:71], v[20:23], v[220:223], v[68:71]
  s_add_u32 m0, s23, 8192
  s_waitcnt lgkmcnt(0)
  v_mfma_f32_16x16x32_bf16 v[56:59], v[24:27], v[196:199], v[56:59]
  v_mfma_f32_16x16x32_bf16 v[60:63], v[28:31], v[196:199], v[60:63]
  v_mfma_f32_16x16x32_bf16 v[72:75], v[24:27], v[220:223], v[72:75]
  v_mfma_f32_16x16x32_bf16 v[76:79], v[28:31], v[220:223], v[76:79]
  s_waitcnt vmcnt(4) lgkmcnt(0)
  buffer_load_dwordx4 v224, s[4:7], s21 offen lds
  buffer_load_dwordx4 v225, s[8:11], s21 offen offset:1024 lds
  ds_read_b64_tr_b16 v[16:17], v2 offset:0
  ds_read_b64_tr_b16 v[18:19], v2 offset:512
  ds_read_b64_tr_b16 v[20:21], v3 offset:0
  ds_read_b64_tr_b16 v[22:23], v3 offset:512
  s_add_u32 m0, s23, 10240
  s_nop 0
  v_cvt_pk_bf16_f32 v32, v48, v49
  v_cvt_pk_bf16_f32 v33, v50, v51
  v_cvt_pk_bf16_f32 v34, v52, v53
  v_cvt_pk_bf16_f32 v35, v54, v55
  v_cvt_pk_bf16_f32 v36, v56, v57
  v_cvt_pk_bf16_f32 v37, v58, v59
  v_cvt_pk_bf16_f32 v38, v60, v61
  v_cvt_pk_bf16_f32 v39, v62, v63
  v_cvt_pk_bf16_f32 v40, v64, v65
  v_cvt_pk_bf16_f32 v41, v66, v67
  v_cvt_pk_bf16_f32 v42, v68, v69
  v_cvt_pk_bf16_f32 v43, v70, v71
  v_cvt_pk_bf16_f32 v44, v72, v73
  v_cvt_pk_bf16_f32 v45, v74, v75
  v_cvt_pk_bf16_f32 v46, v76, v77
  v_cvt_pk_bf16_f32 v47, v78, v79
  ds_write_b128 v6, v[32:35] offset:16
  ds_write_b128 v6, v[36:39] offset:3088
  s_mov_b64 exec, s[42:43]
  ds_write_b128 v6, v[40:43] offset:0
  ds_write_b128 v6, v[44:47] offset:3072
  s_mov_b64 exec, -1
  v_add_u32 v6, s77, v6
  s_waitcnt lgkmcnt(0)
  buffer_load_dwordx4 v226, s[4:7], s21 offen lds
  buffer_load_dwordx4 v227, s[8:11], s21 offen offset:1024 lds
  ds_read_b64_tr_b16 v[24:25], v4 offset:0
  ds_read_b64_tr_b16 v[26:27], v4 offset:512
  ds_read_b64_tr_b16 v[28:29], v5 offset:0
  ds_read_b64_tr_b16 v[30:31], v5 offset:512
  v_subrev_u32 v7, s77, v7
  v_subrev_u32 v8, s77, v8
  v_mfma_f32_16x16x32_bf16 v[48:51], v[16:19], v[176:179], 0
  v_mfma_f32_16x16x32_bf16 v[52:55], v[20:23], v[176:179], 0
  v_mfma_f32_16x16x32_bf16 v[64:67], v[16:19], v[200:203], 0
  v_mfma_f32_16x16x32_bf16 v[68:71], v[20:23], v[200:203], 0
  s_add_u32 m0, s23, 0
  s_waitcnt vmcnt(4) lgkmcnt(0)
  buffer_load_dwordx4 v228, s[4:7], s21 offen lds
  buffer_load_dwordx4 v229, s[8:11], s21 offen offset:1024 lds
  ds_read_b64_tr_b16 v[16:17], v2 offset:4096
  ds_read_b64_tr_b16 v[18:19], v2 offset:4608
  ds_read_b64_tr_b16 v[20:21], v3 offset:4096
  ds_read_b64_tr_b16 v[22:23], v3 offset:4608
  v_mfma_f32_16x16x32_bf16 v[56:59], v[24:27], v[176:179], 0
  v_mfma_f32_16x16x32_bf16 v[60:63], v[28:31], v[176:179], 0
  v_mfma_f32_16x16x32_bf16 v[72:75], v[24:27], v[200:203], 0
  v_mfma_f32_16x16x32_bf16 v[76:79], v[28:31], v[200:203], 0
  s_add_u32 m0, s23, 2048
  s_waitcnt lgkmcnt(0)
  s_barrier
  buffer_load_dwordx4 v230, s[4:7], s21 offen lds
  buffer_load_dwordx4 v231, s[8:11], s21 offen offset:1024 lds
  ds_read_b64_tr_b16 v[24:25], v4 offset:4096
  ds_read_b64_tr_b16 v[26:27], v4 offset:4608
  ds_read_b64_tr_b16 v[28:29], v5 offset:4096
  ds_read_b64_tr_b16 v[30:31], v5 offset:4608
  ds_read_b128 v[32:35], v8 offset:0
  ds_read_b128 v[36:39], v8 offset:256
  ds_read_b128 v[40:43], v8 offset:512
  ds_read_b128 v[44:47], v8 offset:3072
  v_mfma_f32_16x16x32_bf16 v[48:51], v[16:19], v[180:183], v[48:51]
  v_mfma_f32_16x16x32_bf16 v[52:55], v[20:23], v[180:183], v[52:55]
  v_mfma_f32_16x16x32_bf16 v[64:67], v[16:19], v[204:207], v[64:67]
  v_mfma_f32_16x16x32_bf16 v[68:71], v[20:23], v[204:207], v[68:71]
  s_add_u32 m0, s23, 4096
  s_waitcnt vmcnt(4) lgkmcnt(0)
  buffer_load_dwordx4 v232, s[4:7], s21 offen lds
  buffer_load_dwordx4 v233, s[8:11], s21 offen offset:1024 lds
  ds_read_b64_tr_b16 v[16:17], v2 offset:8192
  ds_read_b64_tr_b16 v[18:19], v2 offset:8704
  ds_read_b64_tr_b16 v[20:21], v3 offset:8192
  ds_read_b64_tr_b16 v[22:23], v3 offset:8704
  v_mfma_f32_16x16x32_bf16 v[92:95], v[128:131], v[32:35], v[92:95]
  v_mfma_f32_16x16x32_bf16 v[96:99], v[128:131], v[36:39], v[96:99]
  v_mfma_f32_16x16x32_bf16 v[100:103], v[128:131], v[40:43], v[100:103]
  v_mfma_f32_16x16x32_bf16 v[92:95], v[132:135], v[44:47], v[92:95]
  ds_read_b128 v[32:35], v8 offset:3328
  ds_read_b128 v[36:39], v8 offset:3584
  ds_read_b128 v[40:43], v7 offset:0
  ds_read_b128 v[44:47], v7 offset:256
  v_mfma_f32_16x16x32_bf16 v[56:59], v[24:27], v[180:183], v[56:59]
  v_mfma_f32_16x16x32_bf16 v[60:63], v[28:31], v[180:183], v[60:63]
  v_mfma_f32_16x16x32_bf16 v[72:75], v[24:27], v[204:207], v[72:75]
  v_mfma_f32_16x16x32_bf16 v[76:79], v[28:31], v[204:207], v[76:79]
  s_add_u32 m0, s23, 6144
  s_waitcnt lgkmcnt(0)
  buffer_load_dwordx4 v234, s[4:7], s21 offen lds
  buffer_load_dwordx4 v235, s[8:11], s21 offen offset:1024 lds
  ds_read_b64_tr_b16 v[24:25], v4 offset:8192
  ds_read_b64_tr_b16 v[26:27], v4 offset:8704
  ds_read_b64_tr_b16 v[28:29], v5 offset:8192
  ds_read_b64_tr_b16 v[30:31], v5 offset:8704
  v_mfma_f32_16x16x32_bf16 v[96:99], v[132:135], v[32:35], v[96:99]
  v_mfma_f32_16x16x32_bf16 v[100:103], v[132:135], v[36:39], v[100:103]
  v_mfma_f32_16x16x32_bf16 v[116:119], v[136:139], v[40:43], v[116:119]
  v_mfma_f32_16x16x32_bf16 v[120:123], v[136:139], v[44:47], v[120:123]
  ds_read_b128 v[32:35], v7 offset:512
  ds_read_b128 v[36:39], v7 offset:3072
  ds_read_b128 v[40:43], v7 offset:3328
  ds_read_b128 v[44:47], v7 offset:3584
  v_mfma_f32_16x16x32_bf16 v[48:51], v[16:19], v[184:187], v[48:51]
  v_mfma_f32_16x16x32_bf16 v[52:55], v[20:23], v[184:187], v[52:55]
  v_mfma_f32_16x16x32_bf16 v[64:67], v[16:19], v[208:211], v[64:67]
  v_mfma_f32_16x16x32_bf16 v[68:71], v[20:23], v[208:211], v[68:71]
  s_add_u32 m0, s23, 8192
  s_waitcnt vmcnt(4) lgkmcnt(0)
  buffer_load_dwordx4 v236, s[4:7], s21 offen lds
  buffer_load_dwordx4 v237, s[8:11], s21 offen offset:1024 lds
  ds_read_b64_tr_b16 v[16:17], v2 offset:0
  ds_read_b64_tr_b16 v[18:19], v2 offset:512
  ds_read_b64_tr_b16 v[20:21], v3 offset:0
  ds_read_b64_tr_b16 v[22:23], v3 offset:512
  v_mfma_f32_16x16x32_bf16 v[124:127], v[136:139], v[32:35], v[124:127]
  v_mfma_f32_16x16x32_bf16 v[116:119], v[140:143], v[36:39], v[116:119]
  v_mfma_f32_16x16x32_bf16 v[120:123], v[140:143], v[40:43], v[120:123]
  v_mfma_f32_16x16x32_bf16 v[124:127], v[140:143], v[44:47], v[124:127]
  ds_read_b128 v[32:35], v8 offset:18464
  ds_read_b128 v[36:39], v8 offset:18720
  ds_read_b128 v[40:43], v8 offset:18976
  ds_read_b128 v[44:47], v8 offset:21536
  v_mfma_f32_16x16x32_bf16 v[56:59], v[24:27], v[184:187], v[56:59]
  v_mfma_f32_16x16x32_bf16 v[60:63], v[28:31], v[184:187], v[60:63]
  v_mfma_f32_16x16x32_bf16 v[72:75], v[24:27], v[208:211], v[72:75]
  v_mfma_f32_16x16x32_bf16 v[76:79], v[28:31], v[208:211], v[76:79]
  v_xor_b32 v128, 0x80008000, v128
  v_xor_b32 v129, 0x80008000, v129
  v_xor_b32 v130, 0x80008000, v130
  v_xor_b32 v131, 0x80008000, v131
  v_xor_b32 v132, 0x80008000, v132
  v_xor_b32 v133, 0x80008000, v133
  v_xor_b32 v134, 0x80008000, v134
  v_xor_b32 v135, 0x80008000, v135
  s_add_u32 m0, s23, 10240
  s_waitcnt lgkmcnt(0)
  buffer_load_dwordx4 v238, s[4:7], s21 offen lds
  buffer_load_dwordx4 v239, s[8:11], s21 offen offset:1024 lds
  ds_read_b64_tr_b16 v[24:25], v4 offset:0
  ds_read_b64_tr_b16 v[26:27], v4 offset:512
  ds_read_b64_tr_b16 v[28:29], v5 offset:0
  ds_read_b64_tr_b16 v[30:31], v5 offset:512
  v_mfma_f32_16x16x32_bf16 v[80:83], v[144:147], v[32:35], v[80:83]
  v_mfma_f32_16x16x32_bf16 v[84:87], v[144:147], v[36:39], v[84:87]
  v_mfma_f32_16x16x32_bf16 v[88:91], v[144:147], v[40:43], v[88:91]
  v_mfma_f32_16x16x32_bf16 v[80:83], v[148:151], v[44:47], v[80:83]
  ds_read_b128 v[32:35], v8 offset:21792
  ds_read_b128 v[36:39], v8 offset:22048
  ds_read_b128 v[40:43], v7 offset:18464
  ds_read_b128 v[44:47], v7 offset:18720
  v_mfma_f32_16x16x32_bf16 v[48:51], v[16:19], v[188:191], v[48:51]
  v_mfma_f32_16x16x32_bf16 v[52:55], v[20:23], v[188:191], v[52:55]
  v_mfma_f32_16x16x32_bf16 v[64:67], v[16:19], v[212:215], v[64:67]
  v_mfma_f32_16x16x32_bf16 v[68:71], v[20:23], v[212:215], v[68:71]
  s_add_u32 m0, s23, 0
  s_waitcnt vmcnt(4) lgkmcnt(0)
  s_mov_b32 s21, 0
  buffer_load_dwordx4 v240, s[4:7], s21 offen lds
  buffer_load_dwordx4 v241, s[8:11], s21 offen offset:1024 lds
  ds_read_b64_tr_b16 v[16:17], v2 offset:4096
  ds_read_b64_tr_b16 v[18:19], v2 offset:4608
  ds_read_b64_tr_b16 v[20:21], v3 offset:4096
  ds_read_b64_tr_b16 v[22:23], v3 offset:4608
  v_mfma_f32_16x16x32_bf16 v[84:87], v[148:151], v[32:35], v[84:87]
  v_mfma_f32_16x16x32_bf16 v[88:91], v[148:151], v[36:39], v[88:91]
  v_mfma_f32_16x16x32_bf16 v[104:107], v[128:131], v[40:43], v[104:107]
  v_mfma_f32_16x16x32_bf16 v[108:111], v[128:131], v[44:47], v[108:111]
  ds_read_b128 v[32:35], v7 offset:18976
  ds_read_b128 v[36:39], v7 offset:21536
  ds_read_b128 v[40:43], v7 offset:21792
  ds_read_b128 v[44:47], v7 offset:22048
  v_mfma_f32_16x16x32_bf16 v[56:59], v[24:27], v[188:191], v[56:59]
  v_mfma_f32_16x16x32_bf16 v[60:63], v[28:31], v[188:191], v[60:63]
  v_mfma_f32_16x16x32_bf16 v[72:75], v[24:27], v[212:215], v[72:75]
  v_mfma_f32_16x16x32_bf16 v[76:79], v[28:31], v[212:215], v[76:79]
  s_add_u32 m0, s23, 2048
  s_waitcnt lgkmcnt(0)
  buffer_load_dwordx4 v242, s[4:7], s21 offen lds
  buffer_load_dwordx4 v243, s[8:11], s21 offen offset:1024 lds
  ds_read_b64_tr_b16 v[24:25], v4 offset:4096
  ds_read_b64_tr_b16 v[26:27], v4 offset:4608
  ds_read_b64_tr_b16 v[28:29], v5 offset:4096
  ds_read_b64_tr_b16 v[30:31], v5 offset:4608
  v_mfma_f32_16x16x32_bf16 v[112:115], v[128:131], v[32:35], v[112:115]
  v_mfma_f32_16x16x32_bf16 v[104:107], v[132:135], v[36:39], v[104:107]
  v_mfma_f32_16x16x32_bf16 v[108:111], v[132:135], v[40:43], v[108:111]
  v_mfma_f32_16x16x32_bf16 v[112:115], v[132:135], v[44:47], v[112:115]
  v_mfma_f32_16x16x32_bf16 v[48:51], v[16:19], v[192:195], v[48:51]
  v_mfma_f32_16x16x32_bf16 v[52:55], v[20:23], v[192:195], v[52:55]
  v_mfma_f32_16x16x32_bf16 v[64:67], v[16:19], v[216:219], v[64:67]
  v_mfma_f32_16x16x32_bf16 v[68:71], v[20:23], v[216:219], v[68:71]
  s_add_u32 m0, s23, 4096
  s_waitcnt vmcnt(4) lgkmcnt(0)
  buffer_load_dwordx4 v244, s[4:7], s21 offen lds
  buffer_load_dwordx4 v245, s[8:11], s21 offen offset:1024 lds
  ds_read_b64_tr_b16 v[16:17], v2 offset:8192
  ds_read_b64_tr_b16 v[18:19], v2 offset:8704
  ds_read_b64_tr_b16 v[20:21], v3 offset:8192
  ds_read_b64_tr_b16 v[22:23], v3 offset:8704
  v_mfma_f32_16x16x32_bf16 v[56:59], v[24:27], v[192:195], v[56:59]
  v_mfma_f32_16x16x32_bf16 v[60:63], v[28:31], v[192:195], v[60:63]
  v_mfma_f32_16x16x32_bf16 v[72:75], v[24:27], v[216:219], v[72:75]
  v_mfma_f32_16x16x32_bf16 v[76:79], v[28:31], v[216:219], v[76:79]
  s_add_u32 m0, s23, 6144
  s_waitcnt lgkmcnt(0)
  buffer_load_dwordx4 v246, s[4:7], s21 offen lds
  buffer_load_dwordx4 v247, s[8:11], s21 offen offset:1024 lds
  ds_read_b64_tr_b16 v[24:25], v4 offset:8192
  ds_read_b64_tr_b16 v[26:27], v4 offset:8704
  ds_read_b64_tr_b16 v[28:29], v5 offset:8192
  ds_read_b64_tr_b16 v[30:31], v5 offset:8704
  v_mfma_f32_16x16x32_bf16 v[48:51], v[16:19], v[196:199], v[48:51]
  v_mfma_f32_16x16x32_bf16 v[52:55], v[20:23], v[196:199], v[52:55]
  v_mfma_f32_16x16x32_bf16 v[64:67], v[16:19], v[220:223], v[64:67]
  v_mfma_f32_16x16x32_bf16 v[68:71], v[20:23], v[220:223], v[68:71]
  s_add_u32 m0, s23, 8192
  s_waitcnt lgkmcnt(0)
  v_mfma_f32_16x16x32_bf16 v[56:59], v[24:27], v[196:199], v[56:59]
  v_mfma_f32_16x16x32_bf16 v[60:63], v[28:31], v[196:199], v[60:63]
  v_mfma_f32_16x16x32_bf16 v[72:75], v[24:27], v[220:223], v[72:75]
  v_mfma_f32_16x16x32_bf16 v[76:79], v[28:31], v[220:223], v[76:79]
  s_waitcnt vmcnt(4) lgkmcnt(0)
  buffer_load_dwordx4 v224, s[4:7], s21 offen lds
  buffer_load_dwordx4 v225, s[8:11], s21 offen offset:1024 lds
  ds_read_b64_tr_b16 v[16:17], v2 offset:0
  ds_read_b64_tr_b16 v[18:19], v2 offset:512
  ds_read_b64_tr_b16 v[20:21], v3 offset:0
  ds_read_b64_tr_b16 v[22:23], v3 offset:512
  s_add_u32 s37, s44, 4096
  buffer_load_dwordx4 v[128:131], v10, s[12:15], s44 offen offset:0
  buffer_load_dwordx4 v[132:135], v10, s[12:15], s44 offen offset:1024
  buffer_load_dwordx4 v[136:139], v10, s[12:15], s37 offen offset:0
  buffer_load_dwordx4 v[140:143], v10, s[12:15], s37 offen offset:1024
  s_add_u32 m0, s23, 10240
  v_cvt_pk_bf16_f32 v32, v48, v49
  v_cvt_pk_bf16_f32 v33, v50, v51
  v_cvt_pk_bf16_f32 v34, v52, v53
  v_cvt_pk_bf16_f32 v35, v54, v55
  v_cvt_pk_bf16_f32 v36, v56, v57
  v_cvt_pk_bf16_f32 v37, v58, v59
  v_cvt_pk_bf16_f32 v38, v60, v61
  v_cvt_pk_bf16_f32 v39, v62, v63
  v_cvt_pk_bf16_f32 v40, v64, v65
  v_cvt_pk_bf16_f32 v41, v66, v67
  v_cvt_pk_bf16_f32 v42, v68, v69
  v_cvt_pk_bf16_f32 v43, v70, v71
  v_cvt_pk_bf16_f32 v44, v72, v73
  v_cvt_pk_bf16_f32 v45, v74, v75
  v_cvt_pk_bf16_f32 v46, v76, v77
  v_cvt_pk_bf16_f32 v47, v78, v79
  ds_write_b128 v6, v[32:35] offset:16
  ds_write_b128 v6, v[36:39] offset:3088
  s_mov_b64 exec, s[42:43]
  ds_write_b128 v6, v[40:43] offset:0
  ds_write_b128 v6, v[44:47] offset:3072
  s_mov_b64 exec, -1
  v_subrev_u32 v6, s77, v6
  s_waitcnt lgkmcnt(0)
  buffer_load_dwordx4 v226, s[4:7], s21 offen lds
  buffer_load_dwordx4 v227, s[8:11], s21 offen offset:1024 lds
  ds_read_b64_tr_b16 v[24:25], v4 offset:0
  ds_read_b64_tr_b16 v[26:27], v4 offset:512
  ds_read_b64_tr_b16 v[28:29], v5 offset:0
  ds_read_b64_tr_b16 v[30:31], v5 offset:512
  v_add_u32 v7, s77, v7
  v_add_u32 v8, s77, v8
  v_mfma_f32_16x16x32_bf16 v[48:51], v[16:19], v[176:179], 0
  v_mfma_f32_16x16x32_bf16 v[52:55], v[20:23], v[176:179], 0
  v_mfma_f32_16x16x32_bf16 v[64:67], v[16:19], v[200:203], 0
  v_mfma_f32_16x16x32_bf16 v[68:71], v[20:23], v[200:203], 0
  s_add_u32 m0, s23, 0
  s_waitcnt vmcnt(8) lgkmcnt(0)
  buffer_load_dwordx4 v228, s[4:7], s21 offen lds
  buffer_load_dwordx4 v229, s[8:11], s21 offen offset:1024 lds
  ds_read_b64_tr_b16 v[16:17], v2 offset:4096
  ds_read_b64_tr_b16 v[18:19], v2 offset:4608
  ds_read_b64_tr_b16 v[20:21], v3 offset:4096
  ds_read_b64_tr_b16 v[22:23], v3 offset:4608
  v_mfma_f32_16x16x32_bf16 v[56:59], v[24:27], v[176:179], 0
  v_mfma_f32_16x16x32_bf16 v[60:63], v[28:31], v[176:179], 0
  v_mfma_f32_16x16x32_bf16 v[72:75], v[24:27], v[200:203], 0
  v_mfma_f32_16x16x32_bf16 v[76:79], v[28:31], v[200:203], 0
  s_add_u32 m0, s23, 2048
  s_waitcnt lgkmcnt(0)
  s_barrier
  buffer_load_dwordx4 v230, s[4:7], s21 offen lds
  buffer_load_dwordx4 v231, s[8:11], s21 offen offset:1024 lds
  ds_read_b64_tr_b16 v[24:25], v4 offset:4096
  ds_read_b64_tr_b16 v[26:27], v4 offset:4608
  ds_read_b64_tr_b16 v[28:29], v5 offset:4096
  ds_read_b64_tr_b16 v[30:31], v5 offset:4608
  ds_read_b128 v[32:35], v8 offset:0
  ds_read_b128 v[36:39], v8 offset:256
  ds_read_b128 v[40:43], v8 offset:512
  ds_read_b128 v[44:47], v8 offset:3072
  v_mfma_f32_16x16x32_bf16 v[48:51], v[16:19], v[180:183], v[48:51]
  v_mfma_f32_16x16x32_bf16 v[52:55], v[20:23], v[180:183], v[52:55]
  v_mfma_f32_16x16x32_bf16 v[64:67], v[16:19], v[204:207], v[64:67]
  v_mfma_f32_16x16x32_bf16 v[68:71], v[20:23], v[204:207], v[68:71]
  s_add_u32 m0, s23, 4096
  s_waitcnt vmcnt(4) lgkmcnt(0)
  buffer_load_dwordx4 v232, s[4:7], s21 offen lds
  buffer_load_dwordx4 v233, s[8:11], s21 offen offset:1024 lds
  ds_read_b64_tr_b16 v[16:17], v2 offset:8192
  ds_read_b64_tr_b16 v[18:19], v2 offset:8704
  ds_read_b64_tr_b16 v[20:21], v3 offset:8192
  ds_read_b64_tr_b16 v[22:23], v3 offset:8704
  v_mfma_f32_16x16x32_bf16 v[92:95], v[152:155], v[32:35], v[92:95]
  v_mfma_f32_16x16x32_bf16 v[96:99], v[152:155], v[36:39], v[96:99]
  v_mfma_f32_16x16x32_bf16 v[100:103], v[152:155], v[40:43], v[100:103]
  v_mfma_f32_16x16x32_bf16 v[92:95], v[156:159], v[44:47], v[92:95]
  ds_read_b128 v[32:35], v8 offset:3328
  ds_read_b128 v[36:39], v8 offset:3584
  ds_read_b128 v[40:43], v7 offset:0
  ds_read_b128 v[44:47], v7 offset:256
  v_mfma_f32_16x16x32_bf16 v[56:59], v[24:27], v[180:183], v[56:59]
  v_mfma_f32_16x16x32_bf16 v[60:63], v[28:31], v[180:183], v[60:63]
  v_mfma_f32_16x16x32_bf16 v[72:75], v[24:27], v[204:207], v[72:75]
  v_mfma_f32_16x16x32_bf16 v[76:79], v[28:31], v[204:207], v[76:79]
  s_add_u32 m0, s23, 6144
  s_waitcnt lgkmcnt(0)
  buffer_load_dwordx4 v234, s[4:7], s21 offen lds
  buffer_load_dwordx4 v235, s[8:11], s21 offen offset:1024 lds
  ds_read_b64_tr_b16 v[24:25], v4 offset:8192
  ds_read_b64_tr_b16 v[26:27], v4 offset:8704
  ds_read_b64_tr_b16 v[28:29], v5 offset:8192
  ds_read_b64_tr_b16 v[30:31], v5 offset:8704
  v_mfma_f32_16x16x32_bf16 v[96:99], v[156:159], v[32:35], v[96:99]
  v_mfma_f32_16x16x32_bf16 v[100:103], v[156:159], v[36:39], v[100:103]
  v_mfma_f32_16x16x32_bf16 v[116:119], v[160:163], v[40:43], v[116:119]
  v_mfma_f32_16x16x32_bf16 v[120:123], v[160:163], v[44:47], v[120:123]
  ds_read_b128 v[32:35], v7 offset:512
  ds_read_b128 v[36:39], v7 offset:3072
  ds_read_b128 v[40:43], v7 offset:3328
  ds_read_b128 v[44:47], v7 offset:3584
  v_mfma_f32_16x16x32_bf16 v[48:51], v[16:19], v[184:187], v[48:51]
  v_mfma_f32_16x16x32_bf16 v[52:55], v[20:23], v[184:187], v[52:55]
  v_mfma_f32_16x16x32_bf16 v[64:67], v[16:19], v[208:211], v[64:67]
  v_mfma_f32_16x16x32_bf16 v[68:71], v[20:23], v[208:211], v[68:71]
  s_add_u32 m0, s23, 8192
  s_waitcnt vmcnt(4) lgkmcnt(0)
  buffer_load_dwordx4 v236, s[4:7], s21 offen lds
  buffer_load_dwordx4 v237, s[8:11], s21 offen offset:1024 lds
  ds_read_b64_tr_b16 v[16:17], v2 offset:0
  ds_read_b64_tr_b16 v[18:19], v2 offset:512
  ds_read_b64_tr_b16 v[20:21], v3 offset:0
  ds_read_b64_tr_b16 v[22:23], v3 offset:512
  v_mfma_f32_16x16x32_bf16 v[124:127], v[160:163], v[32:35], v[124:127]
  v_mfma_f32_16x16x32_bf16 v[116:119], v[164:167], v[36:39], v[116:119]
  v_mfma_f32_16x16x32_bf16 v[120:123], v[164:167], v[40:43], v[120:123]
  v_mfma_f32_16x16x32_bf16 v[124:127], v[164:167], v[44:47], v[124:127]
  ds_read_b128 v[32:35], v8 offset:18464
  ds_read_b128 v[36:39], v8 offset:18720
  ds_read_b128 v[40:43], v8 offset:18976
  ds_read_b128 v[44:47], v8 offset:21536
  v_mfma_f32_16x16x32_bf16 v[56:59], v[24:27], v[184:187], v[56:59]
  v_mfma_f32_16x16x32_bf16 v[60:63], v[28:31], v[184:187], v[60:63]
  v_mfma_f32_16x16x32_bf16 v[72:75], v[24:27], v[208:211], v[72:75]
  v_mfma_f32_16x16x32_bf16 v[76:79], v[28:31], v[208:211], v[76:79]
  v_xor_b32 v152, 0x80008000, v152
  v_xor_b32 v153, 0x80008000, v153
  v_xor_b32 v154, 0x80008000, v154
  v_xor_b32 v155, 0x80008000, v155
  v_xor_b32 v156, 0x80008000, v156
  v_xor_b32 v157, 0x80008000, v157
  v_xor_b32 v158, 0x80008000, v158
  v_xor_b32 v159, 0x80008000, v159
  s_add_u32 m0, s23, 10240
  s_waitcnt lgkmcnt(0)
  buffer_load_dwordx4 v238, s[4:7], s21 offen lds
  buffer_load_dwordx4 v239, s[8:11], s21 offen offset:1024 lds
  ds_read_b64_tr_b16 v[24:25], v4 offset:0
  ds_read_b64_tr_b16 v[26:27], v4 offset:512
  ds_read_b64_tr_b16 v[28:29], v5 offset:0
  ds_read_b64_tr_b16 v[30:31], v5 offset:512
  v_mfma_f32_16x16x32_bf16 v[80:83], v[168:171], v[32:35], v[80:83]
  v_mfma_f32_16x16x32_bf16 v[84:87], v[168:171], v[36:39], v[84:87]
  v_mfma_f32_16x16x32_bf16 v[88:91], v[168:171], v[40:43], v[88:91]
  v_mfma_f32_16x16x32_bf16 v[80:83], v[172:175], v[44:47], v[80:83]
  ds_read_b128 v[32:35], v8 offset:21792
  ds_read_b128 v[36:39], v8 offset:22048
  ds_read_b128 v[40:43], v7 offset:18464
  ds_read_b128 v[44:47], v7 offset:18720
  v_mfma_f32_16x16x32_bf16 v[48:51], v[16:19], v[188:191], v[48:51]
  v_mfma_f32_16x16x32_bf16 v[52:55], v[20:23], v[188:191], v[52:55]
  v_mfma_f32_16x16x32_bf16 v[64:67], v[16:19], v[212:215], v[64:67]
  v_mfma_f32_16x16x32_bf16 v[68:71], v[20:23], v[212:215], v[68:71]
  s_add_u32 m0, s23, 0
  s_waitcnt vmcnt(4) lgkmcnt(0)
  s_mov_b32 s21, 128
  buffer_load_dwordx4 v240, s[4:7], s21 offen lds
  buffer_load_dwordx4 v241, s[8:11], s21 offen offset:1024 lds
  ds_read_b64_tr_b16 v[16:17], v2 offset:4096
  ds_read_b64_tr_b16 v[18:19], v2 offset:4608
  ds_read_b64_tr_b16 v[20:21], v3 offset:4096
  ds_read_b64_tr_b16 v[22:23], v3 offset:4608
  v_mfma_f32_16x16x32_bf16 v[84:87], v[172:175], v[32:35], v[84:87]
  v_mfma_f32_16x16x32_bf16 v[88:91], v[172:175], v[36:39], v[88:91]
  v_mfma_f32_16x16x32_bf16 v[104:107], v[152:155], v[40:43], v[104:107]
  v_mfma_f32_16x16x32_bf16 v[108:111], v[152:155], v[44:47], v[108:111]
  ds_read_b128 v[32:35], v7 offset:18976
  ds_read_b128 v[36:39], v7 offset:21536
  ds_read_b128 v[40:43], v7 offset:21792
  ds_read_b128 v[44:47], v7 offset:22048
  v_mfma_f32_16x16x32_bf16 v[56:59], v[24:27], v[188:191], v[56:59]
  v_mfma_f32_16x16x32_bf16 v[60:63], v[28:31], v[188:191], v[60:63]
  v_mfma_f32_16x16x32_bf16 v[72:75], v[24:27], v[212:215], v[72:75]
  v_mfma_f32_16x16x32_bf16 v[76:79], v[28:31], v[212:215], v[76:79]
  s_add_u32 m0, s23, 2048
  s_waitcnt lgkmcnt(0)
  buffer_load_dwordx4 v242, s[4:7], s21 offen lds
  buffer_load_dwordx4 v243, s[8:11], s21 offen offset:1024 lds
  ds_read_b64_tr_b16 v[24:25], v4 offset:4096
  ds_read_b64_tr_b16 v[26:27], v4 offset:4608
  ds_read_b64_tr_b16 v[28:29], v5 offset:4096
  ds_read_b64_tr_b16 v[30:31], v5 offset:4608
  v_mfma_f32_16x16x32_bf16 v[112:115], v[152:155], v[32:35], v[112:115]
  v_mfma_f32_16x16x32_bf16 v[104:107], v[156:159], v[36:39], v[104:107]
  v_mfma_f32_16x16x32_bf16 v[108:111], v[156:159], v[40:43], v[108:111]
  v_mfma_f32_16x16x32_bf16 v[112:115], v[156:159], v[44:47], v[112:115]
  v_mfma_f32_16x16x32_bf16 v[48:51], v[16:19], v[192:195], v[48:51]
  v_mfma_f32_16x16x32_bf16 v[52:55], v[20:23], v[192:195], v[52:55]
  v_mfma_f32_16x16x32_bf16 v[64:67], v[16:19], v[216:219], v[64:67]
  v_mfma_f32_16x16x32_bf16 v[68:71], v[20:23], v[216:219], v[68:71]
  s_add_u32 m0, s23, 4096
  s_waitcnt vmcnt(4) lgkmcnt(0)
  buffer_load_dwordx4 v244, s[4:7], s21 offen lds
  buffer_load_dwordx4 v245, s[8:11], s21 offen offset:1024 lds
  ds_read_b64_tr_b16 v[16:17], v2 offset:8192
  ds_read_b64_tr_b16 v[18:19], v2 offset:8704
  ds_read_b64_tr_b16 v[20:21], v3 offset:8192
  ds_read_b64_tr_b16 v[22:23], v3 offset:8704
  v_mfma_f32_16x16x32_bf16 v[56:59], v[24:27], v[192:195], v[56:59]
  v_mfma_f32_16x16x32_bf16 v[60:63], v[28:31], v[192:195], v[60:63]
  v_mfma_f32_16x16x32_bf16 v[72:75], v[24:27], v[216:219], v[72:75]
  v_mfma_f32_16x16x32_bf16 v[76:79], v[28:31], v[216:219], v[76:79]
  s_add_u32 m0, s23, 6144
  s_waitcnt lgkmcnt(0)
  buffer_load_dwordx4 v246, s[4:7], s21 offen lds
  buffer_load_dwordx4 v247, s[8:11], s21 offen offset:1024 lds
  ds_read_b64_tr_b16 v[24:25], v4 offset:8192
  ds_read_b64_tr_b16 v[26:27], v4 offset:8704
  ds_read_b64_tr_b16 v[28:29], v5 offset:8192
  ds_read_b64_tr_b16 v[30:31], v5 offset:8704
  v_mfma_f32_16x16x32_bf16 v[48:51], v[16:19], v[196:199], v[48:51]
  v_mfma_f32_16x16x32_bf16 v[52:55], v[20:23], v[196:199], v[52:55]
  v_mfma_f32_16x16x32_bf16 v[64:67], v[16:19], v[220:223], v[64:67]
  v_mfma_f32_16x16x32_bf16 v[68:71], v[20:23], v[220:223], v[68:71]
  s_add_u32 m0, s23, 8192
  s_waitcnt lgkmcnt(0)
  v_mfma_f32_16x16x32_bf16 v[56:59], v[24:27], v[196:199], v[56:59]
  v_mfma_f32_16x16x32_bf16 v[60:63], v[28:31], v[196:199], v[60:63]
  v_mfma_f32_16x16x32_bf16 v[72:75], v[24:27], v[220:223], v[72:75]
  v_mfma_f32_16x16x32_bf16 v[76:79], v[28:31], v[220:223], v[76:79]
  s_waitcnt vmcnt(4) lgkmcnt(0)
  buffer_load_dwordx4 v224, s[4:7], s21 offen lds
  buffer_load_dwordx4 v225, s[8:11], s21 offen offset:1024 lds
  ds_read_b64_tr_b16 v[16:17], v2 offset:0
  ds_read_b64_tr_b16 v[18:19], v2 offset:512
  ds_read_b64_tr_b16 v[20:21], v3 offset:0
  ds_read_b64_tr_b16 v[22:23], v3 offset:512
  s_add_u32 s37, s44, 4096
  buffer_load_dwordx4 v[152:155], v10, s[12:15], s44 offen offset:2048
  buffer_load_dwordx4 v[156:159], v10, s[12:15], s44 offen offset:3072
  buffer_load_dwordx4 v[160:163], v10, s[12:15], s37 offen offset:2048
  buffer_load_dwordx4 v[164:167], v10, s[12:15], s37 offen offset:3072
  s_add_u32 m0, s23, 10240
  v_cvt_pk_bf16_f32 v32, v48, v49
  v_cvt_pk_bf16_f32 v33, v50, v51
  v_cvt_pk_bf16_f32 v34, v52, v53
  v_cvt_pk_bf16_f32 v35, v54, v55
  v_cvt_pk_bf16_f32 v36, v56, v57
  v_cvt_pk_bf16_f32 v37, v58, v59
  v_cvt_pk_bf16_f32 v38, v60, v61
  v_cvt_pk_bf16_f32 v39, v62, v63
  v_cvt_pk_bf16_f32 v40, v64, v65
  v_cvt_pk_bf16_f32 v41, v66, v67
  v_cvt_pk_bf16_f32 v42, v68, v69
  v_cvt_pk_bf16_f32 v43, v70, v71
  v_cvt_pk_bf16_f32 v44, v72, v73
  v_cvt_pk_bf16_f32 v45, v74, v75
  v_cvt_pk_bf16_f32 v46, v76, v77
  v_cvt_pk_bf16_f32 v47, v78, v79
  ds_write_b128 v6, v[32:35] offset:16
  ds_write_b128 v6, v[36:39] offset:3088
  s_mov_b64 exec, s[42:43]
  ds_write_b128 v6, v[40:43] offset:0
  ds_write_b128 v6, v[44:47] offset:3072
  s_mov_b64 exec, -1
  v_add_u32 v6, s77, v6
  s_waitcnt lgkmcnt(0)
  buffer_load_dwordx4 v226, s[4:7], s21 offen lds
  buffer_load_dwordx4 v227, s[8:11], s21 offen offset:1024 lds
  ds_read_b64_tr_b16 v[24:25], v4 offset:0
  ds_read_b64_tr_b16 v[26:27], v4 offset:512
  ds_read_b64_tr_b16 v[28:29], v5 offset:0
  ds_read_b64_tr_b16 v[30:31], v5 offset:512
  v_subrev_u32 v7, s77, v7
  v_subrev_u32 v8, s77, v8
  v_mfma_f32_16x16x32_bf16 v[48:51], v[16:19], v[176:179], 0
  v_mfma_f32_16x16x32_bf16 v[52:55], v[20:23], v[176:179], 0
  v_mfma_f32_16x16x32_bf16 v[64:67], v[16:19], v[200:203], 0
  v_mfma_f32_16x16x32_bf16 v[68:71], v[20:23], v[200:203], 0
  s_add_u32 m0, s23, 0
  s_waitcnt vmcnt(8) lgkmcnt(0)
  buffer_load_dwordx4 v228, s[4:7], s21 offen lds
  buffer_load_dwordx4 v229, s[8:11], s21 offen offset:1024 lds
  ds_read_b64_tr_b16 v[16:17], v2 offset:4096
  ds_read_b64_tr_b16 v[18:19], v2 offset:4608
  ds_read_b64_tr_b16 v[20:21], v3 offset:4096
  ds_read_b64_tr_b16 v[22:23], v3 offset:4608
  v_mfma_f32_16x16x32_bf16 v[56:59], v[24:27], v[176:179], 0
  v_mfma_f32_16x16x32_bf16 v[60:63], v[28:31], v[176:179], 0
  v_mfma_f32_16x16x32_bf16 v[72:75], v[24:27], v[200:203], 0
  v_mfma_f32_16x16x32_bf16 v[76:79], v[28:31], v[200:203], 0
  s_add_u32 m0, s23, 2048
  s_waitcnt lgkmcnt(0)
  s_barrier
  buffer_load_dwordx4 v230, s[4:7], s21 offen lds
  buffer_load_dwordx4 v231, s[8:11], s21 offen offset:1024 lds
  ds_read_b64_tr_b16 v[24:25], v4 offset:4096
  ds_read_b64_tr_b16 v[26:27], v4 offset:4608
  ds_read_b64_tr_b16 v[28:29], v5 offset:4096
  ds_read_b64_tr_b16 v[30:31], v5 offset:4608
  ds_read_b128 v[32:35], v7 offset:0
  ds_read_b128 v[36:39], v7 offset:256
  ds_read_b128 v[40:43], v7 offset:512
  ds_read_b128 v[44:47], v7 offset:3072
  v_mfma_f32_16x16x32_bf16 v[48:51], v[16:19], v[180:183], v[48:51]
  v_mfma_f32_16x16x32_bf16 v[52:55], v[20:23], v[180:183], v[52:55]
  v_mfma_f32_16x16x32_bf16 v[64:67], v[16:19], v[204:207], v[64:67]
  v_mfma_f32_16x16x32_bf16 v[68:71], v[20:23], v[204:207], v[68:71]
  s_add_u32 m0, s23, 4096
  s_waitcnt vmcnt(4) lgkmcnt(0)
  buffer_load_dwordx4 v232, s[4:7], s21 offen lds
  buffer_load_dwordx4 v233, s[8:11], s21 offen offset:1024 lds
  ds_read_b64_tr_b16 v[16:17], v2 offset:8192
  ds_read_b64_tr_b16 v[18:19], v2 offset:8704
  ds_read_b64_tr_b16 v[20:21], v3 offset:8192
  ds_read_b64_tr_b16 v[22:23], v3 offset:8704
  v_mfma_f32_16x16x32_bf16 v[80:83], v[128:131], v[32:35], v[80:83]
  v_mfma_f32_16x16x32_bf16 v[84:87], v[128:131], v[36:39], v[84:87]
  v_mfma_f32_16x16x32_bf16 v[88:91], v[128:131], v[40:43], v[88:91]
  v_mfma_f32_16x16x32_bf16 v[80:83], v[132:135], v[44:47], v[80:83]
  ds_read_b128 v[32:35], v7 offset:3328
  ds_read_b128 v[36:39], v7 offset:3584
  ds_read_b128 v[40:43], v7 offset:18464
  ds_read_b128 v[44:47], v7 offset:18720
  v_mfma_f32_16x16x32_bf16 v[56:59], v[24:27], v[180:183], v[56:59]
  v_mfma_f32_16x16x32_bf16 v[60:63], v[28:31], v[180:183], v[60:63]
  v_mfma_f32_16x16x32_bf16 v[72:75], v[24:27], v[204:207], v[72:75]
  v_mfma_f32_16x16x32_bf16 v[76:79], v[28:31], v[204:207], v[76:79]
  s_add_u32 m0, s23, 6144
  s_waitcnt lgkmcnt(0)
  buffer_load_dwordx4 v234, s[4:7], s21 offen lds
  buffer_load_dwordx4 v235, s[8:11], s21 offen offset:1024 lds
  ds_read_b64_tr_b16 v[24:25], v4 offset:8192
  ds_read_b64_tr_b16 v[26:27], v4 offset:8704
  ds_read_b64_tr_b16 v[28:29], v5 offset:8192
  ds_read_b64_tr_b16 v[30:31], v5 offset:8704
  v_mfma_f32_16x16x32_bf16 v[84:87], v[132:135], v[32:35], v[84:87]
  v_mfma_f32_16x16x32_bf16 v[88:91], v[132:135], v[36:39], v[88:91]
  v_mfma_f32_16x16x32_bf16 v[92:95], v[136:139], v[40:43], v[92:95]
  v_mfma_f32_16x16x32_bf16 v[96:99], v[136:139], v[44:47], v[96:99]
  ds_read_b128 v[32:35], v7 offset:18976
  ds_read_b128 v[36:39], v7 offset:21536
  ds_read_b128 v[40:43], v7 offset:21792
  ds_read_b128 v[44:47], v7 offset:22048
  v_mfma_f32_16x16x32_bf16 v[48:51], v[16:19], v[184:187], v[48:51]
  v_mfma_f32_16x16x32_bf16 v[52:55], v[20:23], v[184:187], v[52:55]
  v_mfma_f32_16x16x32_bf16 v[64:67], v[16:19], v[208:211], v[64:67]
  v_mfma_f32_16x16x32_bf16 v[68:71], v[20:23], v[208:211], v[68:71]
  s_add_u32 m0, s23, 8192
  s_waitcnt vmcnt(4) lgkmcnt(0)
  buffer_load_dwordx4 v236, s[4:7], s21 offen lds
  buffer_load_dwordx4 v237, s[8:11], s21 offen offset:1024 lds
  ds_read_b64_tr_b16 v[16:17], v2 offset:0
  ds_read_b64_tr_b16 v[18:19], v2 offset:512
  ds_read_b64_tr_b16 v[20:21], v3 offset:0
  ds_read_b64_tr_b16 v[22:23], v3 offset:512
  v_mfma_f32_16x16x32_bf16 v[100:103], v[136:139], v[32:35], v[100:103]
  v_mfma_f32_16x16x32_bf16 v[92:95], v[140:143], v[36:39], v[92:95]
  v_mfma_f32_16x16x32_bf16 v[96:99], v[140:143], v[40:43], v[96:99]
  v_mfma_f32_16x16x32_bf16 v[100:103], v[140:143], v[44:47], v[100:103]
  ds_read_b128 v[32:35], v8 offset:0
  ds_read_b128 v[36:39], v8 offset:256
  ds_read_b128 v[40:43], v8 offset:512
  ds_read_b128 v[44:47], v8 offset:3072
  v_mfma_f32_16x16x32_bf16 v[56:59], v[24:27], v[184:187], v[56:59]
  v_mfma_f32_16x16x32_bf16 v[60:63], v[28:31], v[184:187], v[60:63]
  v_mfma_f32_16x16x32_bf16 v[72:75], v[24:27], v[208:211], v[72:75]
  v_mfma_f32_16x16x32_bf16 v[76:79], v[28:31], v[208:211], v[76:79]
  s_add_u32 m0, s23, 10240
  s_waitcnt lgkmcnt(0)
  buffer_load_dwordx4 v238, s[4:7], s21 offen lds
  buffer_load_dwordx4 v239, s[8:11], s21 offen offset:1024 lds
  ds_read_b64_tr_b16 v[24:25], v4 offset:0
  ds_read_b64_tr_b16 v[26:27], v4 offset:512
  ds_read_b64_tr_b16 v[28:29], v5 offset:0
  ds_read_b64_tr_b16 v[30:31], v5 offset:512
  v_mfma_f32_16x16x32_bf16 v[104:107], v[136:139], v[32:35], v[104:107]
  v_mfma_f32_16x16x32_bf16 v[108:111], v[136:139], v[36:39], v[108:111]
  v_mfma_f32_16x16x32_bf16 v[112:115], v[136:139], v[40:43], v[112:115]
  v_mfma_f32_16x16x32_bf16 v[104:107], v[140:143], v[44:47], v[104:107]
  ds_read_b128 v[32:35], v8 offset:3328
  ds_read_b128 v[36:39], v8 offset:3584
  ds_read_b128 v[40:43], v8 offset:18464
  ds_read_b128 v[44:47], v8 offset:18720
  v_mfma_f32_16x16x32_bf16 v[48:51], v[16:19], v[188:191], v[48:51]
  v_mfma_f32_16x16x32_bf16 v[52:55], v[20:23], v[188:191], v[52:55]
  v_mfma_f32_16x16x32_bf16 v[64:67], v[16:19], v[212:215], v[64:67]
  v_mfma_f32_16x16x32_bf16 v[68:71], v[20:23], v[212:215], v[68:71]
  s_waitcnt vmcnt(4) lgkmcnt(0)
  ds_read_b64_tr_b16 v[16:17], v2 offset:4096
  ds_read_b64_tr_b16 v[18:19], v2 offset:4608
  ds_read_b64_tr_b16 v[20:21], v3 offset:4096
  ds_read_b64_tr_b16 v[22:23], v3 offset:4608
  v_mfma_f32_16x16x32_bf16 v[108:111], v[140:143], v[32:35], v[108:111]
  v_mfma_f32_16x16x32_bf16 v[112:115], v[140:143], v[36:39], v[112:115]
  v_mfma_f32_16x16x32_bf16 v[116:119], v[136:139], v[40:43], v[116:119]
  v_mfma_f32_16x16x32_bf16 v[120:123], v[136:139], v[44:47], v[120:123]
  ds_read_b128 v[32:35], v8 offset:18976
  ds_read_b128 v[36:39], v8 offset:21536
  ds_read_b128 v[40:43], v8 offset:21792
  ds_read_b128 v[44:47], v8 offset:22048
  v_mfma_f32_16x16x32_bf16 v[56:59], v[24:27], v[188:191], v[56:59]
  v_mfma_f32_16x16x32_bf16 v[60:63], v[28:31], v[188:191], v[60:63]
  v_mfma_f32_16x16x32_bf16 v[72:75], v[24:27], v[212:215], v[72:75]
  v_mfma_f32_16x16x32_bf16 v[76:79], v[28:31], v[212:215], v[76:79]
  s_waitcnt lgkmcnt(0)
  ds_read_b64_tr_b16 v[24:25], v4 offset:4096
  ds_read_b64_tr_b16 v[26:27], v4 offset:4608
  ds_read_b64_tr_b16 v[28:29], v5 offset:4096
  ds_read_b64_tr_b16 v[30:31], v5 offset:4608
  v_mfma_f32_16x16x32_bf16 v[124:127], v[136:139], v[32:35], v[124:127]
  v_mfma_f32_16x16x32_bf16 v[116:119], v[140:143], v[36:39], v[116:119]
  v_mfma_f32_16x16x32_bf16 v[120:123], v[140:143], v[40:43], v[120:123]
  v_mfma_f32_16x16x32_bf16 v[124:127], v[140:143], v[44:47], v[124:127]
  v_mfma_f32_16x16x32_bf16 v[48:51], v[16:19], v[192:195], v[48:51]
  v_mfma_f32_16x16x32_bf16 v[52:55], v[20:23], v[192:195], v[52:55]
  v_mfma_f32_16x16x32_bf16 v[64:67], v[16:19], v[216:219], v[64:67]
  v_mfma_f32_16x16x32_bf16 v[68:71], v[20:23], v[216:219], v[68:71]
  s_waitcnt vmcnt(0) lgkmcnt(0)
  ds_read_b64_tr_b16 v[16:17], v2 offset:8192
  ds_read_b64_tr_b16 v[18:19], v2 offset:8704
  ds_read_b64_tr_b16 v[20:21], v3 offset:8192
  ds_read_b64_tr_b16 v[22:23], v3 offset:8704
  v_mfma_f32_16x16x32_bf16 v[56:59], v[24:27], v[192:195], v[56:59]
  v_mfma_f32_16x16x32_bf16 v[60:63], v[28:31], v[192:195], v[60:63]
  v_mfma_f32_16x16x32_bf16 v[72:75], v[24:27], v[216:219], v[72:75]
  v_mfma_f32_16x16x32_bf16 v[76:79], v[28:31], v[216:219], v[76:79]
  s_waitcnt lgkmcnt(0)
  ds_read_b64_tr_b16 v[24:25], v4 offset:8192
  ds_read_b64_tr_b16 v[26:27], v4 offset:8704
  ds_read_b64_tr_b16 v[28:29], v5 offset:8192
  ds_read_b64_tr_b16 v[30:31], v5 offset:8704
  v_mfma_f32_16x16x32_bf16 v[48:51], v[16:19], v[196:199], v[48:51]
  v_mfma_f32_16x16x32_bf16 v[52:55], v[20:23], v[196:199], v[52:55]
  v_mfma_f32_16x16x32_bf16 v[64:67], v[16:19], v[220:223], v[64:67]
  v_mfma_f32_16x16x32_bf16 v[68:71], v[20:23], v[220:223], v[68:71]
  s_waitcnt lgkmcnt(0)
  v_mfma_f32_16x16x32_bf16 v[56:59], v[24:27], v[196:199], v[56:59]
  v_mfma_f32_16x16x32_bf16 v[60:63], v[28:31], v[196:199], v[60:63]
  v_mfma_f32_16x16x32_bf16 v[72:75], v[24:27], v[220:223], v[72:75]
  v_mfma_f32_16x16x32_bf16 v[76:79], v[28:31], v[220:223], v[76:79]
K2_TAIL:
  s_nop 7
  s_nop 3
  v_cvt_pk_bf16_f32 v32, v48, v49
  v_cvt_pk_bf16_f32 v33, v50, v51
  v_cvt_pk_bf16_f32 v34, v52, v53
  v_cvt_pk_bf16_f32 v35, v54, v55
  v_cvt_pk_bf16_f32 v36, v56, v57
  v_cvt_pk_bf16_f32 v37, v58, v59
  v_cvt_pk_bf16_f32 v38, v60, v61
  v_cvt_pk_bf16_f32 v39, v62, v63
  v_cvt_pk_bf16_f32 v40, v64, v65
  v_cvt_pk_bf16_f32 v41, v66, v67
  v_cvt_pk_bf16_f32 v42, v68, v69
  v_cvt_pk_bf16_f32 v43, v70, v71
  v_cvt_pk_bf16_f32 v44, v72, v73
  v_cvt_pk_bf16_f32 v45, v74, v75
  v_cvt_pk_bf16_f32 v46, v76, v77
  v_cvt_pk_bf16_f32 v47, v78, v79
  ds_write_b128 v6, v[32:35] offset:16
  ds_write_b128 v6, v[36:39] offset:3088
  s_mov_b64 exec, s[42:43]
  ds_write_b128 v6, v[40:43] offset:0
  ds_write_b128 v6, v[44:47] offset:3072
  s_mov_b64 exec, -1
  v_subrev_u32 v6, s77, v6
  v_add_u32 v7, s77, v7
  v_add_u32 v8, s77, v8
  s_waitcnt vmcnt(0) lgkmcnt(0)
  s_barrier
  ds_read_b128 v[176:179], v7 offset:0
  ds_read_b128 v[180:183], v7 offset:256
  ds_read_b128 v[184:187], v7 offset:512
  ds_read_b128 v[188:191], v7 offset:3072
  ds_read_b128 v[192:195], v7 offset:3328
  ds_read_b128 v[196:199], v7 offset:3584
  ds_read_b128 v[200:203], v7 offset:18464
  ds_read_b128 v[204:207], v7 offset:18720
  ds_read_b128 v[208:211], v7 offset:18976
  ds_read_b128 v[212:215], v7 offset:21536
  ds_read_b128 v[216:219], v7 offset:21792
  ds_read_b128 v[220:223], v7 offset:22048
  s_waitcnt lgkmcnt(11)
  v_mfma_f32_16x16x32_bf16 v[80:83], v[152:155], v[176:179], v[80:83]
  ds_read_b128 v[48:51], v8 offset:0
  s_waitcnt lgkmcnt(11)
  v_mfma_f32_16x16x32_bf16 v[84:87], v[152:155], v[180:183], v[84:87]
  ds_read_b128 v[52:55], v8 offset:256
  s_waitcnt lgkmcnt(11)
  v_mfma_f32_16x16x32_bf16 v[88:91], v[152:155], v[184:187], v[88:91]
  ds_read_b128 v[56:59], v8 offset:512
  s_waitcnt lgkmcnt(11)
  v_mfma_f32_16x16x32_bf16 v[80:83], v[156:159], v[188:191], v[80:83]
  ds_read_b128 v[60:63], v8 offset:3072
  s_waitcnt lgkmcnt(11)
  v_mfma_f32_16x16x32_bf16 v[84:87], v[156:159], v[192:195], v[84:87]
  ds_read_b128 v[64:67], v8 offset:3328
  s_waitcnt lgkmcnt(11)
  v_mfma_f32_16x16x32_bf16 v[88:91], v[156:159], v[196:199], v[88:91]
  ds_read_b128 v[68:71], v8 offset:3584
  s_waitcnt lgkmcnt(11)
  v_mfma_f32_16x16x32_bf16 v[92:95], v[160:163], v[200:203], v[92:95]
  ds_read_b128 v[72:75], v8 offset:18464
  s_waitcnt lgkmcnt(11)
  v_mfma_f32_16x16x32_bf16 v[96:99], v[160:163], v[204:207], v[96:99]
  ds_read_b128 v[76:79], v8 offset:18720
  s_waitcnt lgkmcnt(11)
  v_mfma_f32_16x16x32_bf16 v[100:103], v[160:163], v[208:211], v[100:103]
  ds_read_b128 v[16:19], v8 offset:18976
  s_waitcnt lgkmcnt(11)
  v_mfma_f32_16x16x32_bf16 v[92:95], v[164:167], v[212:215], v[92:95]
  ds_read_b128 v[20:23], v8 offset:21536
  s_waitcnt lgkmcnt(11)
  v_mfma_f32_16x16x32_bf16 v[96:99], v[164:167], v[216:219], v[96:99]
  ds_read_b128 v[24:27], v8 offset:21792
  s_waitcnt lgkmcnt(11)
  v_mfma_f32_16x16x32_bf16 v[100:103], v[164:167], v[220:223], v[100:103]
  ds_read_b128 v[28:31], v8 offset:22048
  s_waitcnt lgkmcnt(11)
  v_mfma_f32_16x16x32_bf16 v[104:107], v[160:163], v[48:51], v[104:107]
  s_waitcnt lgkmcnt(10)
  v_mfma_f32_16x16x32_bf16 v[108:111], v[160:163], v[52:55], v[108:111]
  s_waitcnt lgkmcnt(9)
  v_mfma_f32_16x16x32_bf16 v[112:115], v[160:163], v[56:59], v[112:115]
  s_waitcnt lgkmcnt(8)
  v_mfma_f32_16x16x32_bf16 v[104:107], v[164:167], v[60:63], v[104:107]
  s_waitcnt lgkmcnt(7)
  v_mfma_f32_16x16x32_bf16 v[108:111], v[164:167], v[64:67], v[108:111]
  s_waitcnt lgkmcnt(6)
  v_mfma_f32_16x16x32_bf16 v[112:115], v[164:167], v[68:71], v[112:115]
  s_waitcnt lgkmcnt(5)
  v_mfma_f32_16x16x32_bf16 v[116:119], v[160:163], v[72:75], v[116:119]
  s_waitcnt lgkmcnt(4)
  v_mfma_f32_16x16x32_bf16 v[120:123], v[160:163], v[76:79], v[120:123]
  s_waitcnt lgkmcnt(3)
  v_mfma_f32_16x16x32_bf16 v[124:127], v[160:163], v[16:19], v[124:127]
  s_waitcnt lgkmcnt(2)
  v_mfma_f32_16x16x32_bf16 v[116:119], v[164:167], v[20:23], v[116:119]
  s_waitcnt lgkmcnt(1)
  v_mfma_f32_16x16x32_bf16 v[120:123], v[164:167], v[24:27], v[120:123]
  s_waitcnt lgkmcnt(0)
  v_mfma_f32_16x16x32_bf16 v[124:127], v[164:167], v[28:31], v[124:127]
  v_subrev_u32 v7, s77, v7
  v_subrev_u32 v8, s77, v8
  s_cmp_eq_u32 s27, 0
  s_cbranch_scc1 K2_EPI
  s_cmp_lg_u32 s28, 0
  s_cbranch_scc0 K2_NEXTC
  s_add_u32 s26, s26, 20
  s_branch K2_RELOAD
K2_NEXTC:
  s_mov_b32 s26, 0
  s_add_u32 s24, s24, s25
  s_cmp_ge_u32 s24, 250
  s_cbranch_scc1 K2_EPI
  s_branch K2_RELOAD
K2_FALLBACK:
  s_mov_b32 s27, 1
  s_mov_b32 s25, 9
  s_mov_b32 s24, 0
  s_mov_b32 s26, 0
K2_RELOAD:
  s_waitcnt vmcnt(0) lgkmcnt(0)
  s_barrier
  v_lshrrev_b32 v61, 1, v0
  v_add_u32 v61, s24, v61
  v_min_u32 v61, 255, v61
  v_lshrrev_b32 v62, 2, v61
  v_lshlrev_b32 v62, 7, v62
  v_and_b32 v63, 3, v61
  v_lshl_add_u32 v62, v63, 5, v62
  buffer_load_dword v63, v62, s[12:15], s29 offen sc1
  s_waitcnt vmcnt(0)
  s_branch K2_ROUND
F_NOPOLL:
  v_and_b32 v63, 0x07ff07ff, v63
  v_lshrrev_b32 v61, 1, v0
  v_add_u32 v64, s24, v61
  v_cmp_gt_u32 vcc, s25, v61
  s_mov_b32 s45, 250
  v_cmp_gt_u32 s[40:41], s45, v64
  s_nop 1
  s_and_b64 vcc, vcc, s[40:41]
  s_nop 1
  v_cndmask_b32 v63, 0, v63, vcc
  v_lshrrev_b32 v65, 16, v63
  v_and_b32 v67, 0xffff, v63
  v_subrev_u32 v65, s26, v65
  v_max_i32 v65, 0, v65
  v_sub_u32 v66, v65, v249
  v_mul_u32_u24 v64, 1280, v64
  v_add3_u32 v64, v64, v67, s26
  v_add_u32 v64, v64, v249
  v_mul_u32_u24 v64, 12, v64
  s_branch F_RECLD
K2_IDENT:
  v_cmp_gt_u32 vcc, 40, v1
  v_mul_u32_u24 v71, 52, v1
  v_lshrrev_b32 v71, 8, v71
  v_mad_u32_u24 v71, v71, 3, v1
  v_subrev_u32 v74, 40, v1
  v_mul_u32_u24 v75, 86, v74
  v_lshrrev_b32 v75, 8, v75
  v_mad_u32_u24 v75, v75, 5, v74
  v_add_u32 v75, 5, v75
  v_cndmask_b32 v71, v75, v71, vcc
  s_branch K2_PERM
K2_EPI:
  s_nop 7
  v_and_b32 v12, 15, v1
  v_lshrrev_b32 v13, 4, v1
  v_mul_u32_u24 v12, 1040, v12
  v_lshl_add_u32 v12, v13, 3, v12
  s_lshl_b32 s37, s3, 5
  v_add_u32 v12, s37, v12
  s_mul_i32 s37, s3, 5200
  v_add_u32 v13, s37, v10
  s_mov_b32 s45, 0xbfb8aa3b
  v_mul_f32 v20, s45, v80
  v_mul_f32 v21, s45, v81
  v_mul_f32 v22, s45, v82
  v_mul_f32 v23, s45, v83
  v_exp_f32 v20, v20
  v_exp_f32 v21, v21
  v_exp_f32 v22, v22
  v_exp_f32 v23, v23
  s_nop 0
  v_add_f32 v20, 1.0, v20
  v_add_f32 v21, 1.0, v21
  v_add_f32 v22, 1.0, v22
  v_add_f32 v23, 1.0, v23
  v_rcp_f32 v20, v20
  v_rcp_f32 v21, v21
  v_rcp_f32 v22, v22
  v_rcp_f32 v23, v23
  v_mul_f32 v24, s45, v84
  v_mul_f32 v25, s45, v85
  v_mul_f32 v26, s45, v86
  v_mul_f32 v27, s45, v87
  v_exp_f32 v24, v24
  v_exp_f32 v25, v25
  v_exp_f32 v26, v26
  v_exp_f32 v27, v27
  s_nop 0
  v_add_f32 v24, 1.0, v24
  v_add_f32 v25, 1.0, v25
  v_add_f32 v26, 1.0, v26
  v_add_f32 v27, 1.0, v27
  v_rcp_f32 v24, v24
  v_rcp_f32 v25, v25
  v_rcp_f32 v26, v26
  v_rcp_f32 v27, v27
  v_mul_f32 v28, s45, v88
  v_mul_f32 v29, s45, v89
  v_mul_f32 v30, s45, v90
  v_mul_f32 v31, s45, v91
  v_exp_f32 v28, v28
  v_exp_f32 v29, v29
  v_exp_f32 v30, v30
  v_exp_f32 v31, v31
  s_nop 0
  v_add_f32 v28, 1.0, v28
  v_add_f32 v29, 1.0, v29
  v_add_f32 v30, 1.0, v30
  v_add_f32 v31, 1.0, v31
  v_rcp_f32 v28, v28
  v_rcp_f32 v29, v29
  v_rcp_f32 v30, v30
  v_rcp_f32 v31, v31
  s_nop 0
  v_cvt_pk_bf16_f32 v32, v80, v81
  v_cvt_pk_bf16_f32 v33, v82, v83
  ds_write_b64 v12, v[32:33] offset:0
  v_mul_f32 v92, v92, v20
  v_mul_f32 v93, v93, v21
  v_mul_f32 v94, v94, v22
  v_mul_f32 v95, v95, v23
  v_cvt_pk_bf16_f32 v34, v92, v93
  v_cvt_pk_bf16_f32 v35, v94, v95
  ds_write_b64 v12, v[34:35] offset:256
  v_mul_f32 v104, v104, v20
  v_mul_f32 v105, v105, v21
  v_mul_f32 v106, v106, v22
  v_mul_f32 v107, v107, v23
  v_cvt_pk_bf16_f32 v36, v104, v105
  v_cvt_pk_bf16_f32 v37, v106, v107
  ds_write_b64 v12, v[36:37] offset:512
  v_mul_f32 v116, v116, v20
  v_mul_f32 v117, v117, v21
  v_mul_f32 v118, v118, v22
  v_mul_f32 v119, v119, v23
  v_cvt_pk_bf16_f32 v38, v116, v117
  v_cvt_pk_bf16_f32 v39, v118, v119
  ds_write_b64 v12, v[38:39] offset:768
  v_cvt_pk_bf16_f32 v40, v84, v85
  v_cvt_pk_bf16_f32 v41, v86, v87
  ds_write_b64 v12, v[40:41] offset:16640
  v_mul_f32 v96, v96, v24
  v_mul_f32 v97, v97, v25
  v_mul_f32 v98, v98, v26
  v_mul_f32 v99, v99, v27
  v_cvt_pk_bf16_f32 v42, v96, v97
  v_cvt_pk_bf16_f32 v43, v98, v99
  ds_write_b64 v12, v[42:43] offset:16896
  v_mul_f32 v108, v108, v24
  v_mul_f32 v109, v109, v25
  v_mul_f32 v110, v110, v26
  v_mul_f32 v111, v111, v27
  v_cvt_pk_bf16_f32 v44, v108, v109
  v_cvt_pk_bf16_f32 v45, v110, v111
  ds_write_b64 v12, v[44:45] offset:17152
  v_mul_f32 v120, v120, v24
  v_mul_f32 v121, v121, v25
  v_mul_f32 v122, v122, v26
  v_mul_f32 v123, v123, v27
  v_cvt_pk_bf16_f32 v46, v120, v121
  v_cvt_pk_bf16_f32 v47, v122, v123
  ds_write_b64 v12, v[46:47] offset:17408
  v_cvt_pk_bf16_f32 v48, v88, v89
  v_cvt_pk_bf16_f32 v49, v90, v91
  ds_write_b64 v12, v[48:49] offset:33280
  v_mul_f32 v100, v100, v28
  v_mul_f32 v101, v101, v29
  v_mul_f32 v102, v102, v30
  v_mul_f32 v103, v103, v31
  v_cvt_pk_bf16_f32 v50, v100, v101
  v_cvt_pk_bf16_f32 v51, v102, v103
  ds_write_b64 v12, v[50:51] offset:33536
  v_mul_f32 v112, v112, v28
  v_mul_f32 v113, v113, v29
  v_mul_f32 v114, v114, v30
  v_mul_f32 v115, v115, v31
  v_cvt_pk_bf16_f32 v52, v112, v113
  v_cvt_pk_bf16_f32 v53, v114, v115
  ds_write_b64 v12, v[52:53] offset:33792
  v_mul_f32 v124, v124, v28
  v_mul_f32 v125, v125, v29
  v_mul_f32 v126, v126, v30
  v_mul_f32 v127, v127, v31
  v_cvt_pk_bf16_f32 v54, v124, v125
  v_cvt_pk_bf16_f32 v55, v126, v127
  ds_write_b64 v12, v[54:55] offset:34048
  s_waitcnt lgkmcnt(0)
  s_barrier
  ds_read_b128 v[64:67], v13 offset:0
  ds_read_b128 v[68:71], v13 offset:1040
  ds_read_b128 v[72:75], v13 offset:2080
  ds_read_b128 v[76:79], v13 offset:3120
  ds_read_b128 v[80:83], v13 offset:4160
  s_waitcnt lgkmcnt(4)
  s_bitcmp1_b32 s81, 0
  s_cbranch_scc0 K2_NOST0
  buffer_store_dwordx4 v[64:67], v10, s[16:19], s72 offen sc0 sc1
K2_NOST0:
  s_waitcnt lgkmcnt(3)
  s_bitcmp1_b32 s81, 1
  s_cbranch_scc0 K2_NOST1
  buffer_store_dwordx4 v[68:71], v10, s[16:19], s73 offen sc0 sc1
K2_NOST1:
  s_waitcnt lgkmcnt(2)
  s_bitcmp1_b32 s81, 2
  s_cbranch_scc0 K2_NOST2
  buffer_store_dwordx4 v[72:75], v10, s[16:19], s74 offen sc0 sc1
K2_NOST2:
  s_waitcnt lgkmcnt(1)
  s_bitcmp1_b32 s81, 3
  s_cbranch_scc0 K2_NOST3
  buffer_store_dwordx4 v[76:79], v10, s[16:19], s75 offen sc0 sc1
K2_NOST3:
  s_waitcnt lgkmcnt(0)
  s_bitcmp1_b32 s81, 4
  s_cbranch_scc0 K2_NOST4
  buffer_store_dwordx4 v[80:83], v10, s[16:19], s76 offen sc0 sc1
K2_NOST4:
K2_END:
  s_endpgm
.section .rodata,"a"
.p2align 6
.amdhsa_kernel standalone__tensor_product_equiv_equiformer__graph_kernel
  .amdhsa_next_free_vgpr 256
  .amdhsa_next_free_sgpr 102
  .amdhsa_accum_offset 256
  .amdhsa_group_segment_fixed_size 0
  .amdhsa_kernarg_size 96
  .amdhsa_user_sgpr_count 2
  .amdhsa_user_sgpr_kernarg_segment_ptr 1
  .amdhsa_system_sgpr_workgroup_id_x 1
.end_amdhsa_kernel
```
